```python
import torch

def _softmax(x, axis=-1):
    return torch.softmax(x, dim=axis)
def _gelu(x):
    return torch.nn.functional.gelu(x, approximate="tanh")
def _silu(x):
    return torch.nn.functional.silu(x)
def _sigmoid(x):
    return torch.sigmoid(x)
def _layernorm(x, axis=-1, eps=1e-5):
    m = x.mean(dim=axis, keepdim=True)
    v = x.var(dim=axis, keepdim=True, unbiased=False)
    return (x - m) / torch.sqrt(v + eps)
def _scatter_add(tgt, idx, src, axis=0):
    return tgt.clone().index_add_(axis, idx, src)
def _segment_sum(src, seg, n):
    out = torch.zeros((n,) + src.shape[1:], dtype=src.dtype)
    return out.index_add_(0, seg, src)
def _pad(x, pw):
    flat = tuple(v for pair in reversed(pw) for v in pair)
    return torch.nn.functional.pad(x, flat)

kernel_name = 'gated_mix__linear_attn_block__mha_block__prompt'

def setup_inputs():

    _w = (lambda a: (lambda t: t.to(torch.bfloat16) if t.is_floating_point() else t)(torch.as_tensor(a)))
    def _A_setup():
        B, S, D = 1, 2048, 576
        return {
            "x": _w((lambda *s: torch.randn(*s, dtype=torch.bfloat16) * 0.05)(B, S, D)),
            "wqkv": _w((lambda *s: torch.randn(*s, dtype=torch.bfloat16) * 0.8)(D, 3 * D)),
            "wo": _w((lambda *s: torch.randn(*s, dtype=torch.bfloat16) * 0.2)(D, D)),
        }
    _A_in = _A_setup()

    def _B_setup():
        B, S, D, H = 1, 2048, 576, 32
        return {
            "x": _w((lambda *s: torch.randn(*s, dtype=torch.bfloat16) * 0.05)(B, S, D)),
            "wqkv": _w((lambda *s: torch.randn(*s, dtype=torch.bfloat16) * 0.8)(D, 3 * D)),
            "wo": _w((lambda *s: torch.randn(*s, dtype=torch.bfloat16) * 0.05)(D, D)),
        }
    _B_in = _B_setup()

    return {
        "A_x": _A_in["x"],
        "A_wqkv": _A_in["wqkv"],
        "A_wo": _A_in["wo"],
        "B_x": _B_in["x"],
        "B_wqkv": _B_in["wqkv"],
        "B_wo": _B_in["wo"],
        "gate_w": _w((lambda *s: torch.randn(*s, dtype=torch.bfloat16) * 0.05)(576) * 16.0),
    }

def reference(A_x, A_wqkv, A_wo, B_x, B_wqkv, B_wo, gate_w):
    def _A_ref(x, wqkv, wo):
        B, S, D = x.shape
        H = 32; Dh = D // H
        qkv = (lambda x, *d: x.permute(*d))((x @ wqkv).reshape(B, S, 3, H, Dh), 2, 0, 3, 1, 4)
        q, k, v = qkv[0], qkv[1], qkv[2]
        phi = lambda t: torch.where(t > 0, t + 1, torch.exp(t)) + 1e-6
        pq, pk = phi(q), phi(k)
        kv = torch.einsum("bhsd,bhse->bhde", pk, v)
        z = torch.einsum("bhsd->bhd", pk)
        num = torch.einsum("bhqd,bhde->bhqe", pq, kv)
        den = torch.einsum("bhqd,bhd->bhq", pq, z)[..., None] + 1e-6
        o = num / den
        return (lambda x, *d: x.permute(*d))(o, 0, 2, 1, 3).reshape(B, S, D) @ wo

    def _B_ref(x, wqkv, wo):
        B, S, D = x.shape
        H = 32
        Dh = D // H
        qkv = (lambda x, *d: x.permute(*d))((x @ wqkv).reshape(B, S, 3, H, Dh), 2, 0, 3, 1, 4)
        q, k, v = qkv[0], qkv[1], qkv[2]
        scores = torch.einsum("bhqd,bhkd->bhqk", q, k) * (Dh ** -0.5)
        p = _softmax(scores, axis=-1)
        o = torch.einsum("bhqk,bhkd->bhqd", p, v)
        return (lambda x, *d: x.permute(*d))(o, 0, 2, 1, 3).reshape(B, S, D) @ wo

    x = A_x
    g = _sigmoid((x * gate_w).sum(-1, keepdims=True))
    a = _A_ref(x, A_wqkv, A_wo)
    b = _B_ref(x, B_wqkv, B_wo)
    return g * a + (1 - g) * b
```

```asm
; @launch grid=(256,1,1) block=(768,1,1) lds=163840
.amdgcn_target "amdgcn-amd-amdhsa--gfx950"
.text
.globl gated_mix__linear_attn_block__mha_block__prompt_kernel
.p2align 8
.type gated_mix__linear_attn_block__mha_block__prompt_kernel,@function
gated_mix__linear_attn_block__mha_block__prompt_kernel:
  s_cmp_ge_u32 s2, 256
  s_cbranch_scc1 gated_mix__linear_attn_block__mha_block__prompt_kernel_end
  s_load_dwordx2 s[8:9], s[0:1], 0
  s_load_dwordx2 s[16:17], s[0:1], 8
  s_load_dwordx2 s[18:19], s[0:1], 32
  s_load_dwordx2 s[4:5], s[0:1], 48
  s_load_dwordx2 s[92:93], s[0:1], 64
  s_load_dwordx2 s[12:13], s[0:1], 72
  s_load_dwordx2 s[84:85], s[0:1], 16
  s_load_dwordx2 s[96:97], s[0:1], 40
  s_load_dwordx2 s[88:89], s[0:1], 56
  s_mov_b32 s86, 663552
  s_mov_b32 s87, 0x00020000
  s_mov_b32 s98, 663552
  s_mov_b32 s99, 0x00020000
  s_mov_b32 s90, 2359296
  s_mov_b32 s91, 0x00020000
  s_mov_b32 s10, 2359296
  s_mov_b32 s11, 0x00020000
  s_mov_b32 s14, 21099520
  s_mov_b32 s15, 0x00020000
  s_mov_b32 s6, 1152
  s_mov_b32 s7, 0x00020000
  s_mov_b32 s94, 256
  s_mov_b32 s95, 0x00020000
  v_lshrrev_b32 v2, 6, v0
  v_and_b32 v1, 63, v0
  s_and_b32 s28, s2, 7
  v_readfirstlane_b32 s24, v2
  s_lshr_b32 s29, s2, 3
  s_and_b32 s22, s28, 1
  s_lshl_b32 s22, s22, 3
  s_and_b32 s30, s29, 7
  s_add_u32 s22, s22, s30
  s_lshr_b32 s23, s28, 1
  s_lshl_b32 s23, s23, 2
  s_lshr_b32 s30, s29, 3
  s_add_u32 s23, s23, s30
  s_mov_b32 s30, 804084376
  s_mov_b32 s31, 1125152459
  s_lshl_b32 s23, s23, 2
  s_lshr_b64 s[30:31], s[30:31], s23
  s_and_b32 s23, s30, 15
  s_and_b32 s42, s23, 7
  s_lshr_b32 s43, s23, 3
  s_cmp_gt_u32 s24, 3
  s_cbranch_scc1 gated_mix__linear_attn_block__mha_block__prompt_kernel_comp
  v_lshrrev_b32 v2, 3, v1
  s_lshl_b32 s28, s24, 3
  v_add_u32 v2, s28, v2
  v_lshrrev_b32 v3, 1, v2
  v_and_b32 v3, 7, v3
  v_and_b32 v4, 7, v1
  v_xor_b32 v3, v3, v4
  v_lshlrev_b32 v3, 4, v3
  s_lshl_b32 s28, s22, 7
  v_add_u32 v2, s28, v2
  v_mul_u32_u24 v2, 1152, v2
  v_add_u32 v10, v2, v3
  s_lshl_b32 s33, s24, 10
  s_waitcnt lgkmcnt(0)
  s_add_u32 m0, s33, 32768
  s_mov_b32 s28, 0
  buffer_load_dwordx4 v10, s[8:11], s28 offen lds
  s_add_u32 m0, s33, 36864
  s_mov_b32 s28, 36864
  buffer_load_dwordx4 v10, s[8:11], s28 offen lds
  s_add_u32 m0, s33, 40960
  s_mov_b32 s28, 73728
  buffer_load_dwordx4 v10, s[8:11], s28 offen lds
  s_add_u32 m0, s33, 45056
  s_mov_b32 s28, 110592
  buffer_load_dwordx4 v10, s[8:11], s28 offen lds
  s_add_u32 m0, s33, 81920
  s_mov_b32 s28, 128
  buffer_load_dwordx4 v10, s[8:11], s28 offen lds
  s_add_u32 m0, s33, 86016
  s_mov_b32 s28, 36992
  buffer_load_dwordx4 v10, s[8:11], s28 offen lds
  s_add_u32 m0, s33, 90112
  s_mov_b32 s28, 73856
  buffer_load_dwordx4 v10, s[8:11], s28 offen lds
  s_add_u32 m0, s33, 94208
  s_mov_b32 s28, 110720
  buffer_load_dwordx4 v10, s[8:11], s28 offen lds
  s_setprio 1
  v_lshlrev_b32 v20, 4, v1
  v_and_b32 v21, 31, v1
  v_lshrrev_b32 v22, 5, v1
  v_lshlrev_b32 v23, 2, v21
  s_mul_i32 s45, s42, 432
  s_mov_b32 s46, 216
  s_mov_b32 s47, 8
  s_mov_b32 s48, 0
  s_mov_b32 s44, 0
  s_cmp_eq_u32 s43, 0
  s_cbranch_scc0 gated_mix__linear_attn_block__mha_block__prompt_kernel_pv
  s_cmp_gt_u32 s42, 5
  s_cbranch_scc0 gated_mix__linear_attn_block__mha_block__prompt_kernel_pq1
  s_sub_u32 s45, s45, 2304
  s_mov_b32 s44, 1
  s_branch gated_mix__linear_attn_block__mha_block__prompt_kernel_pd
gated_mix__linear_attn_block__mha_block__prompt_kernel_pq1:
  s_cmp_eq_u32 s42, 5
  s_cbranch_scc0 gated_mix__linear_attn_block__mha_block__prompt_kernel_pd
  s_mov_b32 s46, 72
  s_mov_b32 s47, 3
  s_branch gated_mix__linear_attn_block__mha_block__prompt_kernel_pd
gated_mix__linear_attn_block__mha_block__prompt_kernel_pv:
  s_cmp_gt_u32 s42, 2
  s_cbranch_scc0 gated_mix__linear_attn_block__mha_block__prompt_kernel_pv1
  s_mov_b32 s44, 1
  s_cmp_gt_u32 s42, 5
  s_cbranch_scc1 gated_mix__linear_attn_block__mha_block__prompt_kernel_pv2
  s_add_u32 s45, s45, 1152
  s_cmp_eq_u32 s42, 5
  s_cbranch_scc0 gated_mix__linear_attn_block__mha_block__prompt_kernel_pd
  s_mov_b32 s46, 72
  s_mov_b32 s47, 3
  s_mov_b32 s48, 1152
  s_branch gated_mix__linear_attn_block__mha_block__prompt_kernel_pd
gated_mix__linear_attn_block__mha_block__prompt_kernel_pv2:
  s_sub_u32 s45, s45, 1152
  s_branch gated_mix__linear_attn_block__mha_block__prompt_kernel_pd
gated_mix__linear_attn_block__mha_block__prompt_kernel_pv1:
  s_add_u32 s45, s45, 2304
  s_cmp_eq_u32 s42, 2
  s_cbranch_scc0 gated_mix__linear_attn_block__mha_block__prompt_kernel_pd
  s_mov_b32 s46, 144
  s_mov_b32 s47, 5
  s_mov_b32 s48, 2304
gated_mix__linear_attn_block__mha_block__prompt_kernel_pd:
  s_cmp_lg_u32 s2, 0
  s_cbranch_scc1 gated_mix__linear_attn_block__mha_block__prompt_kernel_nonce1
  s_cmp_lg_u32 s24, 0
  s_cbranch_scc1 gated_mix__linear_attn_block__mha_block__prompt_kernel_nonce1
  s_memrealtime s[80:81]
  s_waitcnt lgkmcnt(0)
  s_or_b32 s80, s80, 1
  v_mov_b32 v2, s80
  v_mov_b32 v3, 0
  s_mov_b64 exec, 1
  buffer_store_dword v2, v3, s[92:95], 0 offen sc1
  s_mov_b64 exec, -1
gated_mix__linear_attn_block__mha_block__prompt_kernel_nonce1:
  s_cmp_eq_u32 s44, 0
  s_cselect_b32 s72, s18, s16
  s_cselect_b32 s73, s19, s17
  s_mov_b32 s74, 1990656
  s_mov_b32 s75, 0x00020000
  s_mov_b32 s31, 0
  s_mov_b32 s32, 0
  s_cmp_eq_u32 s47, 8
  s_cbranch_scc1 gated_mix__linear_attn_block__mha_block__prompt_kernel_ld_single
  s_cmp_eq_u32 s44, 1
  s_cbranch_scc1 gated_mix__linear_attn_block__mha_block__prompt_kernel_ld_single
  s_sub_u32 s76, s16, s18
  s_subb_u32 s77, s17, s19
  s_cmp_lt_i32 s77, 0
  s_cbranch_scc1 gated_mix__linear_attn_block__mha_block__prompt_kernel_ld_neg
  s_cmp_lg_u32 s77, 0
  s_cbranch_scc1 gated_mix__linear_attn_block__mha_block__prompt_kernel_ld_far
  s_cmp_gt_u32 s76, 0xffc00000
  s_cbranch_scc1 gated_mix__linear_attn_block__mha_block__prompt_kernel_ld_far
  s_mov_b32 s32, s76
  s_add_u32 s74, s76, 1990656
  s_branch gated_mix__linear_attn_block__mha_block__prompt_kernel_ld_single
gated_mix__linear_attn_block__mha_block__prompt_kernel_ld_neg:
  s_sub_u32 s76, s18, s16
  s_subb_u32 s77, s19, s17
  s_cmp_lg_u32 s77, 0
  s_cbranch_scc1 gated_mix__linear_attn_block__mha_block__prompt_kernel_ld_far
  s_cmp_gt_u32 s76, 0xffc00000
  s_cbranch_scc1 gated_mix__linear_attn_block__mha_block__prompt_kernel_ld_far
  s_mov_b32 s72, s16
  s_mov_b32 s73, s17
  s_mov_b32 s31, s76
  s_add_u32 s74, s76, 1990656
gated_mix__linear_attn_block__mha_block__prompt_kernel_ld_single:
  s_lshl_b32 s28, s24, 1
  v_add_u32 v2, s28, v22
  v_and_b32 v3, 3, v2
  v_lshrrev_b32 v4, 2, v21
  v_xor_b32 v3, v4, v3
  v_and_b32 v4, 3, v21
  v_lshlrev_b32 v4, 4, v4
  v_lshlrev_b32 v5, 6, v3
  v_add_u32 v5, v5, v4
  v_mov_b32 v6, 496
  v_cmp_ne_u32 s[40:41], v5, v6
  v_cmp_gt_u32 vcc, s47, v3
  s_andn2_b32 s28, s45, 63
  s_add_u32 s28, s28, s31
  s_lshl_b32 s29, s47, 6
  s_sub_u32 s30, s48, s29
  s_add_u32 s30, s30, s32
  v_add_u32 v6, s28, v5
  v_add_u32 v7, s30, v5
  v_cndmask_b32 v6, v7, v6, vcc
  v_mul_u32_u24 v7, 3456, v2
  v_add_u32 v8, v6, v7
  v_and_b32 v2, 3, v1
  v_xor_b32 v2, 7, v2
  v_lshlrev_b32 v2, 6, v2
  v_lshlrev_b32 v3, 9, v1
  v_add_u32 v2, v2, v3
  v_add_u32 v11, 48, v2
  s_mov_b64 exec, s[40:41]
  s_add_u32 m0, s33, 0
  s_mov_b32 s28, 0
  buffer_load_dwordx4 v8, s[72:75], s28 offen lds
  s_add_u32 m0, s33, 4096
  s_mov_b32 s28, 27648
  buffer_load_dwordx4 v8, s[72:75], s28 offen lds
  s_add_u32 m0, s33, 8192
  s_mov_b32 s28, 55296
  buffer_load_dwordx4 v8, s[72:75], s28 offen lds
  s_add_u32 m0, s33, 12288
  s_mov_b32 s28, 82944
  buffer_load_dwordx4 v8, s[72:75], s28 offen lds
  s_add_u32 m0, s33, 16384
  s_mov_b32 s28, 110592
  buffer_load_dwordx4 v8, s[72:75], s28 offen lds
  s_add_u32 m0, s33, 20480
  s_mov_b32 s28, 138240
  buffer_load_dwordx4 v8, s[72:75], s28 offen lds
  s_add_u32 m0, s33, 24576
  s_mov_b32 s28, 165888
  buffer_load_dwordx4 v8, s[72:75], s28 offen lds
  s_add_u32 m0, s33, 28672
  s_mov_b32 s28, 193536
  buffer_load_dwordx4 v8, s[72:75], s28 offen lds
  s_mov_b64 exec, -1
  s_lshl_b32 s28, s24, 7
  v_lshlrev_b32 v2, 1, v1
  buffer_load_ushort v68, v2, s[4:7], s28 offen
  buffer_load_ushort v69, v2, s[4:7], s28 offen offset:512
  buffer_load_ushort v70, v2, s[4:7], s28 offen offset:1024
  s_mov_b64 exec, s[40:41]
  s_add_u32 m0, s33, 49152
  s_mov_b32 s28, 221184
  buffer_load_dwordx4 v8, s[72:75], s28 offen lds
  s_add_u32 m0, s33, 53248
  s_mov_b32 s28, 248832
  buffer_load_dwordx4 v8, s[72:75], s28 offen lds
  s_add_u32 m0, s33, 57344
  s_mov_b32 s28, 276480
  buffer_load_dwordx4 v8, s[72:75], s28 offen lds
  s_add_u32 m0, s33, 61440
  s_mov_b32 s28, 304128
  buffer_load_dwordx4 v8, s[72:75], s28 offen lds
  s_add_u32 m0, s33, 65536
  s_mov_b32 s28, 331776
  buffer_load_dwordx4 v8, s[72:75], s28 offen lds
  s_add_u32 m0, s33, 69632
  s_mov_b32 s28, 359424
  buffer_load_dwordx4 v8, s[72:75], s28 offen lds
  s_add_u32 m0, s33, 73728
  s_mov_b32 s28, 387072
  buffer_load_dwordx4 v8, s[72:75], s28 offen lds
  s_add_u32 m0, s33, 77824
  s_mov_b32 s28, 414720
  buffer_load_dwordx4 v8, s[72:75], s28 offen lds
  s_mov_b64 exec, -1
  s_waitcnt vmcnt(8)
  s_cmp_eq_u32 s24, 0
  s_cselect_b64 exec, -1, 0
  v_add_u32 v2, 0, v11
  ds_write_b16 v2, v68
  s_mov_b64 exec, -1
  s_cmp_eq_u32 s24, 1
  s_cselect_b64 exec, -1, 0
  v_add_u32 v2, 49152, v11
  ds_write_b16 v2, v68
  s_mov_b64 exec, -1
  s_cmp_eq_u32 s24, 2
  s_cselect_b64 exec, -1, 0
  v_add_u32 v2, 98304, v11
  ds_write_b16 v2, v68
  s_mov_b64 exec, -1
  s_waitcnt lgkmcnt(0)
  s_barrier
  s_mov_b64 exec, s[40:41]
  s_add_u32 m0, s33, 98304
  s_mov_b32 s28, 442368
  buffer_load_dwordx4 v8, s[72:75], s28 offen lds
  s_add_u32 m0, s33, 102400
  s_mov_b32 s28, 470016
  buffer_load_dwordx4 v8, s[72:75], s28 offen lds
  s_add_u32 m0, s33, 106496
  s_mov_b32 s28, 497664
  buffer_load_dwordx4 v8, s[72:75], s28 offen lds
  s_add_u32 m0, s33, 110592
  s_mov_b32 s28, 525312
  buffer_load_dwordx4 v8, s[72:75], s28 offen lds
  s_add_u32 m0, s33, 114688
  s_mov_b32 s28, 552960
  buffer_load_dwordx4 v8, s[72:75], s28 offen lds
  s_add_u32 m0, s33, 118784
  s_mov_b32 s28, 580608
  buffer_load_dwordx4 v8, s[72:75], s28 offen lds
  s_add_u32 m0, s33, 122880
  s_mov_b32 s28, 608256
  buffer_load_dwordx4 v8, s[72:75], s28 offen lds
  s_add_u32 m0, s33, 126976
  s_mov_b32 s28, 635904
  buffer_load_dwordx4 v8, s[72:75], s28 offen lds
  s_mov_b64 exec, -1
  s_add_u32 m0, s33, 131072
  s_mov_b32 s28, 256
  buffer_load_dwordx4 v10, s[8:11], s28 offen lds
  s_add_u32 m0, s33, 135168
  s_mov_b32 s28, 37120
  buffer_load_dwordx4 v10, s[8:11], s28 offen lds
  s_add_u32 m0, s33, 139264
  s_mov_b32 s28, 73984
  buffer_load_dwordx4 v10, s[8:11], s28 offen lds
  s_add_u32 m0, s33, 143360
  s_mov_b32 s28, 110848
  buffer_load_dwordx4 v10, s[8:11], s28 offen lds
  s_waitcnt vmcnt(12) lgkmcnt(0)
  s_barrier
  s_cmp_eq_u32 s24, 3
  s_cselect_b64 exec, -1, 0
  v_add_u32 v2, 0, v11
  ds_write_b16 v2, v68
  s_mov_b64 exec, -1
  s_mov_b64 exec, s[40:41]
  s_add_u32 m0, s33, 0
  s_mov_b32 s28, 663552
  buffer_load_dwordx4 v8, s[72:75], s28 offen lds
  s_add_u32 m0, s33, 4096
  s_mov_b32 s28, 691200
  buffer_load_dwordx4 v8, s[72:75], s28 offen lds
  s_add_u32 m0, s33, 8192
  s_mov_b32 s28, 718848
  buffer_load_dwordx4 v8, s[72:75], s28 offen lds
  s_add_u32 m0, s33, 12288
  s_mov_b32 s28, 746496
  buffer_load_dwordx4 v8, s[72:75], s28 offen lds
  s_add_u32 m0, s33, 16384
  s_mov_b32 s28, 774144
  buffer_load_dwordx4 v8, s[72:75], s28 offen lds
  s_add_u32 m0, s33, 20480
  s_mov_b32 s28, 801792
  buffer_load_dwordx4 v8, s[72:75], s28 offen lds
  s_add_u32 m0, s33, 24576
  s_mov_b32 s28, 829440
  buffer_load_dwordx4 v8, s[72:75], s28 offen lds
  s_add_u32 m0, s33, 28672
  s_mov_b32 s28, 857088
  buffer_load_dwordx4 v8, s[72:75], s28 offen lds
  s_mov_b64 exec, -1
  s_add_u32 m0, s33, 32768
  s_mov_b32 s28, 384
  buffer_load_dwordx4 v10, s[8:11], s28 offen lds
  s_add_u32 m0, s33, 36864
  s_mov_b32 s28, 37248
  buffer_load_dwordx4 v10, s[8:11], s28 offen lds
  s_add_u32 m0, s33, 40960
  s_mov_b32 s28, 74112
  buffer_load_dwordx4 v10, s[8:11], s28 offen lds
  s_add_u32 m0, s33, 45056
  s_mov_b32 s28, 110976
  buffer_load_dwordx4 v10, s[8:11], s28 offen lds
  s_waitcnt vmcnt(12) lgkmcnt(0)
  s_barrier
  s_cmp_eq_u32 s24, 0
  s_cselect_b64 exec, -1, 0
  v_add_u32 v2, 49152, v11
  ds_write_b16 v2, v69
  s_mov_b64 exec, -1
  s_mov_b64 exec, s[40:41]
  s_add_u32 m0, s33, 49152
  s_mov_b32 s28, 884736
  buffer_load_dwordx4 v8, s[72:75], s28 offen lds
  s_add_u32 m0, s33, 53248
  s_mov_b32 s28, 912384
  buffer_load_dwordx4 v8, s[72:75], s28 offen lds
  s_add_u32 m0, s33, 57344
  s_mov_b32 s28, 940032
  buffer_load_dwordx4 v8, s[72:75], s28 offen lds
  s_add_u32 m0, s33, 61440
  s_mov_b32 s28, 967680
  buffer_load_dwordx4 v8, s[72:75], s28 offen lds
  s_add_u32 m0, s33, 65536
  s_mov_b32 s28, 995328
  buffer_load_dwordx4 v8, s[72:75], s28 offen lds
  s_add_u32 m0, s33, 69632
  s_mov_b32 s28, 1022976
  buffer_load_dwordx4 v8, s[72:75], s28 offen lds
  s_add_u32 m0, s33, 73728
  s_mov_b32 s28, 1050624
  buffer_load_dwordx4 v8, s[72:75], s28 offen lds
  s_add_u32 m0, s33, 77824
  s_mov_b32 s28, 1078272
  buffer_load_dwordx4 v8, s[72:75], s28 offen lds
  s_mov_b64 exec, -1
  s_add_u32 m0, s33, 81920
  s_mov_b32 s28, 512
  buffer_load_dwordx4 v10, s[8:11], s28 offen lds
  s_add_u32 m0, s33, 86016
  s_mov_b32 s28, 37376
  buffer_load_dwordx4 v10, s[8:11], s28 offen lds
  s_add_u32 m0, s33, 90112
  s_mov_b32 s28, 74240
  buffer_load_dwordx4 v10, s[8:11], s28 offen lds
  s_add_u32 m0, s33, 94208
  s_mov_b32 s28, 111104
  buffer_load_dwordx4 v10, s[8:11], s28 offen lds
  s_waitcnt vmcnt(12) lgkmcnt(0)
  s_barrier
  s_cmp_eq_u32 s24, 1
  s_cselect_b64 exec, -1, 0
  v_add_u32 v2, 98304, v11
  ds_write_b16 v2, v69
  s_mov_b64 exec, -1
  s_mov_b64 exec, s[40:41]
  s_add_u32 m0, s33, 98304
  s_mov_b32 s28, 1105920
  buffer_load_dwordx4 v8, s[72:75], s28 offen lds
  s_add_u32 m0, s33, 102400
  s_mov_b32 s28, 1133568
  buffer_load_dwordx4 v8, s[72:75], s28 offen lds
  s_add_u32 m0, s33, 106496
  s_mov_b32 s28, 1161216
  buffer_load_dwordx4 v8, s[72:75], s28 offen lds
  s_add_u32 m0, s33, 110592
  s_mov_b32 s28, 1188864
  buffer_load_dwordx4 v8, s[72:75], s28 offen lds
  s_add_u32 m0, s33, 114688
  s_mov_b32 s28, 1216512
  buffer_load_dwordx4 v8, s[72:75], s28 offen lds
  s_add_u32 m0, s33, 118784
  s_mov_b32 s28, 1244160
  buffer_load_dwordx4 v8, s[72:75], s28 offen lds
  s_add_u32 m0, s33, 122880
  s_mov_b32 s28, 1271808
  buffer_load_dwordx4 v8, s[72:75], s28 offen lds
  s_add_u32 m0, s33, 126976
  s_mov_b32 s28, 1299456
  buffer_load_dwordx4 v8, s[72:75], s28 offen lds
  s_mov_b64 exec, -1
  s_add_u32 m0, s33, 131072
  s_mov_b32 s28, 640
  buffer_load_dwordx4 v10, s[8:11], s28 offen lds
  s_add_u32 m0, s33, 135168
  s_mov_b32 s28, 37504
  buffer_load_dwordx4 v10, s[8:11], s28 offen lds
  s_add_u32 m0, s33, 139264
  s_mov_b32 s28, 74368
  buffer_load_dwordx4 v10, s[8:11], s28 offen lds
  s_add_u32 m0, s33, 143360
  s_mov_b32 s28, 111232
  buffer_load_dwordx4 v10, s[8:11], s28 offen lds
  s_waitcnt vmcnt(12) lgkmcnt(0)
  s_barrier
  v_mov_b32 v31, 0
  buffer_load_dword v30, v31, s[92:95], 0 offen sc1
  s_cmp_eq_u32 s24, 2
  s_cselect_b64 exec, -1, 0
  v_add_u32 v2, 0, v11
  ds_write_b16 v2, v69
  s_mov_b64 exec, -1
  s_mov_b64 exec, s[40:41]
  s_add_u32 m0, s33, 0
  s_mov_b32 s28, 1327104
  buffer_load_dwordx4 v8, s[72:75], s28 offen lds
  s_add_u32 m0, s33, 4096
  s_mov_b32 s28, 1354752
  buffer_load_dwordx4 v8, s[72:75], s28 offen lds
  s_add_u32 m0, s33, 8192
  s_mov_b32 s28, 1382400
  buffer_load_dwordx4 v8, s[72:75], s28 offen lds
  s_add_u32 m0, s33, 12288
  s_mov_b32 s28, 1410048
  buffer_load_dwordx4 v8, s[72:75], s28 offen lds
  s_add_u32 m0, s33, 16384
  s_mov_b32 s28, 1437696
  buffer_load_dwordx4 v8, s[72:75], s28 offen lds
  s_add_u32 m0, s33, 20480
  s_mov_b32 s28, 1465344
  buffer_load_dwordx4 v8, s[72:75], s28 offen lds
  s_add_u32 m0, s33, 24576
  s_mov_b32 s28, 1492992
  buffer_load_dwordx4 v8, s[72:75], s28 offen lds
  s_add_u32 m0, s33, 28672
  s_mov_b32 s28, 1520640
  buffer_load_dwordx4 v8, s[72:75], s28 offen lds
  s_mov_b64 exec, -1
  s_add_u32 m0, s33, 32768
  s_mov_b32 s28, 768
  buffer_load_dwordx4 v10, s[8:11], s28 offen lds
  s_add_u32 m0, s33, 36864
  s_mov_b32 s28, 37632
  buffer_load_dwordx4 v10, s[8:11], s28 offen lds
  s_add_u32 m0, s33, 40960
  s_mov_b32 s28, 74496
  buffer_load_dwordx4 v10, s[8:11], s28 offen lds
  s_add_u32 m0, s33, 45056
  s_mov_b32 s28, 111360
  buffer_load_dwordx4 v10, s[8:11], s28 offen lds
  s_waitcnt vmcnt(12) lgkmcnt(0)
  s_barrier
  s_cmp_eq_u32 s24, 3
  s_cselect_b64 exec, -1, 0
  v_add_u32 v2, 49152, v11
  ds_write_b16 v2, v69
  s_mov_b64 exec, -1
  s_mov_b64 exec, s[40:41]
  s_add_u32 m0, s33, 49152
  s_mov_b32 s28, 1548288
  buffer_load_dwordx4 v8, s[72:75], s28 offen lds
  s_add_u32 m0, s33, 53248
  s_mov_b32 s28, 1575936
  buffer_load_dwordx4 v8, s[72:75], s28 offen lds
  s_add_u32 m0, s33, 57344
  s_mov_b32 s28, 1603584
  buffer_load_dwordx4 v8, s[72:75], s28 offen lds
  s_add_u32 m0, s33, 61440
  s_mov_b32 s28, 1631232
  buffer_load_dwordx4 v8, s[72:75], s28 offen lds
  s_add_u32 m0, s33, 65536
  s_mov_b32 s28, 1658880
  buffer_load_dwordx4 v8, s[72:75], s28 offen lds
  s_add_u32 m0, s33, 69632
  s_mov_b32 s28, 1686528
  buffer_load_dwordx4 v8, s[72:75], s28 offen lds
  s_add_u32 m0, s33, 73728
  s_mov_b32 s28, 1714176
  buffer_load_dwordx4 v8, s[72:75], s28 offen lds
  s_add_u32 m0, s33, 77824
  s_mov_b32 s28, 1741824
  buffer_load_dwordx4 v8, s[72:75], s28 offen lds
  s_mov_b64 exec, -1
  s_add_u32 m0, s33, 81920
  s_mov_b32 s28, 896
  buffer_load_dwordx4 v10, s[8:11], s28 offen lds
  s_add_u32 m0, s33, 86016
  s_mov_b32 s28, 37760
  buffer_load_dwordx4 v10, s[8:11], s28 offen lds
  s_add_u32 m0, s33, 90112
  s_mov_b32 s28, 74624
  buffer_load_dwordx4 v10, s[8:11], s28 offen lds
  s_add_u32 m0, s33, 94208
  s_mov_b32 s28, 111488
  buffer_load_dwordx4 v10, s[8:11], s28 offen lds
  s_waitcnt vmcnt(12) lgkmcnt(0)
  s_barrier
  s_cmp_eq_u32 s24, 0
  s_cselect_b64 exec, -1, 0
  v_add_u32 v2, 98304, v11
  ds_write_b16 v2, v70
  s_mov_b64 exec, -1
  s_mov_b64 exec, s[40:41]
  s_add_u32 m0, s33, 98304
  s_mov_b32 s28, 1769472
  buffer_load_dwordx4 v8, s[72:75], s28 offen lds
  s_add_u32 m0, s33, 102400
  s_mov_b32 s28, 1797120
  buffer_load_dwordx4 v8, s[72:75], s28 offen lds
  s_add_u32 m0, s33, 106496
  s_mov_b32 s28, 1824768
  buffer_load_dwordx4 v8, s[72:75], s28 offen lds
  s_add_u32 m0, s33, 110592
  s_mov_b32 s28, 1852416
  buffer_load_dwordx4 v8, s[72:75], s28 offen lds
  s_add_u32 m0, s33, 114688
  s_mov_b32 s28, 1880064
  buffer_load_dwordx4 v8, s[72:75], s28 offen lds
  s_add_u32 m0, s33, 118784
  s_mov_b32 s28, 1907712
  buffer_load_dwordx4 v8, s[72:75], s28 offen lds
  s_add_u32 m0, s33, 122880
  s_mov_b32 s28, 1935360
  buffer_load_dwordx4 v8, s[72:75], s28 offen lds
  s_add_u32 m0, s33, 126976
  s_mov_b32 s28, 1963008
  buffer_load_dwordx4 v8, s[72:75], s28 offen lds
  s_mov_b64 exec, -1
  s_add_u32 m0, s33, 131072
  s_mov_b32 s28, 1024
  buffer_load_dwordx4 v10, s[8:11], s28 offen lds
  s_add_u32 m0, s33, 135168
  s_mov_b32 s28, 37888
  buffer_load_dwordx4 v10, s[8:11], s28 offen lds
  s_add_u32 m0, s33, 139264
  s_mov_b32 s28, 74752
  buffer_load_dwordx4 v10, s[8:11], s28 offen lds
  s_add_u32 m0, s33, 143360
  s_mov_b32 s28, 111616
  buffer_load_dwordx4 v10, s[8:11], s28 offen lds
  s_waitcnt vmcnt(12) lgkmcnt(0)
  s_barrier
  s_waitcnt vmcnt(0) lgkmcnt(0)
  s_barrier
  s_barrier
  s_branch gated_mix__linear_attn_block__mha_block__prompt_kernel_svc2
gated_mix__linear_attn_block__mha_block__prompt_kernel_ld_far:
  s_lshl_b32 s28, s24, 1
  v_add_u32 v2, s28, v22
  v_and_b32 v3, 3, v2
  v_lshrrev_b32 v4, 2, v21
  v_xor_b32 v3, v4, v3
  v_and_b32 v4, 3, v21
  v_lshlrev_b32 v4, 4, v4
  v_lshlrev_b32 v5, 6, v3
  v_add_u32 v5, v5, v4
  v_mov_b32 v6, 496
  v_cmp_ne_u32 s[40:41], v5, v6
  s_andn2_b32 s28, s45, 63
  s_lshl_b32 s29, s47, 6
  s_sub_u32 s30, s48, s29
  v_add_u32 v6, s28, v5
  v_add_u32 v7, s30, v5
  v_cmp_gt_u32 vcc, s47, v3
  s_nop 1
  v_cndmask_b32 v6, v7, v6, vcc
  v_min_u32 v6, 3440, v6
  v_mul_u32_u24 v7, 3456, v2
  v_add_u32 v6, v6, v7
  s_cmp_eq_u32 s44, 0
  s_cselect_b32 s28, s18, s16
  s_cselect_b32 s29, s19, s17
  v_mov_b32 v7, s16
  v_mov_b32 v5, s28
  v_cndmask_b32 v8, v7, v5, vcc
  v_mov_b32 v7, s17
  v_mov_b32 v5, s29
  v_cndmask_b32 v9, v7, v5, vcc
  v_add_co_u32 v8, vcc, v8, v6
  s_nop 1
  v_addc_co_u32 v9, vcc, 0, v9, vcc
  v_and_b32 v2, 3, v1
  v_xor_b32 v2, 7, v2
  v_lshlrev_b32 v2, 6, v2
  v_lshlrev_b32 v3, 9, v1
  v_add_u32 v2, v2, v3
  v_add_u32 v11, 48, v2
  s_mov_b32 s72, 27648
  s_mov_b32 s73, 0
  s_mov_b64 exec, s[40:41]
  s_add_u32 m0, s33, 0
  s_nop 0
  global_load_lds_dwordx4 v[8:9], off
  v_lshl_add_u64 v[8:9], v[8:9], 0, s[72:73]
  s_add_u32 m0, s33, 4096
  s_nop 0
  global_load_lds_dwordx4 v[8:9], off
  v_lshl_add_u64 v[8:9], v[8:9], 0, s[72:73]
  s_add_u32 m0, s33, 8192
  s_nop 0
  global_load_lds_dwordx4 v[8:9], off
  v_lshl_add_u64 v[8:9], v[8:9], 0, s[72:73]
  s_add_u32 m0, s33, 12288
  s_nop 0
  global_load_lds_dwordx4 v[8:9], off
  v_lshl_add_u64 v[8:9], v[8:9], 0, s[72:73]
  s_add_u32 m0, s33, 16384
  s_nop 0
  global_load_lds_dwordx4 v[8:9], off
  v_lshl_add_u64 v[8:9], v[8:9], 0, s[72:73]
  s_add_u32 m0, s33, 20480
  s_nop 0
  global_load_lds_dwordx4 v[8:9], off
  v_lshl_add_u64 v[8:9], v[8:9], 0, s[72:73]
  s_add_u32 m0, s33, 24576
  s_nop 0
  global_load_lds_dwordx4 v[8:9], off
  v_lshl_add_u64 v[8:9], v[8:9], 0, s[72:73]
  s_add_u32 m0, s33, 28672
  s_nop 0
  global_load_lds_dwordx4 v[8:9], off
  v_lshl_add_u64 v[8:9], v[8:9], 0, s[72:73]
  s_mov_b64 exec, -1
  s_lshl_b32 s28, s24, 7
  v_lshlrev_b32 v2, 1, v1
  buffer_load_ushort v68, v2, s[4:7], s28 offen
  buffer_load_ushort v69, v2, s[4:7], s28 offen offset:512
  buffer_load_ushort v70, v2, s[4:7], s28 offen offset:1024
  s_mov_b64 exec, s[40:41]
  s_add_u32 m0, s33, 49152
  s_nop 0
  global_load_lds_dwordx4 v[8:9], off
  v_lshl_add_u64 v[8:9], v[8:9], 0, s[72:73]
  s_add_u32 m0, s33, 53248
  s_nop 0
  global_load_lds_dwordx4 v[8:9], off
  v_lshl_add_u64 v[8:9], v[8:9], 0, s[72:73]
  s_add_u32 m0, s33, 57344
  s_nop 0
  global_load_lds_dwordx4 v[8:9], off
  v_lshl_add_u64 v[8:9], v[8:9], 0, s[72:73]
  s_add_u32 m0, s33, 61440
  s_nop 0
  global_load_lds_dwordx4 v[8:9], off
  v_lshl_add_u64 v[8:9], v[8:9], 0, s[72:73]
  s_add_u32 m0, s33, 65536
  s_nop 0
  global_load_lds_dwordx4 v[8:9], off
  v_lshl_add_u64 v[8:9], v[8:9], 0, s[72:73]
  s_add_u32 m0, s33, 69632
  s_nop 0
  global_load_lds_dwordx4 v[8:9], off
  v_lshl_add_u64 v[8:9], v[8:9], 0, s[72:73]
  s_add_u32 m0, s33, 73728
  s_nop 0
  global_load_lds_dwordx4 v[8:9], off
  v_lshl_add_u64 v[8:9], v[8:9], 0, s[72:73]
  s_add_u32 m0, s33, 77824
  s_nop 0
  global_load_lds_dwordx4 v[8:9], off
  v_lshl_add_u64 v[8:9], v[8:9], 0, s[72:73]
  s_mov_b64 exec, -1
  s_waitcnt vmcnt(8)
  s_cmp_eq_u32 s24, 0
  s_cselect_b64 exec, -1, 0
  v_add_u32 v2, 0, v11
  ds_write_b16 v2, v68
  s_mov_b64 exec, -1
  s_cmp_eq_u32 s24, 1
  s_cselect_b64 exec, -1, 0
  v_add_u32 v2, 49152, v11
  ds_write_b16 v2, v68
  s_mov_b64 exec, -1
  s_cmp_eq_u32 s24, 2
  s_cselect_b64 exec, -1, 0
  v_add_u32 v2, 98304, v11
  ds_write_b16 v2, v68
  s_mov_b64 exec, -1
  s_waitcnt lgkmcnt(0)
  s_barrier
  s_mov_b64 exec, s[40:41]
  s_add_u32 m0, s33, 98304
  s_nop 0
  global_load_lds_dwordx4 v[8:9], off
  v_lshl_add_u64 v[8:9], v[8:9], 0, s[72:73]
  s_add_u32 m0, s33, 102400
  s_nop 0
  global_load_lds_dwordx4 v[8:9], off
  v_lshl_add_u64 v[8:9], v[8:9], 0, s[72:73]
  s_add_u32 m0, s33, 106496
  s_nop 0
  global_load_lds_dwordx4 v[8:9], off
  v_lshl_add_u64 v[8:9], v[8:9], 0, s[72:73]
  s_add_u32 m0, s33, 110592
  s_nop 0
  global_load_lds_dwordx4 v[8:9], off
  v_lshl_add_u64 v[8:9], v[8:9], 0, s[72:73]
  s_add_u32 m0, s33, 114688
  s_nop 0
  global_load_lds_dwordx4 v[8:9], off
  v_lshl_add_u64 v[8:9], v[8:9], 0, s[72:73]
  s_add_u32 m0, s33, 118784
  s_nop 0
  global_load_lds_dwordx4 v[8:9], off
  v_lshl_add_u64 v[8:9], v[8:9], 0, s[72:73]
  s_add_u32 m0, s33, 122880
  s_nop 0
  global_load_lds_dwordx4 v[8:9], off
  v_lshl_add_u64 v[8:9], v[8:9], 0, s[72:73]
  s_add_u32 m0, s33, 126976
  s_nop 0
  global_load_lds_dwordx4 v[8:9], off
  v_lshl_add_u64 v[8:9], v[8:9], 0, s[72:73]
  s_mov_b64 exec, -1
  s_add_u32 m0, s33, 131072
  s_mov_b32 s28, 256
  buffer_load_dwordx4 v10, s[8:11], s28 offen lds
  s_add_u32 m0, s33, 135168
  s_mov_b32 s28, 37120
  buffer_load_dwordx4 v10, s[8:11], s28 offen lds
  s_add_u32 m0, s33, 139264
  s_mov_b32 s28, 73984
  buffer_load_dwordx4 v10, s[8:11], s28 offen lds
  s_add_u32 m0, s33, 143360
  s_mov_b32 s28, 110848
  buffer_load_dwordx4 v10, s[8:11], s28 offen lds
  s_waitcnt vmcnt(12) lgkmcnt(0)
  s_barrier
  s_cmp_eq_u32 s24, 3
  s_cselect_b64 exec, -1, 0
  v_add_u32 v2, 0, v11
  ds_write_b16 v2, v68
  s_mov_b64 exec, -1
  s_mov_b64 exec, s[40:41]
  s_add_u32 m0, s33, 0
  s_nop 0
  global_load_lds_dwordx4 v[8:9], off
  v_lshl_add_u64 v[8:9], v[8:9], 0, s[72:73]
  s_add_u32 m0, s33, 4096
  s_nop 0
  global_load_lds_dwordx4 v[8:9], off
  v_lshl_add_u64 v[8:9], v[8:9], 0, s[72:73]
  s_add_u32 m0, s33, 8192
  s_nop 0
  global_load_lds_dwordx4 v[8:9], off
  v_lshl_add_u64 v[8:9], v[8:9], 0, s[72:73]
  s_add_u32 m0, s33, 12288
  s_nop 0
  global_load_lds_dwordx4 v[8:9], off
  v_lshl_add_u64 v[8:9], v[8:9], 0, s[72:73]
  s_add_u32 m0, s33, 16384
  s_nop 0
  global_load_lds_dwordx4 v[8:9], off
  v_lshl_add_u64 v[8:9], v[8:9], 0, s[72:73]
  s_add_u32 m0, s33, 20480
  s_nop 0
  global_load_lds_dwordx4 v[8:9], off
  v_lshl_add_u64 v[8:9], v[8:9], 0, s[72:73]
  s_add_u32 m0, s33, 24576
  s_nop 0
  global_load_lds_dwordx4 v[8:9], off
  v_lshl_add_u64 v[8:9], v[8:9], 0, s[72:73]
  s_add_u32 m0, s33, 28672
  s_nop 0
  global_load_lds_dwordx4 v[8:9], off
  v_lshl_add_u64 v[8:9], v[8:9], 0, s[72:73]
  s_mov_b64 exec, -1
  s_add_u32 m0, s33, 32768
  s_mov_b32 s28, 384
  buffer_load_dwordx4 v10, s[8:11], s28 offen lds
  s_add_u32 m0, s33, 36864
  s_mov_b32 s28, 37248
  buffer_load_dwordx4 v10, s[8:11], s28 offen lds
  s_add_u32 m0, s33, 40960
  s_mov_b32 s28, 74112
  buffer_load_dwordx4 v10, s[8:11], s28 offen lds
  s_add_u32 m0, s33, 45056
  s_mov_b32 s28, 110976
  buffer_load_dwordx4 v10, s[8:11], s28 offen lds
  s_waitcnt vmcnt(12) lgkmcnt(0)
  s_barrier
  s_cmp_eq_u32 s24, 0
  s_cselect_b64 exec, -1, 0
  v_add_u32 v2, 49152, v11
  ds_write_b16 v2, v69
  s_mov_b64 exec, -1
  s_mov_b64 exec, s[40:41]
  s_add_u32 m0, s33, 49152
  s_nop 0
  global_load_lds_dwordx4 v[8:9], off
  v_lshl_add_u64 v[8:9], v[8:9], 0, s[72:73]
  s_add_u32 m0, s33, 53248
  s_nop 0
  global_load_lds_dwordx4 v[8:9], off
  v_lshl_add_u64 v[8:9], v[8:9], 0, s[72:73]
  s_add_u32 m0, s33, 57344
  s_nop 0
  global_load_lds_dwordx4 v[8:9], off
  v_lshl_add_u64 v[8:9], v[8:9], 0, s[72:73]
  s_add_u32 m0, s33, 61440
  s_nop 0
  global_load_lds_dwordx4 v[8:9], off
  v_lshl_add_u64 v[8:9], v[8:9], 0, s[72:73]
  s_add_u32 m0, s33, 65536
  s_nop 0
  global_load_lds_dwordx4 v[8:9], off
  v_lshl_add_u64 v[8:9], v[8:9], 0, s[72:73]
  s_add_u32 m0, s33, 69632
  s_nop 0
  global_load_lds_dwordx4 v[8:9], off
  v_lshl_add_u64 v[8:9], v[8:9], 0, s[72:73]
  s_add_u32 m0, s33, 73728
  s_nop 0
  global_load_lds_dwordx4 v[8:9], off
  v_lshl_add_u64 v[8:9], v[8:9], 0, s[72:73]
  s_add_u32 m0, s33, 77824
  s_nop 0
  global_load_lds_dwordx4 v[8:9], off
  v_lshl_add_u64 v[8:9], v[8:9], 0, s[72:73]
  s_mov_b64 exec, -1
  s_add_u32 m0, s33, 81920
  s_mov_b32 s28, 512
  buffer_load_dwordx4 v10, s[8:11], s28 offen lds
  s_add_u32 m0, s33, 86016
  s_mov_b32 s28, 37376
  buffer_load_dwordx4 v10, s[8:11], s28 offen lds
  s_add_u32 m0, s33, 90112
  s_mov_b32 s28, 74240
  buffer_load_dwordx4 v10, s[8:11], s28 offen lds
  s_add_u32 m0, s33, 94208
  s_mov_b32 s28, 111104
  buffer_load_dwordx4 v10, s[8:11], s28 offen lds
  s_waitcnt vmcnt(12) lgkmcnt(0)
  s_barrier
  s_cmp_eq_u32 s24, 1
  s_cselect_b64 exec, -1, 0
  v_add_u32 v2, 98304, v11
  ds_write_b16 v2, v69
  s_mov_b64 exec, -1
  s_mov_b64 exec, s[40:41]
  s_add_u32 m0, s33, 98304
  s_nop 0
  global_load_lds_dwordx4 v[8:9], off
  v_lshl_add_u64 v[8:9], v[8:9], 0, s[72:73]
  s_add_u32 m0, s33, 102400
  s_nop 0
  global_load_lds_dwordx4 v[8:9], off
  v_lshl_add_u64 v[8:9], v[8:9], 0, s[72:73]
  s_add_u32 m0, s33, 106496
  s_nop 0
  global_load_lds_dwordx4 v[8:9], off
  v_lshl_add_u64 v[8:9], v[8:9], 0, s[72:73]
  s_add_u32 m0, s33, 110592
  s_nop 0
  global_load_lds_dwordx4 v[8:9], off
  v_lshl_add_u64 v[8:9], v[8:9], 0, s[72:73]
  s_add_u32 m0, s33, 114688
  s_nop 0
  global_load_lds_dwordx4 v[8:9], off
  v_lshl_add_u64 v[8:9], v[8:9], 0, s[72:73]
  s_add_u32 m0, s33, 118784
  s_nop 0
  global_load_lds_dwordx4 v[8:9], off
  v_lshl_add_u64 v[8:9], v[8:9], 0, s[72:73]
  s_add_u32 m0, s33, 122880
  s_nop 0
  global_load_lds_dwordx4 v[8:9], off
  v_lshl_add_u64 v[8:9], v[8:9], 0, s[72:73]
  s_add_u32 m0, s33, 126976
  s_nop 0
  global_load_lds_dwordx4 v[8:9], off
  v_lshl_add_u64 v[8:9], v[8:9], 0, s[72:73]
  s_mov_b64 exec, -1
  s_add_u32 m0, s33, 131072
  s_mov_b32 s28, 640
  buffer_load_dwordx4 v10, s[8:11], s28 offen lds
  s_add_u32 m0, s33, 135168
  s_mov_b32 s28, 37504
  buffer_load_dwordx4 v10, s[8:11], s28 offen lds
  s_add_u32 m0, s33, 139264
  s_mov_b32 s28, 74368
  buffer_load_dwordx4 v10, s[8:11], s28 offen lds
  s_add_u32 m0, s33, 143360
  s_mov_b32 s28, 111232
  buffer_load_dwordx4 v10, s[8:11], s28 offen lds
  s_waitcnt vmcnt(12) lgkmcnt(0)
  s_barrier
  v_mov_b32 v31, 0
  buffer_load_dword v30, v31, s[92:95], 0 offen sc1
  s_cmp_eq_u32 s24, 2
  s_cselect_b64 exec, -1, 0
  v_add_u32 v2, 0, v11
  ds_write_b16 v2, v69
  s_mov_b64 exec, -1
  s_mov_b64 exec, s[40:41]
  s_add_u32 m0, s33, 0
  s_nop 0
  global_load_lds_dwordx4 v[8:9], off
  v_lshl_add_u64 v[8:9], v[8:9], 0, s[72:73]
  s_add_u32 m0, s33, 4096
  s_nop 0
  global_load_lds_dwordx4 v[8:9], off
  v_lshl_add_u64 v[8:9], v[8:9], 0, s[72:73]
  s_add_u32 m0, s33, 8192
  s_nop 0
  global_load_lds_dwordx4 v[8:9], off
  v_lshl_add_u64 v[8:9], v[8:9], 0, s[72:73]
  s_add_u32 m0, s33, 12288
  s_nop 0
  global_load_lds_dwordx4 v[8:9], off
  v_lshl_add_u64 v[8:9], v[8:9], 0, s[72:73]
  s_add_u32 m0, s33, 16384
  s_nop 0
  global_load_lds_dwordx4 v[8:9], off
  v_lshl_add_u64 v[8:9], v[8:9], 0, s[72:73]
  s_add_u32 m0, s33, 20480
  s_nop 0
  global_load_lds_dwordx4 v[8:9], off
  v_lshl_add_u64 v[8:9], v[8:9], 0, s[72:73]
  s_add_u32 m0, s33, 24576
  s_nop 0
  global_load_lds_dwordx4 v[8:9], off
  v_lshl_add_u64 v[8:9], v[8:9], 0, s[72:73]
  s_add_u32 m0, s33, 28672
  s_nop 0
  global_load_lds_dwordx4 v[8:9], off
  v_lshl_add_u64 v[8:9], v[8:9], 0, s[72:73]
  s_mov_b64 exec, -1
  s_add_u32 m0, s33, 32768
  s_mov_b32 s28, 768
  buffer_load_dwordx4 v10, s[8:11], s28 offen lds
  s_add_u32 m0, s33, 36864
  s_mov_b32 s28, 37632
  buffer_load_dwordx4 v10, s[8:11], s28 offen lds
  s_add_u32 m0, s33, 40960
  s_mov_b32 s28, 74496
  buffer_load_dwordx4 v10, s[8:11], s28 offen lds
  s_add_u32 m0, s33, 45056
  s_mov_b32 s28, 111360
  buffer_load_dwordx4 v10, s[8:11], s28 offen lds
  s_waitcnt vmcnt(12) lgkmcnt(0)
  s_barrier
  s_cmp_eq_u32 s24, 3
  s_cselect_b64 exec, -1, 0
  v_add_u32 v2, 49152, v11
  ds_write_b16 v2, v69
  s_mov_b64 exec, -1
  s_mov_b64 exec, s[40:41]
  s_add_u32 m0, s33, 49152
  s_nop 0
  global_load_lds_dwordx4 v[8:9], off
  v_lshl_add_u64 v[8:9], v[8:9], 0, s[72:73]
  s_add_u32 m0, s33, 53248
  s_nop 0
  global_load_lds_dwordx4 v[8:9], off
  v_lshl_add_u64 v[8:9], v[8:9], 0, s[72:73]
  s_add_u32 m0, s33, 57344
  s_nop 0
  global_load_lds_dwordx4 v[8:9], off
  v_lshl_add_u64 v[8:9], v[8:9], 0, s[72:73]
  s_add_u32 m0, s33, 61440
  s_nop 0
  global_load_lds_dwordx4 v[8:9], off
  v_lshl_add_u64 v[8:9], v[8:9], 0, s[72:73]
  s_add_u32 m0, s33, 65536
  s_nop 0
  global_load_lds_dwordx4 v[8:9], off
  v_lshl_add_u64 v[8:9], v[8:9], 0, s[72:73]
  s_add_u32 m0, s33, 69632
  s_nop 0
  global_load_lds_dwordx4 v[8:9], off
  v_lshl_add_u64 v[8:9], v[8:9], 0, s[72:73]
  s_add_u32 m0, s33, 73728
  s_nop 0
  global_load_lds_dwordx4 v[8:9], off
  v_lshl_add_u64 v[8:9], v[8:9], 0, s[72:73]
  s_add_u32 m0, s33, 77824
  s_nop 0
  global_load_lds_dwordx4 v[8:9], off
  v_lshl_add_u64 v[8:9], v[8:9], 0, s[72:73]
  s_mov_b64 exec, -1
  s_add_u32 m0, s33, 81920
  s_mov_b32 s28, 896
  buffer_load_dwordx4 v10, s[8:11], s28 offen lds
  s_add_u32 m0, s33, 86016
  s_mov_b32 s28, 37760
  buffer_load_dwordx4 v10, s[8:11], s28 offen lds
  s_add_u32 m0, s33, 90112
  s_mov_b32 s28, 74624
  buffer_load_dwordx4 v10, s[8:11], s28 offen lds
  s_add_u32 m0, s33, 94208
  s_mov_b32 s28, 111488
  buffer_load_dwordx4 v10, s[8:11], s28 offen lds
  s_waitcnt vmcnt(12) lgkmcnt(0)
  s_barrier
  s_cmp_eq_u32 s24, 0
  s_cselect_b64 exec, -1, 0
  v_add_u32 v2, 98304, v11
  ds_write_b16 v2, v70
  s_mov_b64 exec, -1
  s_mov_b64 exec, s[40:41]
  s_add_u32 m0, s33, 98304
  s_nop 0
  global_load_lds_dwordx4 v[8:9], off
  v_lshl_add_u64 v[8:9], v[8:9], 0, s[72:73]
  s_add_u32 m0, s33, 102400
  s_nop 0
  global_load_lds_dwordx4 v[8:9], off
  v_lshl_add_u64 v[8:9], v[8:9], 0, s[72:73]
  s_add_u32 m0, s33, 106496
  s_nop 0
  global_load_lds_dwordx4 v[8:9], off
  v_lshl_add_u64 v[8:9], v[8:9], 0, s[72:73]
  s_add_u32 m0, s33, 110592
  s_nop 0
  global_load_lds_dwordx4 v[8:9], off
  v_lshl_add_u64 v[8:9], v[8:9], 0, s[72:73]
  s_add_u32 m0, s33, 114688
  s_nop 0
  global_load_lds_dwordx4 v[8:9], off
  v_lshl_add_u64 v[8:9], v[8:9], 0, s[72:73]
  s_add_u32 m0, s33, 118784
  s_nop 0
  global_load_lds_dwordx4 v[8:9], off
  v_lshl_add_u64 v[8:9], v[8:9], 0, s[72:73]
  s_add_u32 m0, s33, 122880
  s_nop 0
  global_load_lds_dwordx4 v[8:9], off
  v_lshl_add_u64 v[8:9], v[8:9], 0, s[72:73]
  s_add_u32 m0, s33, 126976
  s_nop 0
  global_load_lds_dwordx4 v[8:9], off
  v_lshl_add_u64 v[8:9], v[8:9], 0, s[72:73]
  s_mov_b64 exec, -1
  s_add_u32 m0, s33, 131072
  s_mov_b32 s28, 1024
  buffer_load_dwordx4 v10, s[8:11], s28 offen lds
  s_add_u32 m0, s33, 135168
  s_mov_b32 s28, 37888
  buffer_load_dwordx4 v10, s[8:11], s28 offen lds
  s_add_u32 m0, s33, 139264
  s_mov_b32 s28, 74752
  buffer_load_dwordx4 v10, s[8:11], s28 offen lds
  s_add_u32 m0, s33, 143360
  s_mov_b32 s28, 111616
  buffer_load_dwordx4 v10, s[8:11], s28 offen lds
  s_waitcnt vmcnt(12) lgkmcnt(0)
  s_barrier
  s_waitcnt vmcnt(0) lgkmcnt(0)
  s_barrier
  s_barrier
gated_mix__linear_attn_block__mha_block__prompt_kernel_svc2:
  s_mov_b32 s46, s23
  s_mov_b32 s48, s22
  s_and_b32 s26, s2, 7
  s_lshl_b32 s26, s26, 2
  s_lshr_b32 s29, s2, 3
  s_and_b32 s30, s29, 3
  s_add_u32 s26, s26, s30
  s_lshr_b32 s27, s2, 5
  v_and_b32 v1, 63, v0
  v_lshlrev_b32 v9, 4, v1
  v_and_b32 v3, 31, v1
  v_lshrrev_b32 v4, 5, v1
  v_lshlrev_b32 v11, 2, v3
  s_mul_i32 s33, s26, 155648
  s_add_u32 s33, s33, 2359296
  v_readfirstlane_b32 s47, v30
  v_mov_b32 v3, 0
  s_mov_b32 s30, 0
  s_nop 1
  s_cmp_lg_u32 s47, 0
  s_cbranch_scc1 gated_mix__linear_attn_block__mha_block__prompt_kernel_ndone
gated_mix__linear_attn_block__mha_block__prompt_kernel_npoll:
  buffer_load_dword v2, v3, s[92:95], 0 offen sc1
  s_waitcnt vmcnt(0)
  v_readfirstlane_b32 s47, v2
  s_nop 3
  s_cmp_lg_u32 s47, 0
  s_cbranch_scc1 gated_mix__linear_attn_block__mha_block__prompt_kernel_ndone
  s_add_u32 s30, s30, 1
  s_cmp_lt_u32 s30, 0x40000
  s_cbranch_scc0 gated_mix__linear_attn_block__mha_block__prompt_kernel_ndone
  s_sleep 8
  s_branch gated_mix__linear_attn_block__mha_block__prompt_kernel_npoll
gated_mix__linear_attn_block__mha_block__prompt_kernel_ndone:
  s_barrier
  s_barrier
  s_cmp_eq_u32 s24, 1
  s_cbranch_scc1 gated_mix__linear_attn_block__mha_block__prompt_kernel_dopoll
  s_cmp_lg_u32 s24, 0
  s_cbranch_scc1 gated_mix__linear_attn_block__mha_block__prompt_kernel_nopoll
  v_mov_b32 v2, s47
  s_lshl_b32 s29, s46, 4
  s_add_u32 s29, s29, s48
  s_lshl_b32 s29, s29, 7
  s_add_u32 s29, s29, 20213760
  v_lshlrev_b32 v3, 15, v1
  s_mov_b64 exec, 0xff
  buffer_store_dword v2, v3, s[12:15], s29 offen sc1
  s_mov_b64 exec, -1
  s_branch gated_mix__linear_attn_block__mha_block__prompt_kernel_nopoll
gated_mix__linear_attn_block__mha_block__prompt_kernel_dopoll:
  s_add_u32 s29, s26, 0
  s_mul_i32 s29, s29, 5462
  s_lshr_b32 s29, s29, 16
  s_add_u32 s30, s26, 32
  s_mul_i32 s30, s30, 5462
  s_lshr_b32 s30, s30, 16
  s_add_u32 s30, s30, 0
  s_add_u32 s31, s26, 0
  s_mul_i32 s31, s31, 5462
  s_lshr_b32 s31, s31, 16
  s_add_u32 s31, s31, 8
  v_lshrrev_b32 v2, 4, v1
  v_mov_b32 v3, s29
  v_mov_b32 v4, s30
  v_cmp_eq_u32 vcc, 1, v2
  s_nop 1
  v_cndmask_b32 v3, v3, v4, vcc
  v_mov_b32 v4, s31
  v_cmp_le_u32 vcc, 2, v2
  s_nop 1
  v_cndmask_b32 v3, v3, v4, vcc
  v_cmp_le_u32 vcc, 3, v2
  s_nop 1
  v_cndmask_b32 v3, v3, v3, vcc
  v_lshlrev_b32 v3, 11, v3
  v_and_b32 v4, 15, v1
  v_lshlrev_b32 v4, 7, v4
  v_add_u32 v3, v3, v4
  s_and_b32 s29, s2, 7
  s_lshl_b32 s29, s29, 15
  s_add_u32 s29, s29, 20213760
  s_mov_b32 s32, 0
gated_mix__linear_attn_block__mha_block__prompt_kernel_wfb:
  buffer_load_dword v164, v3, s[12:15], s29 offen sc1
  s_waitcnt vmcnt(0)
  v_cmp_ne_u32 vcc, s47, v164
  s_nop 3
  s_cmp_eq_u64 vcc, 0
  s_cbranch_scc1 gated_mix__linear_attn_block__mha_block__prompt_kernel_wfb_ok
  s_add_u32 s32, s32, 1
  s_cmp_lt_u32 s32, 0x40000
  s_cbranch_scc0 gated_mix__linear_attn_block__mha_block__prompt_kernel_wfb_ok
  s_sleep 2
  s_branch gated_mix__linear_attn_block__mha_block__prompt_kernel_wfb
gated_mix__linear_attn_block__mha_block__prompt_kernel_wfb_ok:
gated_mix__linear_attn_block__mha_block__prompt_kernel_nopoll:
  s_barrier
  v_and_b32 v3, 31, v1
  v_lshrrev_b32 v4, 5, v1
  v_lshlrev_b32 v2, 4, v3
  v_mul_u32_u24 v6, 320, v4
  v_add_u32 v6, v6, v2
  v_cmp_gt_u32 vcc, 19, v3
  v_mov_b32 v2, 2130706432
  s_nop 0
  v_cndmask_b32 v6, v2, v6, vcc
  v_cmp_gt_u32 vcc, 32, v1
  s_nop 1
  v_cndmask_b32 v10, v2, v11, vcc
  s_mul_i32 s45, s26, 81920
  s_mul_i32 s29, s24, 20480
  s_add_u32 s45, s45, s29
  v_mov_b32 v2, 155904
  v_mov_b32 v4, 0
  ds_write_b32 v2, v4
  s_lshl_b32 s29, s26, 13
  s_lshl_b32 s30, s24, 11
  s_add_u32 s29, s29, s30
  s_add_u32 s30, s29, 19949568
  s_add_u32 s29, s29, 19687424
  buffer_load_dwordx4 v[12:15], v9, s[12:15], s29 offen sc1
  buffer_load_dwordx4 v[16:19], v9, s[12:15], s29 offen offset:1024 sc1
  buffer_load_dwordx4 v[20:23], v9, s[12:15], s30 offen sc1
  buffer_load_dwordx4 v[24:27], v9, s[12:15], s30 offen offset:1024 sc1
  s_lshl_b32 s29, s24, 10
  s_add_u32 s29, s29, 0
  s_mov_b32 m0, s29
  s_add_u32 s29, s29, s33
  buffer_load_dwordx4 v9, s[12:15], s29 offen sc1 lds
  s_lshl_b32 s29, s24, 10
  s_add_u32 s29, s29, 4096
  s_mov_b32 m0, s29
  s_add_u32 s29, s29, s33
  buffer_load_dwordx4 v9, s[12:15], s29 offen sc1 lds
  s_lshl_b32 s29, s24, 10
  s_add_u32 s29, s29, 8192
  s_mov_b32 m0, s29
  s_add_u32 s29, s29, s33
  buffer_load_dwordx4 v9, s[12:15], s29 offen sc1 lds
  s_lshl_b32 s29, s24, 10
  s_add_u32 s29, s29, 12288
  s_mov_b32 m0, s29
  s_add_u32 s29, s29, s33
  buffer_load_dwordx4 v9, s[12:15], s29 offen sc1 lds
  s_lshl_b32 s29, s24, 10
  s_cmp_ge_u32 s24, 3
  s_cselect_b32 s30, 58368, 0
  s_add_u32 s29, s29, s30
  s_add_u32 s29, s29, 16384
  s_mov_b32 m0, s29
  s_add_u32 s29, s29, s33
  buffer_load_dwordx4 v9, s[12:15], s29 offen sc1 lds
  s_lshl_b32 s29, s24, 10
  s_add_u32 s29, s29, 78848
  s_mov_b32 m0, s29
  s_add_u32 s29, s29, s33
  buffer_load_dwordx4 v9, s[12:15], s29 offen sc1 lds
  s_lshl_b32 s29, s24, 10
  s_add_u32 s29, s29, 82944
  s_mov_b32 m0, s29
  s_add_u32 s29, s29, s33
  buffer_load_dwordx4 v9, s[12:15], s29 offen sc1 lds
  s_lshl_b32 s29, s24, 10
  s_add_u32 s29, s29, 87040
  s_mov_b32 m0, s29
  s_add_u32 s29, s29, s33
  buffer_load_dwordx4 v9, s[12:15], s29 offen sc1 lds
  s_lshl_b32 s29, s24, 10
  s_add_u32 s29, s29, 91136
  s_mov_b32 m0, s29
  s_add_u32 s29, s29, s33
  buffer_load_dwordx4 v9, s[12:15], s29 offen sc1 lds
  s_cmp_ge_u32 s24, 2
  s_cbranch_scc1 kd_19
  s_lshl_b32 s29, s24, 10
  s_add_u32 s29, s29, 95232
  s_mov_b32 m0, s29
  s_add_u32 s29, s29, s33
  buffer_load_dwordx4 v9, s[12:15], s29 offen sc1 lds
kd_19:
  s_waitcnt vmcnt(9)
  v_max_u32 v12, v12, v13
  v_max_u32 v20, v20, v21
  v_max3_u32 v12, v12, v14, v15
  v_max3_u32 v20, v20, v22, v23
  v_max3_u32 v12, v12, v16, v17
  v_max3_u32 v20, v20, v24, v25
  v_max3_u32 v12, v12, v18, v19
  v_max3_u32 v20, v20, v26, v27
  s_nop 1
  v_max_u32_dpp v12, v12, v12 row_ror:1 row_mask:0xf bank_mask:0xf
  v_max_u32_dpp v20, v20, v20 row_ror:1 row_mask:0xf bank_mask:0xf
  s_nop 0
  v_max_u32_dpp v12, v12, v12 row_ror:2 row_mask:0xf bank_mask:0xf
  v_max_u32_dpp v20, v20, v20 row_ror:2 row_mask:0xf bank_mask:0xf
  s_nop 0
  v_max_u32_dpp v12, v12, v12 row_ror:4 row_mask:0xf bank_mask:0xf
  v_max_u32_dpp v20, v20, v20 row_ror:4 row_mask:0xf bank_mask:0xf
  s_nop 0
  v_max_u32_dpp v12, v12, v12 row_ror:8 row_mask:0xf bank_mask:0xf
  v_max_u32_dpp v20, v20, v20 row_ror:8 row_mask:0xf bank_mask:0xf
  s_nop 0
  v_lshrrev_b32 v2, 4, v1
  s_lshl_b32 s29, s24, 2
  v_add_u32 v2, s29, v2
  v_lshlrev_b32 v2, 3, v2
  v_add_u32 v2, 155712, v2
  v_mov_b32 v13, v20
  ds_write_b64 v2, v[12:13]
  s_waitcnt vmcnt(0) lgkmcnt(0)
  s_barrier
  s_cmp_lt_u32 s24, 2
  s_cbranch_scc1 k23_20
  s_and_b32 s29, s24, 1
  s_lshl_b32 s29, s29, 10
  s_add_u32 s29, s29, 19456
  s_mov_b32 m0, s29
  s_add_u32 s29, s29, s33
  buffer_load_dwordx4 v9, s[12:15], s29 offen sc1 lds
  s_and_b32 s29, s24, 1
  s_lshl_b32 s29, s29, 10
  s_add_u32 s29, s29, 21504
  s_mov_b32 m0, s29
  s_add_u32 s29, s29, s33
  buffer_load_dwordx4 v9, s[12:15], s29 offen sc1 lds
  s_and_b32 s29, s24, 1
  s_lshl_b32 s29, s29, 10
  s_add_u32 s29, s29, 23552
  s_mov_b32 m0, s29
  s_add_u32 s29, s29, s33
  buffer_load_dwordx4 v9, s[12:15], s29 offen sc1 lds
  s_and_b32 s29, s24, 1
  s_lshl_b32 s29, s29, 10
  s_add_u32 s29, s29, 25600
  s_mov_b32 m0, s29
  s_add_u32 s29, s29, s33
  buffer_load_dwordx4 v9, s[12:15], s29 offen sc1 lds
  s_and_b32 s29, s24, 1
  s_lshl_b32 s29, s29, 10
  s_add_u32 s29, s29, 27648
  s_mov_b32 m0, s29
  s_add_u32 s29, s29, s33
  buffer_load_dwordx4 v9, s[12:15], s29 offen sc1 lds
  s_and_b32 s29, s24, 1
  s_lshl_b32 s29, s29, 10
  s_add_u32 s29, s29, 29696
  s_mov_b32 m0, s29
  s_add_u32 s29, s29, s33
  buffer_load_dwordx4 v9, s[12:15], s29 offen sc1 lds
  s_and_b32 s29, s24, 1
  s_lshl_b32 s29, s29, 10
  s_add_u32 s29, s29, 31744
  s_mov_b32 m0, s29
  s_add_u32 s29, s29, s33
  buffer_load_dwordx4 v9, s[12:15], s29 offen sc1 lds
  s_and_b32 s29, s24, 1
  s_lshl_b32 s29, s29, 10
  s_add_u32 s29, s29, 33792
  s_mov_b32 m0, s29
  s_add_u32 s29, s29, s33
  buffer_load_dwordx4 v9, s[12:15], s29 offen sc1 lds
  s_and_b32 s29, s24, 1
  s_lshl_b32 s29, s29, 10
  s_add_u32 s29, s29, 35840
  s_mov_b32 m0, s29
  s_add_u32 s29, s29, s33
  buffer_load_dwordx4 v9, s[12:15], s29 offen sc1 lds
  s_and_b32 s29, s24, 1
  s_lshl_b32 s29, s29, 10
  s_cmp_eq_u32 s24, 3
  s_cselect_b32 s30, 58368, 0
  s_add_u32 s29, s29, s30
  s_add_u32 s29, s29, 37888
  s_mov_b32 m0, s29
  s_add_u32 s29, s29, s33
  buffer_load_dwordx4 v9, s[12:15], s29 offen sc1 lds
  s_and_b32 s29, s24, 1
  s_lshl_b32 s29, s29, 10
  s_add_u32 s29, s29, 98304
  s_mov_b32 m0, s29
  s_add_u32 s29, s29, s33
  buffer_load_dwordx4 v9, s[12:15], s29 offen sc1 lds
  s_and_b32 s29, s24, 1
  s_lshl_b32 s29, s29, 10
  s_add_u32 s29, s29, 100352
  s_mov_b32 m0, s29
  s_add_u32 s29, s29, s33
  buffer_load_dwordx4 v9, s[12:15], s29 offen sc1 lds
  s_and_b32 s29, s24, 1
  s_lshl_b32 s29, s29, 10
  s_add_u32 s29, s29, 102400
  s_mov_b32 m0, s29
  s_add_u32 s29, s29, s33
  buffer_load_dwordx4 v9, s[12:15], s29 offen sc1 lds
  s_and_b32 s29, s24, 1
  s_lshl_b32 s29, s29, 10
  s_add_u32 s29, s29, 104448
  s_mov_b32 m0, s29
  s_add_u32 s29, s29, s33
  buffer_load_dwordx4 v9, s[12:15], s29 offen sc1 lds
  s_and_b32 s29, s24, 1
  s_lshl_b32 s29, s29, 10
  s_add_u32 s29, s29, 106496
  s_mov_b32 m0, s29
  s_add_u32 s29, s29, s33
  buffer_load_dwordx4 v9, s[12:15], s29 offen sc1 lds
  s_and_b32 s29, s24, 1
  s_lshl_b32 s29, s29, 10
  s_add_u32 s29, s29, 108544
  s_mov_b32 m0, s29
  s_add_u32 s29, s29, s33
  buffer_load_dwordx4 v9, s[12:15], s29 offen sc1 lds
  s_and_b32 s29, s24, 1
  s_lshl_b32 s29, s29, 10
  s_add_u32 s29, s29, 110592
  s_mov_b32 m0, s29
  s_add_u32 s29, s29, s33
  buffer_load_dwordx4 v9, s[12:15], s29 offen sc1 lds
  s_and_b32 s29, s24, 1
  s_lshl_b32 s29, s29, 10
  s_add_u32 s29, s29, 112640
  s_mov_b32 m0, s29
  s_add_u32 s29, s29, s33
  buffer_load_dwordx4 v9, s[12:15], s29 offen sc1 lds
  s_and_b32 s29, s24, 1
  s_lshl_b32 s29, s29, 10
  s_add_u32 s29, s29, 114688
  s_mov_b32 m0, s29
  s_add_u32 s29, s29, s33
  buffer_load_dwordx4 v9, s[12:15], s29 offen sc1 lds
  s_and_b32 s29, s24, 1
  s_lshl_b32 s29, s29, 10
  s_add_u32 s29, s29, 38912
  s_mov_b32 m0, s29
  s_add_u32 s29, s29, s33
  buffer_load_dwordx4 v9, s[12:15], s29 offen sc1 lds
  s_and_b32 s29, s24, 1
  s_lshl_b32 s29, s29, 10
  s_add_u32 s29, s29, 40960
  s_mov_b32 m0, s29
  s_add_u32 s29, s29, s33
  buffer_load_dwordx4 v9, s[12:15], s29 offen sc1 lds
  s_and_b32 s29, s24, 1
  s_lshl_b32 s29, s29, 10
  s_add_u32 s29, s29, 43008
  s_mov_b32 m0, s29
  s_add_u32 s29, s29, s33
  buffer_load_dwordx4 v9, s[12:15], s29 offen sc1 lds
  s_and_b32 s29, s24, 1
  s_lshl_b32 s29, s29, 10
  s_add_u32 s29, s29, 45056
  s_mov_b32 m0, s29
  s_add_u32 s29, s29, s33
  buffer_load_dwordx4 v9, s[12:15], s29 offen sc1 lds
  s_and_b32 s29, s24, 1
  s_lshl_b32 s29, s29, 10
  s_add_u32 s29, s29, 47104
  s_mov_b32 m0, s29
  s_add_u32 s29, s29, s33
  buffer_load_dwordx4 v9, s[12:15], s29 offen sc1 lds
  s_and_b32 s29, s24, 1
  s_lshl_b32 s29, s29, 10
  s_add_u32 s29, s29, 49152
  s_mov_b32 m0, s29
  s_add_u32 s29, s29, s33
  buffer_load_dwordx4 v9, s[12:15], s29 offen sc1 lds
  s_and_b32 s29, s24, 1
  s_lshl_b32 s29, s29, 10
  s_add_u32 s29, s29, 51200
  s_mov_b32 m0, s29
  s_add_u32 s29, s29, s33
  buffer_load_dwordx4 v9, s[12:15], s29 offen sc1 lds
  s_and_b32 s29, s24, 1
  s_lshl_b32 s29, s29, 10
  s_add_u32 s29, s29, 53248
  s_mov_b32 m0, s29
  s_add_u32 s29, s29, s33
  buffer_load_dwordx4 v9, s[12:15], s29 offen sc1 lds
  s_and_b32 s29, s24, 1
  s_lshl_b32 s29, s29, 10
  s_add_u32 s29, s29, 55296
  s_mov_b32 m0, s29
  s_add_u32 s29, s29, s33
  buffer_load_dwordx4 v9, s[12:15], s29 offen sc1 lds
  s_and_b32 s29, s24, 1
  s_lshl_b32 s29, s29, 10
  s_cmp_eq_u32 s24, 3
  s_cselect_b32 s30, 58368, 0
  s_add_u32 s29, s29, s30
  s_add_u32 s29, s29, 57344
  s_mov_b32 m0, s29
  s_add_u32 s29, s29, s33
  buffer_load_dwordx4 v9, s[12:15], s29 offen sc1 lds
  s_and_b32 s29, s24, 1
  s_lshl_b32 s29, s29, 10
  s_add_u32 s29, s29, 117760
  s_mov_b32 m0, s29
  s_add_u32 s29, s29, s33
  buffer_load_dwordx4 v9, s[12:15], s29 offen sc1 lds
  s_and_b32 s29, s24, 1
  s_lshl_b32 s29, s29, 10
  s_add_u32 s29, s29, 119808
  s_mov_b32 m0, s29
  s_add_u32 s29, s29, s33
  buffer_load_dwordx4 v9, s[12:15], s29 offen sc1 lds
  s_and_b32 s29, s24, 1
  s_lshl_b32 s29, s29, 10
  s_add_u32 s29, s29, 121856
  s_mov_b32 m0, s29
  s_add_u32 s29, s29, s33
  buffer_load_dwordx4 v9, s[12:15], s29 offen sc1 lds
  s_and_b32 s29, s24, 1
  s_lshl_b32 s29, s29, 10
  s_add_u32 s29, s29, 123904
  s_mov_b32 m0, s29
  s_add_u32 s29, s29, s33
  buffer_load_dwordx4 v9, s[12:15], s29 offen sc1 lds
  s_and_b32 s29, s24, 1
  s_lshl_b32 s29, s29, 10
  s_add_u32 s29, s29, 125952
  s_mov_b32 m0, s29
  s_add_u32 s29, s29, s33
  buffer_load_dwordx4 v9, s[12:15], s29 offen sc1 lds
  s_and_b32 s29, s24, 1
  s_lshl_b32 s29, s29, 10
  s_add_u32 s29, s29, 128000
  s_mov_b32 m0, s29
  s_add_u32 s29, s29, s33
  buffer_load_dwordx4 v9, s[12:15], s29 offen sc1 lds
  s_and_b32 s29, s24, 1
  s_lshl_b32 s29, s29, 10
  s_add_u32 s29, s29, 130048
  s_mov_b32 m0, s29
  s_add_u32 s29, s29, s33
  buffer_load_dwordx4 v9, s[12:15], s29 offen sc1 lds
  s_and_b32 s29, s24, 1
  s_lshl_b32 s29, s29, 10
  s_add_u32 s29, s29, 132096
  s_mov_b32 m0, s29
  s_add_u32 s29, s29, s33
  buffer_load_dwordx4 v9, s[12:15], s29 offen sc1 lds
  s_and_b32 s29, s24, 1
  s_lshl_b32 s29, s29, 10
  s_add_u32 s29, s29, 134144
  s_mov_b32 m0, s29
  s_add_u32 s29, s29, s33
  buffer_load_dwordx4 v9, s[12:15], s29 offen sc1 lds
  s_and_b32 s29, s24, 1
  s_lshl_b32 s29, s29, 10
  s_add_u32 s29, s29, 58368
  s_mov_b32 m0, s29
  s_add_u32 s29, s29, s33
  buffer_load_dwordx4 v9, s[12:15], s29 offen sc1 lds
  s_and_b32 s29, s24, 1
  s_lshl_b32 s29, s29, 10
  s_add_u32 s29, s29, 60416
  s_mov_b32 m0, s29
  s_add_u32 s29, s29, s33
  buffer_load_dwordx4 v9, s[12:15], s29 offen sc1 lds
  s_and_b32 s29, s24, 1
  s_lshl_b32 s29, s29, 10
  s_add_u32 s29, s29, 62464
  s_mov_b32 m0, s29
  s_add_u32 s29, s29, s33
  buffer_load_dwordx4 v9, s[12:15], s29 offen sc1 lds
  s_and_b32 s29, s24, 1
  s_lshl_b32 s29, s29, 10
  s_add_u32 s29, s29, 64512
  s_mov_b32 m0, s29
  s_add_u32 s29, s29, s33
  buffer_load_dwordx4 v9, s[12:15], s29 offen sc1 lds
  s_and_b32 s29, s24, 1
  s_lshl_b32 s29, s29, 10
  s_add_u32 s29, s29, 66560
  s_mov_b32 m0, s29
  s_add_u32 s29, s29, s33
  buffer_load_dwordx4 v9, s[12:15], s29 offen sc1 lds
  s_and_b32 s29, s24, 1
  s_lshl_b32 s29, s29, 10
  s_add_u32 s29, s29, 68608
  s_mov_b32 m0, s29
  s_add_u32 s29, s29, s33
  buffer_load_dwordx4 v9, s[12:15], s29 offen sc1 lds
  s_and_b32 s29, s24, 1
  s_lshl_b32 s29, s29, 10
  s_add_u32 s29, s29, 70656
  s_mov_b32 m0, s29
  s_add_u32 s29, s29, s33
  buffer_load_dwordx4 v9, s[12:15], s29 offen sc1 lds
  s_and_b32 s29, s24, 1
  s_lshl_b32 s29, s29, 10
  s_add_u32 s29, s29, 72704
  s_mov_b32 m0, s29
  s_add_u32 s29, s29, s33
  buffer_load_dwordx4 v9, s[12:15], s29 offen sc1 lds
  s_and_b32 s29, s24, 1
  s_lshl_b32 s29, s29, 10
  s_add_u32 s29, s29, 74752
  s_mov_b32 m0, s29
  s_add_u32 s29, s29, s33
  buffer_load_dwordx4 v9, s[12:15], s29 offen sc1 lds
  s_and_b32 s29, s24, 1
  s_lshl_b32 s29, s29, 10
  s_cmp_eq_u32 s24, 3
  s_cselect_b32 s30, 58368, 0
  s_add_u32 s29, s29, s30
  s_add_u32 s29, s29, 76800
  s_mov_b32 m0, s29
  s_add_u32 s29, s29, s33
  buffer_load_dwordx4 v9, s[12:15], s29 offen sc1 lds
  s_and_b32 s29, s24, 1
  s_lshl_b32 s29, s29, 10
  s_add_u32 s29, s29, 137216
  s_mov_b32 m0, s29
  s_add_u32 s29, s29, s33
  buffer_load_dwordx4 v9, s[12:15], s29 offen sc1 lds
  s_and_b32 s29, s24, 1
  s_lshl_b32 s29, s29, 10
  s_add_u32 s29, s29, 139264
  s_mov_b32 m0, s29
  s_add_u32 s29, s29, s33
  buffer_load_dwordx4 v9, s[12:15], s29 offen sc1 lds
  s_and_b32 s29, s24, 1
  s_lshl_b32 s29, s29, 10
  s_add_u32 s29, s29, 141312
  s_mov_b32 m0, s29
  s_add_u32 s29, s29, s33
  buffer_load_dwordx4 v9, s[12:15], s29 offen sc1 lds
  s_and_b32 s29, s24, 1
  s_lshl_b32 s29, s29, 10
  s_add_u32 s29, s29, 143360
  s_mov_b32 m0, s29
  s_add_u32 s29, s29, s33
  buffer_load_dwordx4 v9, s[12:15], s29 offen sc1 lds
  s_and_b32 s29, s24, 1
  s_lshl_b32 s29, s29, 10
  s_add_u32 s29, s29, 145408
  s_mov_b32 m0, s29
  s_add_u32 s29, s29, s33
  buffer_load_dwordx4 v9, s[12:15], s29 offen sc1 lds
  s_and_b32 s29, s24, 1
  s_lshl_b32 s29, s29, 10
  s_add_u32 s29, s29, 147456
  s_mov_b32 m0, s29
  s_add_u32 s29, s29, s33
  buffer_load_dwordx4 v9, s[12:15], s29 offen sc1 lds
  s_and_b32 s29, s24, 1
  s_lshl_b32 s29, s29, 10
  s_add_u32 s29, s29, 149504
  s_mov_b32 m0, s29
  s_add_u32 s29, s29, s33
  buffer_load_dwordx4 v9, s[12:15], s29 offen sc1 lds
  s_and_b32 s29, s24, 1
  s_lshl_b32 s29, s29, 10
  s_add_u32 s29, s29, 151552
  s_mov_b32 m0, s29
  s_add_u32 s29, s29, s33
  buffer_load_dwordx4 v9, s[12:15], s29 offen sc1 lds
  s_and_b32 s29, s24, 1
  s_lshl_b32 s29, s29, 10
  s_add_u32 s29, s29, 153600
  s_mov_b32 m0, s29
  s_add_u32 s29, s29, s33
  buffer_load_dwordx4 v9, s[12:15], s29 offen sc1 lds
  s_waitcnt vmcnt(0)
  v_mov_b32 v2, 155904
  v_mov_b32 v3, 2
  s_mov_b64 exec, 1
  ds_add_u32 v2, v3
  s_mov_b64 exec, -1
k23_20:
  v_and_b32 v3, 31, v1
  v_lshrrev_b32 v4, 5, v1
  v_mul_u32_u24 v4, 20, v4
  v_add_u32 v4, v4, v3
  v_mul_u32_u24 v8, 48, v4
  v_add_u32 v7, 156160, v8
  v_cmp_gt_u32 vcc, 20, v3
  v_mov_b32 v2, 0x10000000
  v_mov_b32 v4, 2130706432
  v_cndmask_b32 v7, v2, v7, vcc
  v_cndmask_b32 v8, v4, v8, vcc
  s_cmp_gt_u32 s24, 1
  s_cbranch_scc1 k01_21
  s_add_u32 s29, s26, 64
  s_mul_i32 s29, s29, 5462
  s_lshr_b32 s29, s29, 16
  s_add_u32 s30, s26, 32
  s_mul_i32 s30, s30, 5462
  s_lshr_b32 s30, s30, 16
  s_add_u32 s30, s30, 8
  s_add_u32 s31, s26, 64
  s_mul_i32 s31, s31, 5462
  s_lshr_b32 s31, s31, 16
  s_add_u32 s31, s31, 8
  v_lshrrev_b32 v2, 4, v1
  v_mov_b32 v3, s29
  v_mov_b32 v4, s30
  v_cmp_eq_u32 vcc, 1, v2
  s_nop 1
  v_cndmask_b32 v3, v3, v4, vcc
  v_mov_b32 v4, s31
  v_cmp_le_u32 vcc, 2, v2
  s_nop 1
  v_cndmask_b32 v3, v3, v4, vcc
  v_cmp_le_u32 vcc, 3, v2
  s_nop 1
  v_cndmask_b32 v3, v3, 0, vcc
  v_lshlrev_b32 v3, 11, v3
  s_lshl_b32 s29, s27, 1
  v_and_b32 v4, 1, v1
  v_add_u32 v4, s29, v4
  v_lshlrev_b32 v4, 7, v4
  v_add_u32 v3, v3, v4
  s_and_b32 s29, s2, 7
  s_lshl_b32 s29, s29, 15
  s_add_u32 s29, s29, 20213760
  s_mov_b32 s32, 0
gated_mix__linear_attn_block__mha_block__prompt_kernel_wfa:
  buffer_load_dword v164, v3, s[12:15], s29 offen sc1
  s_waitcnt vmcnt(0)
  v_cmp_ne_u32 vcc, s47, v164
  s_nop 3
  s_cmp_eq_u64 vcc, 0
  s_cbranch_scc1 gated_mix__linear_attn_block__mha_block__prompt_kernel_wfa_ok
  s_add_u32 s32, s32, 1
  s_cmp_lt_u32 s32, 0x40000
  s_cbranch_scc0 gated_mix__linear_attn_block__mha_block__prompt_kernel_wfa_ok
  s_sleep 2
  s_branch gated_mix__linear_attn_block__mha_block__prompt_kernel_wfa
gated_mix__linear_attn_block__mha_block__prompt_kernel_wfa_ok:
  s_mul_i32 s45, s26, 81920
  s_lshl_b32 s29, s27, 4
  s_lshl_b32 s30, s24, 3
  s_add_u32 s29, s29, s30
  s_mul_i32 s29, s29, 640
  s_add_u32 s45, s45, s29
  s_add_u32 s29, s45, 9699328
  buffer_load_dwordx4 v[100:103], v6, s[12:15], s29 offen sc1
  s_add_u32 s29, s45, 12321792
  buffer_load_dwordx4 v[104:107], v6, s[12:15], s29 offen sc1
  s_add_u32 s29, s45, 9699968
  buffer_load_dwordx4 v[108:111], v6, s[12:15], s29 offen sc1
  s_add_u32 s29, s45, 12322432
  buffer_load_dwordx4 v[112:115], v6, s[12:15], s29 offen sc1
  s_add_u32 s29, s45, 9700608
  buffer_load_dwordx4 v[116:119], v6, s[12:15], s29 offen sc1
  s_add_u32 s29, s45, 12323072
  buffer_load_dwordx4 v[120:123], v6, s[12:15], s29 offen sc1
  s_add_u32 s29, s45, 9701248
  buffer_load_dwordx4 v[124:127], v6, s[12:15], s29 offen sc1
  s_add_u32 s29, s45, 12323712
  buffer_load_dwordx4 v[128:131], v6, s[12:15], s29 offen sc1
  s_add_u32 s29, s45, 9701888
  buffer_load_dwordx4 v[132:135], v6, s[12:15], s29 offen sc1
  s_add_u32 s29, s45, 12324352
  buffer_load_dwordx4 v[136:139], v6, s[12:15], s29 offen sc1
  s_add_u32 s29, s45, 9702528
  buffer_load_dwordx4 v[140:143], v6, s[12:15], s29 offen sc1
  s_add_u32 s29, s45, 12324992
  buffer_load_dwordx4 v[144:147], v6, s[12:15], s29 offen sc1
  s_add_u32 s29, s45, 9703168
  buffer_load_dwordx4 v[148:151], v6, s[12:15], s29 offen sc1
  s_add_u32 s29, s45, 12325632
  buffer_load_dwordx4 v[152:155], v6, s[12:15], s29 offen sc1
  s_add_u32 s29, s45, 9703808
  buffer_load_dwordx4 v[156:159], v6, s[12:15], s29 offen sc1
  s_add_u32 s29, s45, 12326272
  buffer_load_dwordx4 v[160:163], v6, s[12:15], s29 offen sc1
  s_waitcnt vmcnt(8)
  v_mfma_f32_32x32x16_bf16 v[68:83], v[100:103], v[104:107], 0
  v_mfma_f32_32x32x16_bf16 v[68:83], v[108:111], v[112:115], v[68:83]
  v_mfma_f32_32x32x16_bf16 v[68:83], v[116:119], v[120:123], v[68:83]
  v_mfma_f32_32x32x16_bf16 v[68:83], v[124:127], v[128:131], v[68:83]
  s_waitcnt vmcnt(0)
  v_mfma_f32_32x32x16_bf16 v[68:83], v[132:135], v[136:139], v[68:83]
  v_mfma_f32_32x32x16_bf16 v[68:83], v[140:143], v[144:147], v[68:83]
  v_mfma_f32_32x32x16_bf16 v[68:83], v[148:151], v[152:155], v[68:83]
  v_mfma_f32_32x32x16_bf16 v[68:83], v[156:159], v[160:163], v[68:83]
  s_mul_i32 s29, s24, 1920
  v_add_u32 v2, s29, v7
  s_nop 15
  s_nop 1
  ds_write_b128 v2, v[68:71] offset:0
  ds_write_b128 v2, v[72:75] offset:16
  ds_write_b128 v2, v[76:79] offset:32
  s_waitcnt lgkmcnt(0)
k01_21:
  s_barrier
  s_cmp_gt_u32 s24, 1
  s_cbranch_scc1 k01_22
  ds_read_b128 v[100:103], v7 offset:0
  ds_read_b128 v[104:107], v7 offset:1920
  ds_read_b128 v[108:111], v7 offset:16
  ds_read_b128 v[112:115], v7 offset:1936
  ds_read_b128 v[116:119], v7 offset:32
  ds_read_b128 v[120:123], v7 offset:1952
  s_waitcnt lgkmcnt(0)
  v_add_f32 v68, v100, v104
  v_add_f32 v69, v101, v105
  v_add_f32 v70, v102, v106
  v_add_f32 v71, v103, v107
  v_add_f32 v72, v108, v112
  v_add_f32 v73, v109, v113
  v_add_f32 v74, v110, v114
  v_add_f32 v75, v111, v115
  v_add_f32 v76, v116, v120
  v_add_f32 v77, v117, v121
  v_add_f32 v78, v118, v122
  v_add_f32 v79, v119, v123
  s_cmp_lg_u32 s24, 0
  s_cbranch_scc1 k0_23
  s_lshl_b32 s29, s26, 3
  s_add_u32 s29, s29, s27
  s_lshl_b32 s30, s29, 11
  s_add_u32 s30, s30, 20574208
  buffer_store_dwordx4 v[68:71], v8, s[12:15], s30 offen sc1
  buffer_store_dwordx4 v[72:75], v8, s[12:15], s30 offen offset:16 sc1
  buffer_store_dwordx4 v[76:79], v8, s[12:15], s30 offen offset:32 sc1
  s_lshl_b32 s29, s29, 7
  s_add_u32 s29, s29, 20541440
  s_waitcnt vmcnt(0)
  v_mov_b32 v2, s47
  v_mov_b32 v3, 0
  s_mov_b64 exec, 1
  buffer_store_dword v2, v3, s[12:15], s29 offen sc1
  s_mov_b64 exec, -1
k0_23:
  s_lshl_b32 s29, s26, 10
  s_add_u32 s29, s29, 20541440
  v_and_b32 v3, 7, v1
  v_lshlrev_b32 v3, 7, v3
  s_mov_b32 s32, 0
gated_mix__linear_attn_block__mha_block__prompt_kernel_wk:
  buffer_load_dword v164, v3, s[12:15], s29 offen sc1
  s_waitcnt vmcnt(0)
  v_cmp_ne_u32 vcc, s47, v164
  s_nop 3
  s_cmp_eq_u64 vcc, 0
  s_cbranch_scc1 gated_mix__linear_attn_block__mha_block__prompt_kernel_wk_ok
  s_add_u32 s32, s32, 1
  s_cmp_lt_u32 s32, 0x40000
  s_cbranch_scc0 gated_mix__linear_attn_block__mha_block__prompt_kernel_wk_ok
  s_sleep 2
  s_branch gated_mix__linear_attn_block__mha_block__prompt_kernel_wk
gated_mix__linear_attn_block__mha_block__prompt_kernel_wk_ok:
  s_lshl_b32 s29, s26, 3
  s_lshl_b32 s30, s24, 2
  s_add_u32 s29, s29, s30
  s_lshl_b32 s29, s29, 11
  s_add_u32 s29, s29, 20574208
  buffer_load_dwordx4 v[100:103], v8, s[12:15], s29 offen offset:0 sc1
  buffer_load_dwordx4 v[116:119], v8, s[12:15], s29 offen offset:16 sc1
  buffer_load_dwordx4 v[132:135], v8, s[12:15], s29 offen offset:32 sc1
  s_add_u32 s29, s29, 2048
  buffer_load_dwordx4 v[104:107], v8, s[12:15], s29 offen offset:0 sc1
  buffer_load_dwordx4 v[120:123], v8, s[12:15], s29 offen offset:16 sc1
  buffer_load_dwordx4 v[136:139], v8, s[12:15], s29 offen offset:32 sc1
  s_add_u32 s29, s29, 2048
  buffer_load_dwordx4 v[108:111], v8, s[12:15], s29 offen offset:0 sc1
  buffer_load_dwordx4 v[124:127], v8, s[12:15], s29 offen offset:16 sc1
  buffer_load_dwordx4 v[140:143], v8, s[12:15], s29 offen offset:32 sc1
  s_add_u32 s29, s29, 2048
  buffer_load_dwordx4 v[112:115], v8, s[12:15], s29 offen offset:0 sc1
  buffer_load_dwordx4 v[128:131], v8, s[12:15], s29 offen offset:16 sc1
  buffer_load_dwordx4 v[144:147], v8, s[12:15], s29 offen offset:32 sc1
  s_waitcnt vmcnt(0)
  v_add_f32 v100, v100, v104
  v_add_f32 v108, v108, v112
  v_add_f32 v101, v101, v105
  v_add_f32 v109, v109, v113
  v_add_f32 v102, v102, v106
  v_add_f32 v110, v110, v114
  v_add_f32 v103, v103, v107
  v_add_f32 v111, v111, v115
  v_add_f32 v68, v100, v108
  v_add_f32 v69, v101, v109
  v_add_f32 v70, v102, v110
  v_add_f32 v71, v103, v111
  v_add_f32 v116, v116, v120
  v_add_f32 v124, v124, v128
  v_add_f32 v117, v117, v121
  v_add_f32 v125, v125, v129
  v_add_f32 v118, v118, v122
  v_add_f32 v126, v126, v130
  v_add_f32 v119, v119, v123
  v_add_f32 v127, v127, v131
  v_add_f32 v72, v116, v124
  v_add_f32 v73, v117, v125
  v_add_f32 v74, v118, v126
  v_add_f32 v75, v119, v127
  v_add_f32 v132, v132, v136
  v_add_f32 v140, v140, v144
  v_add_f32 v133, v133, v137
  v_add_f32 v141, v141, v145
  v_add_f32 v134, v134, v138
  v_add_f32 v142, v142, v146
  v_add_f32 v135, v135, v139
  v_add_f32 v143, v143, v147
  v_add_f32 v76, v132, v140
  v_add_f32 v77, v133, v141
  v_add_f32 v78, v134, v142
  v_add_f32 v79, v135, v143
  s_mul_i32 s29, s24, 1920
  v_add_u32 v2, s29, v7
  ds_write_b128 v2, v[68:71] offset:0
  ds_write_b128 v2, v[72:75] offset:16
  ds_write_b128 v2, v[76:79] offset:32
k01_22:
  s_lshl_b32 s28, s27, 3
  s_lshl_b32 s29, s24, 1
  s_add_u32 s28, s28, s29
  s_lshl_b32 s29, s26, 6
  s_add_u32 s29, s29, s28
  s_lshl_b32 s39, s29, 10
  s_lshl_b32 s40, s29, 7
  s_add_u32 s29, s39, 7340032
  s_add_u32 s30, s40, 9437184
  buffer_load_dwordx4 v[12:15], v9, s[12:15], s29 offen sc1
  buffer_load_dwordx4 v[16:19], v9, s[12:15], s29 offen offset:1024 sc1
  buffer_load_dword v20, v11, s[12:15], s30 offen sc1
  buffer_load_dword v22, v11, s[12:15], s30 offen offset:128 sc1
  s_lshl_b32 s29, s28, 7
  s_add_u32 s29, s29, 14960640
  buffer_load_dword v30, v11, s[12:15], s29 offen sc1
  buffer_load_dword v31, v11, s[12:15], s29 offen offset:128 sc1
  s_waitcnt vmcnt(0) lgkmcnt(0)
  s_barrier
  ds_read_b128 v[100:103], v7 offset:0
  ds_read_b128 v[104:107], v7 offset:1920
  ds_read_b128 v[108:111], v7 offset:16
  ds_read_b128 v[112:115], v7 offset:1936
  ds_read_b128 v[116:119], v7 offset:32
  ds_read_b128 v[120:123], v7 offset:1952
  s_waitcnt lgkmcnt(0)
  v_add_f32 v68, v100, v104
  v_add_f32 v69, v101, v105
  v_add_f32 v70, v102, v106
  v_add_f32 v71, v103, v107
  v_add_f32 v72, v108, v112
  v_add_f32 v73, v109, v113
  v_add_f32 v74, v110, v114
  v_add_f32 v75, v111, v115
  v_add_f32 v76, v116, v120
  v_add_f32 v77, v117, v121
  v_add_f32 v78, v118, v122
  v_add_f32 v79, v119, v123
  v_cvt_pk_bf16_f32 v24, v68, v69
  v_cvt_pk_bf16_f32 v25, v70, v71
  v_cvt_pk_bf16_f32 v26, v72, v73
  v_cvt_pk_bf16_f32 v27, v74, v75
  v_cvt_pk_bf16_f32 v2, v76, v77
  v_cmp_gt_u32 vcc, 32, v1
  v_mov_b32 v29, 0
  v_mov_b32 v21, 0
  v_mov_b32 v23, 0
  v_cndmask_b32 v28, 0, v2, vcc
  v_cndmask_b32 v20, 0, v20, vcc
  v_cndmask_b32 v22, 0, v22, vcc
  s_nop 1
  v_mfma_f32_32x32x16_bf16 v[100:115], v[24:27], v[12:15], 0
  v_mfma_f32_32x32x16_bf16 v[116:131], v[24:27], v[16:19], 0
  v_mfma_f32_32x32x8_bf16 v[100:115], v[28:29], v[20:21], v[100:115]
  v_mfma_f32_32x32x8_bf16 v[116:131], v[28:29], v[22:23], v[116:131]
  s_nop 15
  s_nop 3
  v_mov_b32 v2, v110
  v_mov_b32 v3, v110
  s_nop 1
  v_permlane32_swap_b32 v2, v3
  s_nop 1
  v_add_f32 v2, 0x358637bd, v2
  v_rcp_f32 v2, v2
  s_nop 0
  v_mul_f32 v2, v2, v30
  v_mul_f32 v100, v100, v2
  v_mul_f32 v101, v101, v2
  v_mul_f32 v102, v102, v2
  v_mul_f32 v103, v103, v2
  v_mul_f32 v104, v104, v2
  v_mul_f32 v105, v105, v2
  v_mul_f32 v106, v106, v2
  v_mul_f32 v107, v107, v2
  v_mul_f32 v108, v108, v2
  v_mul_f32 v109, v109, v2
  v_cvt_pk_bf16_f32 v100, v100, v101
  v_cvt_pk_bf16_f32 v101, v102, v103
  v_cvt_pk_bf16_f32 v102, v104, v105
  v_cvt_pk_bf16_f32 v103, v106, v107
  v_cvt_pk_bf16_f32 v104, v108, v109
  s_add_u32 s29, s39, 14968832
  s_add_u32 s30, s40, 17065984
  buffer_store_dwordx4 v[100:103], v9, s[12:15], s29 offen sc1
  buffer_store_dword v104, v10, s[12:15], s30 offen sc1
  s_add_u32 s39, s39, 1024
  s_add_u32 s40, s40, 128
  v_mov_b32 v2, v126
  v_mov_b32 v3, v126
  s_nop 1
  v_permlane32_swap_b32 v2, v3
  s_nop 1
  v_add_f32 v2, 0x358637bd, v2
  v_rcp_f32 v2, v2
  s_nop 0
  v_mul_f32 v2, v2, v31
  v_mul_f32 v116, v116, v2
  v_mul_f32 v117, v117, v2
  v_mul_f32 v118, v118, v2
  v_mul_f32 v119, v119, v2
  v_mul_f32 v120, v120, v2
  v_mul_f32 v121, v121, v2
  v_mul_f32 v122, v122, v2
  v_mul_f32 v123, v123, v2
  v_mul_f32 v124, v124, v2
  v_mul_f32 v125, v125, v2
  v_cvt_pk_bf16_f32 v116, v116, v117
  v_cvt_pk_bf16_f32 v117, v118, v119
  v_cvt_pk_bf16_f32 v118, v120, v121
  v_cvt_pk_bf16_f32 v119, v122, v123
  v_cvt_pk_bf16_f32 v120, v124, v125
  s_add_u32 s29, s39, 14968832
  s_add_u32 s30, s40, 17065984
  buffer_store_dwordx4 v[116:119], v9, s[12:15], s29 offen sc1
  buffer_store_dword v120, v10, s[12:15], s30 offen sc1
  s_and_b32 s71, s2, 7
  s_lshl_b32 s71, s71, 2
  s_lshr_b32 s31, s2, 3
  s_and_b32 s32, s31, 3
  s_add_u32 s71, s71, s32
  s_lshr_b32 s70, s31, 2
  s_lshr_b32 s72, s24, 1
  s_and_b32 s32, s24, 1
  s_lshl_b32 s73, s71, 1
  s_add_u32 s73, s73, s32
  v_add_u32 v2, 0, v1
  v_mul_u32_u24 v3, 7282, v2
  v_lshrrev_b32 v3, 16, v3
  v_mul_u32_u24 v4, 9, v3
  v_sub_u32 v4, v2, v4
  v_mul_u32_u24 v3, 1152, v3
  v_lshlrev_b32 v4, 4, v4
  v_add_u32 v140, v3, v4
  v_add_u32 v2, 64, v1
  v_mul_u32_u24 v3, 7282, v2
  v_lshrrev_b32 v3, 16, v3
  v_mul_u32_u24 v4, 9, v3
  v_sub_u32 v4, v2, v4
  v_mul_u32_u24 v3, 1152, v3
  v_lshlrev_b32 v4, 4, v4
  v_add_u32 v141, v3, v4
  v_add_u32 v2, 128, v1
  v_mul_u32_u24 v3, 7282, v2
  v_lshrrev_b32 v3, 16, v3
  v_mul_u32_u24 v4, 9, v3
  v_sub_u32 v4, v2, v4
  v_mul_u32_u24 v3, 1152, v3
  v_lshlrev_b32 v4, 4, v4
  v_add_u32 v142, v3, v4
  v_add_u32 v2, 192, v1
  v_mul_u32_u24 v3, 7282, v2
  v_lshrrev_b32 v3, 16, v3
  v_mul_u32_u24 v4, 9, v3
  v_sub_u32 v4, v2, v4
  v_mul_u32_u24 v3, 1152, v3
  v_lshlrev_b32 v4, 4, v4
  v_add_u32 v143, v3, v4
  v_add_u32 v2, 256, v1
  v_mul_u32_u24 v3, 7282, v2
  v_lshrrev_b32 v3, 16, v3
  v_mul_u32_u24 v4, 9, v3
  v_sub_u32 v4, v2, v4
  v_mul_u32_u24 v3, 1152, v3
  v_lshlrev_b32 v4, 4, v4
  v_add_u32 v144, v3, v4
  v_add_u32 v2, 320, v1
  v_mul_u32_u24 v3, 7282, v2
  v_lshrrev_b32 v3, 16, v3
  v_mul_u32_u24 v4, 9, v3
  v_sub_u32 v4, v2, v4
  v_mul_u32_u24 v3, 1152, v3
  v_lshlrev_b32 v4, 4, v4
  v_add_u32 v145, v3, v4
  v_add_u32 v2, 384, v1
  v_mul_u32_u24 v3, 7282, v2
  v_lshrrev_b32 v3, 16, v3
  v_mul_u32_u24 v4, 9, v3
  v_sub_u32 v4, v2, v4
  v_mul_u32_u24 v3, 1152, v3
  v_lshlrev_b32 v4, 4, v4
  v_add_u32 v146, v3, v4
  v_add_u32 v2, 448, v1
  v_mul_u32_u24 v3, 7282, v2
  v_lshrrev_b32 v3, 16, v3
  v_mul_u32_u24 v4, 9, v3
  v_sub_u32 v4, v2, v4
  v_mul_u32_u24 v3, 1152, v3
  v_lshlrev_b32 v4, 4, v4
  v_add_u32 v147, v3, v4
  v_add_u32 v2, 512, v1
  v_mul_u32_u24 v3, 7282, v2
  v_lshrrev_b32 v3, 16, v3
  v_mul_u32_u24 v4, 9, v3
  v_sub_u32 v4, v2, v4
  v_mul_u32_u24 v3, 1152, v3
  v_lshlrev_b32 v4, 4, v4
  v_add_u32 v148, v3, v4
  s_and_b32 s31, s24, 1
  s_mul_i32 s31, s31, 77824
  s_lshr_b32 s32, s24, 1
  s_mul_i32 s32, s32, 20736
  s_add_u32 s74, s31, s32
  s_waitcnt vmcnt(0)
  s_barrier
  s_cmp_lg_u32 s24, 0
  s_cbranch_scc1 sv_24
  s_lshl_b32 s29, s27, 5
  s_add_u32 s29, s29, s26
  s_lshl_b32 s29, s29, 7
  s_add_u32 s29, s29, 20508672
  v_mov_b32 v2, s47
  v_mov_b32 v3, 0
  s_mov_b64 exec, 1
  buffer_store_dword v2, v3, s[12:15], s29 offen sc1
  s_mov_b64 exec, -1
sv_24:
  s_cmp_gt_u32 s24, 1
  s_cbranch_scc1 sv_25
  s_mul_i32 s29, s24, 165888
  s_mul_i32 s30, s70, 144
  s_add_u32 s29, s29, s30
  s_add_u32 m0, s74, 0
  s_add_u32 s30, s29, 0
  buffer_load_dwordx4 v140, s[84:87], s30 offen lds
  s_add_u32 m0, s74, 1024
  s_add_u32 s30, s29, 0
  buffer_load_dwordx4 v141, s[84:87], s30 offen lds
  s_add_u32 m0, s74, 2048
  s_add_u32 s30, s29, 0
  buffer_load_dwordx4 v142, s[84:87], s30 offen lds
  s_add_u32 m0, s74, 3072
  s_add_u32 s30, s29, 0
  buffer_load_dwordx4 v143, s[84:87], s30 offen lds
  s_add_u32 m0, s74, 4096
  s_add_u32 s30, s29, 0
  buffer_load_dwordx4 v144, s[84:87], s30 offen lds
  s_add_u32 m0, s74, 5120
  s_add_u32 s30, s29, 0
  buffer_load_dwordx4 v145, s[84:87], s30 offen lds
  s_add_u32 m0, s74, 6144
  s_add_u32 s30, s29, 0
  buffer_load_dwordx4 v146, s[84:87], s30 offen lds
  s_add_u32 m0, s74, 7168
  s_add_u32 s30, s29, 0
  buffer_load_dwordx4 v147, s[84:87], s30 offen lds
  s_add_u32 m0, s74, 8192
  s_add_u32 s30, s29, 0
  buffer_load_dwordx4 v148, s[84:87], s30 offen lds
  s_add_u32 m0, s74, 9216
  s_add_u32 s30, s29, 73728
  buffer_load_dwordx4 v140, s[84:87], s30 offen lds
  s_add_u32 m0, s74, 10240
  s_add_u32 s30, s29, 73728
  buffer_load_dwordx4 v141, s[84:87], s30 offen lds
  s_add_u32 m0, s74, 11264
  s_add_u32 s30, s29, 73728
  buffer_load_dwordx4 v142, s[84:87], s30 offen lds
  s_add_u32 m0, s74, 12288
  s_add_u32 s30, s29, 73728
  buffer_load_dwordx4 v143, s[84:87], s30 offen lds
  s_add_u32 m0, s74, 13312
  s_add_u32 s30, s29, 73728
  buffer_load_dwordx4 v144, s[84:87], s30 offen lds
  s_add_u32 m0, s74, 14336
  s_add_u32 s30, s29, 73728
  buffer_load_dwordx4 v145, s[84:87], s30 offen lds
  s_add_u32 m0, s74, 15360
  s_add_u32 s30, s29, 73728
  buffer_load_dwordx4 v146, s[84:87], s30 offen lds
  s_add_u32 m0, s74, 16384
  s_add_u32 s30, s29, 73728
  buffer_load_dwordx4 v147, s[84:87], s30 offen lds
  s_add_u32 m0, s74, 17408
  s_add_u32 s30, s29, 73728
  buffer_load_dwordx4 v148, s[84:87], s30 offen lds
  s_add_u32 m0, s74, 18432
  s_add_u32 s30, s29, 147456
  buffer_load_dwordx4 v140, s[84:87], s30 offen lds
  s_add_u32 m0, s74, 19456
  s_add_u32 s30, s29, 147456
  buffer_load_dwordx4 v141, s[84:87], s30 offen lds
  s_mov_b64 exec, 0xffff
  s_add_u32 m0, s74, 20480
  s_add_u32 s30, s29, 147456
  buffer_load_dwordx4 v142, s[84:87], s30 offen lds
  s_mov_b64 exec, -1
sv_25:
  s_mul_i32 s29, s24, 165888
  s_mul_i32 s30, s70, 144
  s_add_u32 s29, s29, s30
  s_add_u32 s30, s29, 0
  buffer_load_dwordx4 v[56:59], v140, s[96:99], s30 offen
  s_add_u32 s30, s29, 0
  buffer_load_dwordx4 v[60:63], v141, s[96:99], s30 offen
  s_add_u32 s30, s29, 0
  buffer_load_dwordx4 v[64:67], v142, s[96:99], s30 offen
  s_add_u32 s30, s29, 0
  buffer_load_dwordx4 v[68:71], v143, s[96:99], s30 offen
  s_add_u32 s30, s29, 0
  buffer_load_dwordx4 v[72:75], v144, s[96:99], s30 offen
  s_add_u32 s30, s29, 0
  buffer_load_dwordx4 v[76:79], v145, s[96:99], s30 offen
  s_add_u32 s30, s29, 0
  buffer_load_dwordx4 v[80:83], v146, s[96:99], s30 offen
  s_add_u32 s30, s29, 0
  buffer_load_dwordx4 v[84:87], v147, s[96:99], s30 offen
  s_add_u32 s30, s29, 0
  buffer_load_dwordx4 v[88:91], v148, s[96:99], s30 offen
  s_add_u32 s30, s29, 73728
  buffer_load_dwordx4 v[92:95], v140, s[96:99], s30 offen
  s_add_u32 s30, s29, 73728
  buffer_load_dwordx4 v[96:99], v141, s[96:99], s30 offen
  s_add_u32 s30, s29, 73728
  buffer_load_dwordx4 v[100:103], v142, s[96:99], s30 offen
  s_add_u32 s30, s29, 73728
  buffer_load_dwordx4 v[104:107], v143, s[96:99], s30 offen
  s_add_u32 s30, s29, 73728
  buffer_load_dwordx4 v[108:111], v144, s[96:99], s30 offen
  s_add_u32 s30, s29, 73728
  buffer_load_dwordx4 v[112:115], v145, s[96:99], s30 offen
  s_add_u32 s30, s29, 73728
  buffer_load_dwordx4 v[116:119], v146, s[96:99], s30 offen
  s_add_u32 s30, s29, 73728
  buffer_load_dwordx4 v[120:123], v147, s[96:99], s30 offen
  s_add_u32 s30, s29, 73728
  buffer_load_dwordx4 v[124:127], v148, s[96:99], s30 offen
  s_add_u32 s30, s29, 147456
  buffer_load_dwordx4 v[128:131], v140, s[96:99], s30 offen
  s_add_u32 s30, s29, 147456
  buffer_load_dwordx4 v[132:135], v141, s[96:99], s30 offen
  s_mov_b64 exec, 0xffff
  s_add_u32 s30, s29, 147456
  buffer_load_dwordx4 v[136:139], v142, s[96:99], s30 offen
  s_mov_b64 exec, -1
  s_and_b32 s29, s2, 7
  s_lshl_b32 s29, s29, 12
  s_add_u32 s29, s29, 20508672
  v_and_b32 v3, 31, v1
  v_lshlrev_b32 v3, 7, v3
  s_mov_b32 s32, 0
gated_mix__linear_attn_block__mha_block__prompt_kernel_w2a:
  buffer_load_dword v164, v3, s[12:15], s29 offen sc1
  s_waitcnt vmcnt(0)
  v_cmp_ne_u32 vcc, s47, v164
  s_nop 3
  s_cmp_eq_u64 vcc, 0
  s_cbranch_scc1 gated_mix__linear_attn_block__mha_block__prompt_kernel_w2a_ok
  s_add_u32 s32, s32, 1
  s_cmp_lt_u32 s32, 0x40000
  s_cbranch_scc0 gated_mix__linear_attn_block__mha_block__prompt_kernel_w2a_ok
  s_sleep 2
  s_branch gated_mix__linear_attn_block__mha_block__prompt_kernel_w2a
gated_mix__linear_attn_block__mha_block__prompt_kernel_w2a_ok:
  s_barrier
  v_sub_f32 v30, 1.0, v30
  v_sub_f32 v31, 1.0, v31
  s_lshl_b32 s29, s24, 8
  s_add_u32 s29, s29, 119296
  v_add_u32 v2, s29, v11
  s_mov_b64 exec, 0xffffffff
  ds_write_b32 v2, v30
  ds_write_b32 v2, v31 offset:128
  s_mov_b64 exec, -1
  s_cmp_lt_u32 s24, 2
  s_cbranch_scc1 sv_26
  s_mul_i32 s29, s24, 165888
  s_mul_i32 s30, s70, 144
  s_add_u32 s29, s29, s30
  s_add_u32 m0, s74, 0
  s_add_u32 s30, s29, 0
  buffer_load_dwordx4 v140, s[84:87], s30 offen lds
  s_add_u32 m0, s74, 1024
  s_add_u32 s30, s29, 0
  buffer_load_dwordx4 v141, s[84:87], s30 offen lds
  s_add_u32 m0, s74, 2048
  s_add_u32 s30, s29, 0
  buffer_load_dwordx4 v142, s[84:87], s30 offen lds
  s_add_u32 m0, s74, 3072
  s_add_u32 s30, s29, 0
  buffer_load_dwordx4 v143, s[84:87], s30 offen lds
  s_add_u32 m0, s74, 4096
  s_add_u32 s30, s29, 0
  buffer_load_dwordx4 v144, s[84:87], s30 offen lds
  s_add_u32 m0, s74, 5120
  s_add_u32 s30, s29, 0
  buffer_load_dwordx4 v145, s[84:87], s30 offen lds
  s_add_u32 m0, s74, 6144
  s_add_u32 s30, s29, 0
  buffer_load_dwordx4 v146, s[84:87], s30 offen lds
  s_add_u32 m0, s74, 7168
  s_add_u32 s30, s29, 0
  buffer_load_dwordx4 v147, s[84:87], s30 offen lds
  s_add_u32 m0, s74, 8192
  s_add_u32 s30, s29, 0
  buffer_load_dwordx4 v148, s[84:87], s30 offen lds
  s_add_u32 m0, s74, 9216
  s_add_u32 s30, s29, 73728
  buffer_load_dwordx4 v140, s[84:87], s30 offen lds
  s_add_u32 m0, s74, 10240
  s_add_u32 s30, s29, 73728
  buffer_load_dwordx4 v141, s[84:87], s30 offen lds
  s_add_u32 m0, s74, 11264
  s_add_u32 s30, s29, 73728
  buffer_load_dwordx4 v142, s[84:87], s30 offen lds
  s_add_u32 m0, s74, 12288
  s_add_u32 s30, s29, 73728
  buffer_load_dwordx4 v143, s[84:87], s30 offen lds
  s_add_u32 m0, s74, 13312
  s_add_u32 s30, s29, 73728
  buffer_load_dwordx4 v144, s[84:87], s30 offen lds
  s_add_u32 m0, s74, 14336
  s_add_u32 s30, s29, 73728
  buffer_load_dwordx4 v145, s[84:87], s30 offen lds
  s_add_u32 m0, s74, 15360
  s_add_u32 s30, s29, 73728
  buffer_load_dwordx4 v146, s[84:87], s30 offen lds
  s_add_u32 m0, s74, 16384
  s_add_u32 s30, s29, 73728
  buffer_load_dwordx4 v147, s[84:87], s30 offen lds
  s_add_u32 m0, s74, 17408
  s_add_u32 s30, s29, 73728
  buffer_load_dwordx4 v148, s[84:87], s30 offen lds
  s_add_u32 m0, s74, 18432
  s_add_u32 s30, s29, 147456
  buffer_load_dwordx4 v140, s[84:87], s30 offen lds
  s_add_u32 m0, s74, 19456
  s_add_u32 s30, s29, 147456
  buffer_load_dwordx4 v141, s[84:87], s30 offen lds
  s_mov_b64 exec, 0xffff
  s_add_u32 m0, s74, 20480
  s_add_u32 s30, s29, 147456
  buffer_load_dwordx4 v142, s[84:87], s30 offen lds
  s_mov_b64 exec, -1
sv_26:
  s_waitcnt lgkmcnt(0)
  s_barrier
  s_cmp_lt_u32 s24, 2
  s_cbranch_scc1 sv_27
  s_waitcnt vmcnt(0)
sv_27:
  s_barrier
  s_cmp_lg_u32 s24, 0
  s_cbranch_scc1 sv_28
  s_lshl_b32 s29, s27, 5
  s_add_u32 s29, s29, s26
  s_lshl_b32 s29, s29, 7
  s_add_u32 s29, s29, 20475904
  v_mov_b32 v2, s47
  v_mov_b32 v3, 0
  s_mov_b64 exec, 1
  buffer_store_dword v2, v3, s[12:15], s29 offen sc1
  s_mov_b64 exec, -1
sv_28:
  s_mov_b32 s75, 120320
  s_cmp_eq_u32 s24, 1
  s_cselect_b32 s75, 141056, s75
  s_cmp_eq_u32 s24, 2
  s_cselect_b32 s75, 41472, s75
  s_cmp_eq_u32 s24, 3
  s_cselect_b32 s75, 0, s75
  s_cmp_eq_u32 s24, 3
  s_cbranch_scc1 sv_29
  v_add_u32 v2, s75, v9
  ds_write_b128 v2, v[56:59] offset:0
  ds_write_b128 v2, v[60:63] offset:1024
  ds_write_b128 v2, v[64:67] offset:2048
  ds_write_b128 v2, v[68:71] offset:3072
  ds_write_b128 v2, v[72:75] offset:4096
  ds_write_b128 v2, v[76:79] offset:5120
  ds_write_b128 v2, v[80:83] offset:6144
  ds_write_b128 v2, v[84:87] offset:7168
  ds_write_b128 v2, v[88:91] offset:8192
  ds_write_b128 v2, v[92:95] offset:9216
  ds_write_b128 v2, v[96:99] offset:10240
  ds_write_b128 v2, v[100:103] offset:11264
  ds_write_b128 v2, v[104:107] offset:12288
  ds_write_b128 v2, v[108:111] offset:13312
  ds_write_b128 v2, v[112:115] offset:14336
  ds_write_b128 v2, v[116:119] offset:15360
  ds_write_b128 v2, v[120:123] offset:16384
  ds_write_b128 v2, v[124:127] offset:17408
  ds_write_b128 v2, v[128:131] offset:18432
  ds_write_b128 v2, v[132:135] offset:19456
  s_mov_b64 exec, 0xffff
  ds_write_b128 v2, v[136:139] offset:20480
  s_mov_b64 exec, -1
sv_29:
  s_barrier
  s_cmp_lg_u32 s24, 3
  s_cbranch_scc1 sv_30
  v_add_u32 v2, s75, v9
  ds_write_b128 v2, v[56:59] offset:0
  ds_write_b128 v2, v[60:63] offset:1024
  ds_write_b128 v2, v[64:67] offset:2048
  ds_write_b128 v2, v[68:71] offset:3072
  ds_write_b128 v2, v[72:75] offset:4096
  ds_write_b128 v2, v[76:79] offset:5120
  ds_write_b128 v2, v[80:83] offset:6144
  ds_write_b128 v2, v[84:87] offset:7168
  ds_write_b128 v2, v[88:91] offset:8192
  ds_write_b128 v2, v[92:95] offset:9216
  ds_write_b128 v2, v[96:99] offset:10240
  ds_write_b128 v2, v[100:103] offset:11264
  ds_write_b128 v2, v[104:107] offset:12288
  ds_write_b128 v2, v[108:111] offset:13312
  ds_write_b128 v2, v[112:115] offset:14336
  ds_write_b128 v2, v[116:119] offset:15360
  ds_write_b128 v2, v[120:123] offset:16384
  ds_write_b128 v2, v[124:127] offset:17408
  ds_write_b128 v2, v[128:131] offset:18432
  ds_write_b128 v2, v[132:135] offset:19456
  s_mov_b64 exec, 0xffff
  ds_write_b128 v2, v[136:139] offset:20480
  s_mov_b64 exec, -1
sv_30:
  s_waitcnt lgkmcnt(0)
  s_cmp_lg_u32 s24, 1
  s_cbranch_scc1 sv_31
  s_and_b32 s29, s2, 7
  s_lshl_b32 s29, s29, 12
  s_add_u32 s29, s29, 20475904
  v_and_b32 v3, 31, v1
  v_lshlrev_b32 v3, 7, v3
  s_mov_b32 s32, 0
gated_mix__linear_attn_block__mha_block__prompt_kernel_w2b:
  buffer_load_dword v164, v3, s[12:15], s29 offen sc1
  s_waitcnt vmcnt(0)
  v_cmp_ne_u32 vcc, s47, v164
  s_nop 3
  s_cmp_eq_u64 vcc, 0
  s_cbranch_scc1 gated_mix__linear_attn_block__mha_block__prompt_kernel_w2b_ok
  s_add_u32 s32, s32, 1
  s_cmp_lt_u32 s32, 0x40000
  s_cbranch_scc0 gated_mix__linear_attn_block__mha_block__prompt_kernel_w2b_ok
  s_sleep 2
  s_branch gated_mix__linear_attn_block__mha_block__prompt_kernel_w2b
gated_mix__linear_attn_block__mha_block__prompt_kernel_w2b_ok:
sv_31:
  s_barrier
  s_barrier
  s_barrier
  s_cmp_lg_u32 s24, 0
  s_cbranch_scc1 sv_32
  v_add_u32 v2, 512, v1
  v_mul_u32_u24 v3, 7282, v2
  v_lshrrev_b32 v3, 16, v3
  v_mul_u32_u24 v4, 9, v3
  v_sub_u32 v4, v2, v4
  v_mul_u32_u24 v5, 304, v3
  v_lshlrev_b32 v66, 5, v4
  v_add_u32 v5, v5, v66
  ds_read_b128 v[28:31], v5 offset:0
  ds_read_b128 v[32:35], v5 offset:16
  ds_read_b128 v[36:39], v5 offset:19456
  ds_read_b128 v[40:43], v5 offset:19472
  ds_read_b128 v[44:47], v5 offset:38912
  ds_read_b128 v[48:51], v5 offset:38928
  ds_read_b128 v[52:55], v5 offset:58368
  ds_read_b128 v[56:59], v5 offset:58384
  s_lshl_b32 s31, s71, 6
  v_add_u32 v3, s31, v3
  v_mul_u32_u24 v3, 1152, v3
  v_lshlrev_b32 v4, 4, v4
  v_add_u32 v3, v3, v4
  s_mul_i32 s31, s70, 144
  s_waitcnt lgkmcnt(0)
  v_add_f32 v28, v28, v36
  v_add_f32 v44, v44, v52
  v_add_f32 v29, v29, v37
  v_add_f32 v45, v45, v53
  v_add_f32 v30, v30, v38
  v_add_f32 v46, v46, v54
  v_add_f32 v31, v31, v39
  v_add_f32 v47, v47, v55
  v_add_f32 v32, v32, v40
  v_add_f32 v48, v48, v56
  v_add_f32 v33, v33, v41
  v_add_f32 v49, v49, v57
  v_add_f32 v34, v34, v42
  v_add_f32 v50, v50, v58
  v_add_f32 v35, v35, v43
  v_add_f32 v51, v51, v59
  v_add_f32 v28, v28, v44
  v_add_f32 v29, v29, v45
  v_add_f32 v30, v30, v46
  v_add_f32 v31, v31, v47
  v_add_f32 v32, v32, v48
  v_add_f32 v33, v33, v49
  v_add_f32 v34, v34, v50
  v_add_f32 v35, v35, v51
  v_cvt_pk_bf16_f32 v60, v28, v29
  v_cvt_pk_bf16_f32 v61, v30, v31
  v_cvt_pk_bf16_f32 v62, v32, v33
  v_cvt_pk_bf16_f32 v63, v34, v35
  buffer_store_dwordx4 v[60:63], v3, s[88:91], s31 offen
sv_32:
  s_endpgm
gated_mix__linear_attn_block__mha_block__prompt_kernel_comp:
  s_sub_u32 s24, s24, 4
  s_and_b32 s25, s24, 3
  s_lshr_b32 s26, s24, 2
  s_lshl_b32 s27, s22, 2
  s_add_u32 s27, s27, s25
  v_lshlrev_b32 v20, 4, v1
  v_and_b32 v21, 31, v1
  v_lshrrev_b32 v22, 5, v1
  v_lshlrev_b32 v23, 2, v21
  s_mul_i32 s45, s42, 432
  s_mov_b32 s46, 216
  s_mov_b32 s47, 8
  s_mov_b32 s48, 0
  s_mov_b32 s44, 0
  s_cmp_eq_u32 s43, 0
  s_cbranch_scc0 gated_mix__linear_attn_block__mha_block__prompt_kernel_c_pv
  s_cmp_gt_u32 s42, 5
  s_cbranch_scc0 gated_mix__linear_attn_block__mha_block__prompt_kernel_c_pq1
  s_sub_u32 s45, s45, 2304
  s_mov_b32 s44, 1
  s_branch gated_mix__linear_attn_block__mha_block__prompt_kernel_c_pd
gated_mix__linear_attn_block__mha_block__prompt_kernel_c_pq1:
  s_cmp_eq_u32 s42, 5
  s_cbranch_scc0 gated_mix__linear_attn_block__mha_block__prompt_kernel_c_pd
  s_mov_b32 s46, 72
  s_mov_b32 s47, 3
  s_branch gated_mix__linear_attn_block__mha_block__prompt_kernel_c_pd
gated_mix__linear_attn_block__mha_block__prompt_kernel_c_pv:
  s_cmp_gt_u32 s42, 2
  s_cbranch_scc0 gated_mix__linear_attn_block__mha_block__prompt_kernel_c_pv1
  s_mov_b32 s44, 1
  s_cmp_gt_u32 s42, 5
  s_cbranch_scc1 gated_mix__linear_attn_block__mha_block__prompt_kernel_c_pv2
  s_add_u32 s45, s45, 1152
  s_cmp_eq_u32 s42, 5
  s_cbranch_scc0 gated_mix__linear_attn_block__mha_block__prompt_kernel_c_pd
  s_mov_b32 s46, 72
  s_mov_b32 s47, 3
  s_mov_b32 s48, 1152
  s_branch gated_mix__linear_attn_block__mha_block__prompt_kernel_c_pd
gated_mix__linear_attn_block__mha_block__prompt_kernel_c_pv2:
  s_sub_u32 s45, s45, 1152
  s_branch gated_mix__linear_attn_block__mha_block__prompt_kernel_c_pd
gated_mix__linear_attn_block__mha_block__prompt_kernel_c_pv1:
  s_add_u32 s45, s45, 2304
  s_cmp_eq_u32 s42, 2
  s_cbranch_scc0 gated_mix__linear_attn_block__mha_block__prompt_kernel_c_pd
  s_mov_b32 s46, 144
  s_mov_b32 s47, 5
  s_mov_b32 s48, 2304
gated_mix__linear_attn_block__mha_block__prompt_kernel_c_pd:
  s_waitcnt lgkmcnt(0)
  s_cmp_lg_u32 s24, 0
  s_cbranch_scc1 gated_mix__linear_attn_block__mha_block__prompt_kernel_pcd
  s_getpc_b64 s[76:77]
gated_mix__linear_attn_block__mha_block__prompt_kernel_pc:
  s_sub_u32 s76, s76, gated_mix__linear_attn_block__mha_block__prompt_kernel_pc-gated_mix__linear_attn_block__mha_block__prompt_kernel
  s_subb_u32 s77, s77, 0
  s_lshr_b32 s28, s2, 3
  s_lshl_b32 s28, s28, 11
  v_lshlrev_b32 v2, 7, v1
  v_add_u32 v2, s28, v2
  v_min_u32 v2, gated_mix__linear_attn_block__mha_block__prompt_kernel_end-gated_mix__linear_attn_block__mha_block__prompt_kernel, v2
  s_mov_b64 exec, 0xffff
  global_load_dword v160, v2, s[76:77]
  s_mov_b64 exec, -1
gated_mix__linear_attn_block__mha_block__prompt_kernel_pcd:
  v_lshrrev_b32 v2, 4, v1
  v_and_b32 v132, 1, v2
  v_lshrrev_b32 v2, 1, v2
  v_and_b32 v4, 15, v1
  v_lshrrev_b32 v133, 2, v4
  v_and_b32 v134, 3, v4
  v_lshlrev_b32 v2, 3, v2
  v_add_u32 v2, v2, v133
  v_lshlrev_b32 v135, 9, v2
  s_and_b32 s31, s45, 63
  s_lshl_b32 s32, s47, 6
  s_lshl_b32 s30, s46, 1
  s_sub_u32 s32, s32, s30
  s_lshl_b32 s28, s26, 2
  s_add_u32 s28, s28, 0
  s_add_u32 s29, s28, 5
  s_cmp_ge_u32 s29, 6
  s_cselect_b32 s30, 6, 0
  s_sub_u32 s29, s29, s30
  s_mul_i32 s28, s28, 36
  s_mul_i32 s29, s29, 36
  s_add_u32 s29, s29, 20
  v_mov_b32 v6, s28
  v_mov_b32 v7, s29
  v_cmp_eq_u32 vcc, 0, v132
  v_lshlrev_b32 v2, 2, v134
  s_nop 0
  v_cndmask_b32 v6, v7, v6, vcc
  v_add_u32 v6, v6, v2
  v_lshlrev_b32 v3, 1, v6
  v_add_u32 v4, s31, v3
  v_add_u32 v3, s32, v3
  v_cmp_gt_u32 vcc, s46, v6
  s_nop 1
  v_cndmask_b32 v3, v3, v4, vcc
  v_lshrrev_b32 v4, 6, v3
  v_xor_b32 v4, v4, v133
  v_lshlrev_b32 v4, 6, v4
  v_and_b32 v5, 63, v3
  v_add_u32 v4, v4, v5
  v_add_u32 v12, v4, v135
  s_lshl_b32 s28, s26, 2
  s_add_u32 s28, s28, 1
  s_add_u32 s29, s28, 5
  s_cmp_ge_u32 s29, 6
  s_cselect_b32 s30, 6, 0
  s_sub_u32 s29, s29, s30
  s_mul_i32 s28, s28, 36
  s_mul_i32 s29, s29, 36
  s_add_u32 s29, s29, 20
  v_mov_b32 v6, s28
  v_mov_b32 v7, s29
  v_cmp_eq_u32 vcc, 0, v132
  v_lshlrev_b32 v2, 2, v134
  s_nop 0
  v_cndmask_b32 v6, v7, v6, vcc
  v_add_u32 v6, v6, v2
  v_lshlrev_b32 v3, 1, v6
  v_add_u32 v4, s31, v3
  v_add_u32 v3, s32, v3
  v_cmp_gt_u32 vcc, s46, v6
  s_nop 1
  v_cndmask_b32 v3, v3, v4, vcc
  v_lshrrev_b32 v4, 6, v3
  v_xor_b32 v4, v4, v133
  v_lshlrev_b32 v4, 6, v4
  v_and_b32 v5, 63, v3
  v_add_u32 v4, v4, v5
  v_add_u32 v13, v4, v135
  v_mov_b32 v6, 72
  v_mov_b32 v7, 56
  v_cmp_eq_u32 vcc, 0, v132
  v_lshlrev_b32 v2, 2, v134
  s_nop 0
  v_cndmask_b32 v6, v7, v6, vcc
  v_add_u32 v6, v6, v2
  v_lshlrev_b32 v3, 1, v6
  v_add_u32 v4, s31, v3
  v_add_u32 v3, s32, v3
  v_cmp_gt_u32 vcc, s46, v6
  s_nop 1
  v_cndmask_b32 v3, v3, v4, vcc
  v_lshrrev_b32 v4, 6, v3
  v_xor_b32 v4, v4, v133
  v_lshlrev_b32 v4, 6, v4
  v_and_b32 v5, 63, v3
  v_add_u32 v4, v4, v5
  v_add_u32 v14, v4, v135
  v_lshlrev_b32 v6, 2, v132
  v_add_u32 v6, v6, v134
  v_mul_u32_u24 v7, 36, v6
  v_add_u32 v7, 16, v7
  v_lshlrev_b32 v3, 1, v7
  v_add_u32 v4, s31, v3
  v_add_u32 v3, s32, v3
  v_cmp_gt_u32 vcc, s46, v7
  s_nop 1
  v_cndmask_b32 v3, v3, v4, vcc
  v_lshrrev_b32 v4, 6, v3
  v_xor_b32 v4, v4, v133
  v_lshlrev_b32 v4, 6, v4
  v_and_b32 v5, 63, v3
  v_add_u32 v4, v4, v5
  v_add_u32 v136, v4, v135
  v_mov_b32 v3, 496
  v_lshrrev_b32 v4, 6, v3
  v_xor_b32 v4, v4, v133
  v_lshlrev_b32 v4, 6, v4
  v_and_b32 v5, 63, v3
  v_add_u32 v4, v4, v5
  v_add_u32 v137, v4, v135
  v_cmp_gt_u32 vcc, 6, v6
  s_nop 1
  v_cndmask_b32 v136, v137, v136, vcc
  s_cmp_eq_u32 s26, 0
  s_cselect_b64 vcc, -1, 0
  v_cndmask_b32 v14, v136, v14, vcc
  v_mov_b32 v6, 108
  v_mov_b32 v7, 92
  v_cmp_eq_u32 vcc, 0, v132
  v_lshlrev_b32 v2, 2, v134
  s_nop 0
  v_cndmask_b32 v6, v7, v6, vcc
  v_add_u32 v6, v6, v2
  v_lshlrev_b32 v3, 1, v6
  v_add_u32 v4, s31, v3
  v_add_u32 v3, s32, v3
  v_cmp_gt_u32 vcc, s46, v6
  s_nop 1
  v_cndmask_b32 v3, v3, v4, vcc
  v_lshrrev_b32 v4, 6, v3
  v_xor_b32 v4, v4, v133
  v_lshlrev_b32 v4, 6, v4
  v_and_b32 v5, 63, v3
  v_add_u32 v4, v4, v5
  v_add_u32 v15, v4, v135
  v_lshrrev_b32 v2, 1, v21
  v_and_b32 v2, 7, v2
  v_xor_b32 v2, v2, v22
  v_lshlrev_b32 v2, 4, v2
  s_lshl_b32 s28, s25, 5
  v_add_u32 v3, s28, v21
  v_lshlrev_b32 v3, 7, v3
  v_add_u32 v3, 32768, v3
  v_add_u32 v16, v2, v3
  v_xor_b32 v17, 32, v16
  v_xor_b32 v18, 64, v16
  v_xor_b32 v19, 96, v16
  v_mov_b32 v68, 0
  v_mov_b32 v69, 0
  v_mov_b32 v70, 0
  v_mov_b32 v71, 0
  v_mov_b32 v72, 0
  v_mov_b32 v73, 0
  v_mov_b32 v74, 0
  v_mov_b32 v75, 0
  v_mov_b32 v76, 0
  v_mov_b32 v77, 0
  v_mov_b32 v78, 0
  v_mov_b32 v79, 0
  v_mov_b32 v80, 0
  v_mov_b32 v81, 0
  v_mov_b32 v82, 0
  v_mov_b32 v83, 0
  v_mov_b32 v84, 0
  v_mov_b32 v85, 0
  v_mov_b32 v86, 0
  v_mov_b32 v87, 0
  v_mov_b32 v88, 0
  v_mov_b32 v89, 0
  v_mov_b32 v90, 0
  v_mov_b32 v91, 0
  v_mov_b32 v92, 0
  v_mov_b32 v93, 0
  v_mov_b32 v94, 0
  v_mov_b32 v95, 0
  v_mov_b32 v96, 0
  v_mov_b32 v97, 0
  v_mov_b32 v98, 0
  v_mov_b32 v99, 0
  v_mov_b32 v100, 0
  v_mov_b32 v101, 0
  v_mov_b32 v102, 0
  v_mov_b32 v103, 0
  v_mov_b32 v104, 0
  v_mov_b32 v105, 0
  v_mov_b32 v106, 0
  v_mov_b32 v107, 0
  v_mov_b32 v108, 0
  v_mov_b32 v109, 0
  v_mov_b32 v110, 0
  v_mov_b32 v111, 0
  v_mov_b32 v112, 0
  v_mov_b32 v113, 0
  v_mov_b32 v114, 0
  v_mov_b32 v115, 0
  v_mov_b32 v116, 0
  v_mov_b32 v117, 0
  v_mov_b32 v118, 0
  v_mov_b32 v119, 0
  v_mov_b32 v120, 0
  v_mov_b32 v121, 0
  v_mov_b32 v122, 0
  v_mov_b32 v123, 0
  v_mov_b32 v124, 0
  v_mov_b32 v125, 0
  v_mov_b32 v126, 0
  v_mov_b32 v127, 0
  v_mov_b32 v128, 0
  v_mov_b32 v129, 0
  v_mov_b32 v130, 0
  v_mov_b32 v131, 0
  s_lshl_b32 s28, s43, 1
  s_add_u32 s28, s28, s26
  s_cmp_eq_u32 s28, 1
  s_cbranch_scc1 gated_mix__linear_attn_block__mha_block__prompt_kernel_v01
  s_cmp_eq_u32 s28, 2
  s_cbranch_scc1 gated_mix__linear_attn_block__mha_block__prompt_kernel_v10
  s_cmp_eq_u32 s28, 3
  s_cbranch_scc1 gated_mix__linear_attn_block__mha_block__prompt_kernel_v11
  s_barrier
  ds_read_b128 v[28:31], v16
  ds_read_b64_tr_b16 v[36:37], v12 offset:0
  ds_read_b64_tr_b16 v[38:39], v12 offset:2048
  ds_read_b64_tr_b16 v[40:41], v13 offset:0
  ds_read_b64_tr_b16 v[42:43], v13 offset:2048
  ds_read_b64_tr_b16 v[44:45], v14 offset:0
  ds_read_b64_tr_b16 v[46:47], v14 offset:2048
  ds_read_b64_tr_b16 v[48:49], v15 offset:0
  ds_read_b64_tr_b16 v[50:51], v15 offset:2048
  s_mov_b32 s38, 0
gated_mix__linear_attn_block__mha_block__prompt_kernel_g00_loop:
  ds_read_b128 v[32:35], v17
  ds_read_b64_tr_b16 v[52:53], v12 offset:8192
  ds_read_b64_tr_b16 v[54:55], v12 offset:10240
  ds_read_b64_tr_b16 v[56:57], v13 offset:8192
  ds_read_b64_tr_b16 v[58:59], v13 offset:10240
  ds_read_b64_tr_b16 v[60:61], v14 offset:8192
  ds_read_b64_tr_b16 v[62:63], v14 offset:10240
  ds_read_b64_tr_b16 v[64:65], v15 offset:8192
  ds_read_b64_tr_b16 v[66:67], v15 offset:10240
  s_waitcnt lgkmcnt(9)
  v_mfma_f32_32x32x16_bf16 v[68:83], v[36:39], v[28:31], v[68:83]
  v_mfma_f32_32x32x16_bf16 v[84:99], v[40:43], v[28:31], v[84:99]
  v_mfma_f32_32x32x16_bf16 v[100:115], v[44:47], v[28:31], v[100:115]
  v_mfma_f32_32x32x16_bf16 v[116:131], v[48:51], v[28:31], v[116:131]
  ds_read_b128 v[28:31], v18
  ds_read_b64_tr_b16 v[36:37], v12 offset:16384
  ds_read_b64_tr_b16 v[38:39], v12 offset:18432
  ds_read_b64_tr_b16 v[40:41], v13 offset:16384
  ds_read_b64_tr_b16 v[42:43], v13 offset:18432
  ds_read_b64_tr_b16 v[44:45], v14 offset:16384
  ds_read_b64_tr_b16 v[46:47], v14 offset:18432
  ds_read_b64_tr_b16 v[48:49], v15 offset:16384
  ds_read_b64_tr_b16 v[50:51], v15 offset:18432
  s_waitcnt lgkmcnt(9)
  v_mfma_f32_32x32x16_bf16 v[68:83], v[52:55], v[32:35], v[68:83]
  v_mfma_f32_32x32x16_bf16 v[84:99], v[56:59], v[32:35], v[84:99]
  v_mfma_f32_32x32x16_bf16 v[100:115], v[60:63], v[32:35], v[100:115]
  v_mfma_f32_32x32x16_bf16 v[116:131], v[64:67], v[32:35], v[116:131]
  ds_read_b128 v[32:35], v19
  ds_read_b64_tr_b16 v[52:53], v12 offset:24576
  ds_read_b64_tr_b16 v[54:55], v12 offset:26624
  ds_read_b64_tr_b16 v[56:57], v13 offset:24576
  ds_read_b64_tr_b16 v[58:59], v13 offset:26624
  ds_read_b64_tr_b16 v[60:61], v14 offset:24576
  ds_read_b64_tr_b16 v[62:63], v14 offset:26624
  ds_read_b64_tr_b16 v[64:65], v15 offset:24576
  ds_read_b64_tr_b16 v[66:67], v15 offset:26624
  s_waitcnt lgkmcnt(9)
  v_mfma_f32_32x32x16_bf16 v[68:83], v[36:39], v[28:31], v[68:83]
  v_mfma_f32_32x32x16_bf16 v[84:99], v[40:43], v[28:31], v[84:99]
  v_mfma_f32_32x32x16_bf16 v[100:115], v[44:47], v[28:31], v[100:115]
  v_mfma_f32_32x32x16_bf16 v[116:131], v[48:51], v[28:31], v[116:131]
  s_waitcnt lgkmcnt(0)
  s_barrier
  v_add_u32 v12, 49152, v12
  v_add_u32 v13, 49152, v13
  v_add_u32 v14, 49152, v14
  v_add_u32 v15, 49152, v15
  v_add_u32 v16, 49152, v16
  v_add_u32 v17, 49152, v17
  v_add_u32 v18, 49152, v18
  v_add_u32 v19, 49152, v19
  ds_read_b128 v[28:31], v16
  ds_read_b64_tr_b16 v[36:37], v12 offset:0
  ds_read_b64_tr_b16 v[38:39], v12 offset:2048
  ds_read_b64_tr_b16 v[40:41], v13 offset:0
  ds_read_b64_tr_b16 v[42:43], v13 offset:2048
  ds_read_b64_tr_b16 v[44:45], v14 offset:0
  ds_read_b64_tr_b16 v[46:47], v14 offset:2048
  ds_read_b64_tr_b16 v[48:49], v15 offset:0
  ds_read_b64_tr_b16 v[50:51], v15 offset:2048
  v_mfma_f32_32x32x16_bf16 v[68:83], v[52:55], v[32:35], v[68:83]
  v_mfma_f32_32x32x16_bf16 v[84:99], v[56:59], v[32:35], v[84:99]
  v_mfma_f32_32x32x16_bf16 v[100:115], v[60:63], v[32:35], v[100:115]
  v_mfma_f32_32x32x16_bf16 v[116:131], v[64:67], v[32:35], v[116:131]
  ds_read_b128 v[32:35], v17
  ds_read_b64_tr_b16 v[52:53], v12 offset:8192
  ds_read_b64_tr_b16 v[54:55], v12 offset:10240
  ds_read_b64_tr_b16 v[56:57], v13 offset:8192
  ds_read_b64_tr_b16 v[58:59], v13 offset:10240
  ds_read_b64_tr_b16 v[60:61], v14 offset:8192
  ds_read_b64_tr_b16 v[62:63], v14 offset:10240
  ds_read_b64_tr_b16 v[64:65], v15 offset:8192
  ds_read_b64_tr_b16 v[66:67], v15 offset:10240
  s_waitcnt lgkmcnt(9)
  v_mfma_f32_32x32x16_bf16 v[68:83], v[36:39], v[28:31], v[68:83]
  v_mfma_f32_32x32x16_bf16 v[84:99], v[40:43], v[28:31], v[84:99]
  v_mfma_f32_32x32x16_bf16 v[100:115], v[44:47], v[28:31], v[100:115]
  v_mfma_f32_32x32x16_bf16 v[116:131], v[48:51], v[28:31], v[116:131]
  ds_read_b128 v[28:31], v18
  ds_read_b64_tr_b16 v[36:37], v12 offset:16384
  ds_read_b64_tr_b16 v[38:39], v12 offset:18432
  ds_read_b64_tr_b16 v[40:41], v13 offset:16384
  ds_read_b64_tr_b16 v[42:43], v13 offset:18432
  ds_read_b64_tr_b16 v[44:45], v14 offset:16384
  ds_read_b64_tr_b16 v[46:47], v14 offset:18432
  ds_read_b64_tr_b16 v[48:49], v15 offset:16384
  ds_read_b64_tr_b16 v[50:51], v15 offset:18432
  s_waitcnt lgkmcnt(9)
  v_mfma_f32_32x32x16_bf16 v[68:83], v[52:55], v[32:35], v[68:83]
  v_mfma_f32_32x32x16_bf16 v[84:99], v[56:59], v[32:35], v[84:99]
  v_mfma_f32_32x32x16_bf16 v[100:115], v[60:63], v[32:35], v[100:115]
  v_mfma_f32_32x32x16_bf16 v[116:131], v[64:67], v[32:35], v[116:131]
  ds_read_b128 v[32:35], v19
  ds_read_b64_tr_b16 v[52:53], v12 offset:24576
  ds_read_b64_tr_b16 v[54:55], v12 offset:26624
  ds_read_b64_tr_b16 v[56:57], v13 offset:24576
  ds_read_b64_tr_b16 v[58:59], v13 offset:26624
  ds_read_b64_tr_b16 v[60:61], v14 offset:24576
  ds_read_b64_tr_b16 v[62:63], v14 offset:26624
  ds_read_b64_tr_b16 v[64:65], v15 offset:24576
  ds_read_b64_tr_b16 v[66:67], v15 offset:26624
  s_waitcnt lgkmcnt(9)
  v_mfma_f32_32x32x16_bf16 v[68:83], v[36:39], v[28:31], v[68:83]
  v_mfma_f32_32x32x16_bf16 v[84:99], v[40:43], v[28:31], v[84:99]
  v_mfma_f32_32x32x16_bf16 v[100:115], v[44:47], v[28:31], v[100:115]
  v_mfma_f32_32x32x16_bf16 v[116:131], v[48:51], v[28:31], v[116:131]
  s_waitcnt lgkmcnt(0)
  s_barrier
  v_add_u32 v12, 49152, v12
  v_add_u32 v13, 49152, v13
  v_add_u32 v14, 49152, v14
  v_add_u32 v15, 49152, v15
  v_add_u32 v16, 49152, v16
  v_add_u32 v17, 49152, v17
  v_add_u32 v18, 49152, v18
  v_add_u32 v19, 49152, v19
  ds_read_b128 v[28:31], v16
  ds_read_b64_tr_b16 v[36:37], v12 offset:0
  ds_read_b64_tr_b16 v[38:39], v12 offset:2048
  ds_read_b64_tr_b16 v[40:41], v13 offset:0
  ds_read_b64_tr_b16 v[42:43], v13 offset:2048
  ds_read_b64_tr_b16 v[44:45], v14 offset:0
  ds_read_b64_tr_b16 v[46:47], v14 offset:2048
  ds_read_b64_tr_b16 v[48:49], v15 offset:0
  ds_read_b64_tr_b16 v[50:51], v15 offset:2048
  v_mfma_f32_32x32x16_bf16 v[68:83], v[52:55], v[32:35], v[68:83]
  v_mfma_f32_32x32x16_bf16 v[84:99], v[56:59], v[32:35], v[84:99]
  v_mfma_f32_32x32x16_bf16 v[100:115], v[60:63], v[32:35], v[100:115]
  v_mfma_f32_32x32x16_bf16 v[116:131], v[64:67], v[32:35], v[116:131]
  ds_read_b128 v[32:35], v17
  ds_read_b64_tr_b16 v[52:53], v12 offset:8192
  ds_read_b64_tr_b16 v[54:55], v12 offset:10240
  ds_read_b64_tr_b16 v[56:57], v13 offset:8192
  ds_read_b64_tr_b16 v[58:59], v13 offset:10240
  ds_read_b64_tr_b16 v[60:61], v14 offset:8192
  ds_read_b64_tr_b16 v[62:63], v14 offset:10240
  ds_read_b64_tr_b16 v[64:65], v15 offset:8192
  ds_read_b64_tr_b16 v[66:67], v15 offset:10240
  s_waitcnt lgkmcnt(9)
  v_mfma_f32_32x32x16_bf16 v[68:83], v[36:39], v[28:31], v[68:83]
  v_mfma_f32_32x32x16_bf16 v[84:99], v[40:43], v[28:31], v[84:99]
  v_mfma_f32_32x32x16_bf16 v[100:115], v[44:47], v[28:31], v[100:115]
  v_mfma_f32_32x32x16_bf16 v[116:131], v[48:51], v[28:31], v[116:131]
  ds_read_b128 v[28:31], v18
  ds_read_b64_tr_b16 v[36:37], v12 offset:16384
  ds_read_b64_tr_b16 v[38:39], v12 offset:18432
  ds_read_b64_tr_b16 v[40:41], v13 offset:16384
  ds_read_b64_tr_b16 v[42:43], v13 offset:18432
  ds_read_b64_tr_b16 v[44:45], v14 offset:16384
  ds_read_b64_tr_b16 v[46:47], v14 offset:18432
  ds_read_b64_tr_b16 v[48:49], v15 offset:16384
  ds_read_b64_tr_b16 v[50:51], v15 offset:18432
  s_waitcnt lgkmcnt(9)
  v_mfma_f32_32x32x16_bf16 v[68:83], v[52:55], v[32:35], v[68:83]
  v_mfma_f32_32x32x16_bf16 v[84:99], v[56:59], v[32:35], v[84:99]
  v_mfma_f32_32x32x16_bf16 v[100:115], v[60:63], v[32:35], v[100:115]
  v_mfma_f32_32x32x16_bf16 v[116:131], v[64:67], v[32:35], v[116:131]
  ds_read_b128 v[32:35], v19
  ds_read_b64_tr_b16 v[52:53], v12 offset:24576
  ds_read_b64_tr_b16 v[54:55], v12 offset:26624
  ds_read_b64_tr_b16 v[56:57], v13 offset:24576
  ds_read_b64_tr_b16 v[58:59], v13 offset:26624
  ds_read_b64_tr_b16 v[60:61], v14 offset:24576
  ds_read_b64_tr_b16 v[62:63], v14 offset:26624
  ds_read_b64_tr_b16 v[64:65], v15 offset:24576
  ds_read_b64_tr_b16 v[66:67], v15 offset:26624
  s_waitcnt lgkmcnt(9)
  v_mfma_f32_32x32x16_bf16 v[68:83], v[36:39], v[28:31], v[68:83]
  v_mfma_f32_32x32x16_bf16 v[84:99], v[40:43], v[28:31], v[84:99]
  v_mfma_f32_32x32x16_bf16 v[100:115], v[44:47], v[28:31], v[100:115]
  v_mfma_f32_32x32x16_bf16 v[116:131], v[48:51], v[28:31], v[116:131]
  s_waitcnt lgkmcnt(0)
  s_cmp_eq_u32 s38, 2
  s_cbranch_scc1 gated_mix__linear_attn_block__mha_block__prompt_kernel_g00_last
  s_barrier
  v_add_u32 v12, 4294868992, v12
  v_add_u32 v13, 4294868992, v13
  v_add_u32 v14, 4294868992, v14
  v_add_u32 v15, 4294868992, v15
  v_add_u32 v16, 4294868992, v16
  v_add_u32 v17, 4294868992, v17
  v_add_u32 v18, 4294868992, v18
  v_add_u32 v19, 4294868992, v19
  s_add_u32 s38, s38, 1
  ds_read_b128 v[28:31], v16
  ds_read_b64_tr_b16 v[36:37], v12 offset:0
  ds_read_b64_tr_b16 v[38:39], v12 offset:2048
  ds_read_b64_tr_b16 v[40:41], v13 offset:0
  ds_read_b64_tr_b16 v[42:43], v13 offset:2048
  ds_read_b64_tr_b16 v[44:45], v14 offset:0
  ds_read_b64_tr_b16 v[46:47], v14 offset:2048
  ds_read_b64_tr_b16 v[48:49], v15 offset:0
  ds_read_b64_tr_b16 v[50:51], v15 offset:2048
  v_mfma_f32_32x32x16_bf16 v[68:83], v[52:55], v[32:35], v[68:83]
  v_mfma_f32_32x32x16_bf16 v[84:99], v[56:59], v[32:35], v[84:99]
  v_mfma_f32_32x32x16_bf16 v[100:115], v[60:63], v[32:35], v[100:115]
  v_mfma_f32_32x32x16_bf16 v[116:131], v[64:67], v[32:35], v[116:131]
  s_branch gated_mix__linear_attn_block__mha_block__prompt_kernel_g00_loop
gated_mix__linear_attn_block__mha_block__prompt_kernel_g00_last:
  s_barrier
  v_mfma_f32_32x32x16_bf16 v[68:83], v[52:55], v[32:35], v[68:83]
  v_mfma_f32_32x32x16_bf16 v[84:99], v[56:59], v[32:35], v[84:99]
  v_mfma_f32_32x32x16_bf16 v[100:115], v[60:63], v[32:35], v[100:115]
  v_mfma_f32_32x32x16_bf16 v[116:131], v[64:67], v[32:35], v[116:131]
  s_nop 15
  s_nop 3
  s_mov_b32 s78, 1069066811
  s_mov_b32 s79, 1069066811
  s_mov_b32 s76, 897988541
  s_mov_b32 s77, 897988541
  v_cmp_gt_u32 vcc, 32, v1
  v_mov_b32 v7, 2130706432
  s_lshr_b32 s28, s27, 3
  s_mul_i32 s28, s28, 19456
  s_add_u32 s28, s28, 2359296
  v_cndmask_b32 v7, v7, v23, vcc
  s_and_b32 s29, s27, 7
  s_lshl_b32 s30, s29, 10
  s_add_u32 s80, s28, s30
  s_lshl_b32 s30, s29, 7
  s_add_u32 s81, s28, s30
  s_add_u32 s81, s81, 8192
  s_mul_i32 s82, s42, 12
  s_mov_b32 s74, 1051597459
  s_mov_b32 s75, 1051597459
  s_cmp_eq_u32 s42, 2
  s_cbranch_scc1 gated_mix__linear_attn_block__mha_block__prompt_kernel_e00_k2
  s_cmp_eq_u32 s42, 5
  s_cbranch_scc1 gated_mix__linear_attn_block__mha_block__prompt_kernel_e00_k5
  s_cmp_gt_u32 s42, 5
  s_cbranch_scc1 gated_mix__linear_attn_block__mha_block__prompt_kernel_e00_k6
  s_cmp_gt_u32 s42, 2
  s_cbranch_scc1 gated_mix__linear_attn_block__mha_block__prompt_kernel_e00_k3
  s_add_u32 s64, s82, 0
  s_and_b32 s64, s64, 31
  s_lshl_b32 s28, s64, 6
  s_add_u32 s32, s28, s27
  v_pk_mul_f32 v[68:69], v[68:69], s[74:75]
  v_pk_mul_f32 v[70:71], v[70:71], s[74:75]
  v_pk_mul_f32 v[72:73], v[72:73], s[74:75]
  v_pk_mul_f32 v[74:75], v[74:75], s[74:75]
  s_lshl_b32 s65, s32, 10
  s_add_u32 s65, s65, 0
  v_cvt_pk_bf16_f32 v68, v68, v69
  v_cvt_pk_bf16_f32 v69, v70, v71
  v_cvt_pk_bf16_f32 v70, v72, v73
  v_cvt_pk_bf16_f32 v71, v74, v75
  buffer_store_dwordx4 v[68:71], v20, s[12:15], s65 offen sc1
  s_add_u32 s64, s82, 11
  s_and_b32 s64, s64, 31
  s_lshl_b32 s28, s64, 6
  s_add_u32 s32, s28, s27
  v_pk_mul_f32 v[76:77], v[76:77], s[74:75]
  v_pk_mul_f32 v[78:79], v[78:79], s[74:75]
  v_pk_mul_f32 v[80:81], v[80:81], s[74:75]
  v_pk_mul_f32 v[82:83], v[82:83], s[74:75]
  s_lshl_b32 s65, s32, 10
  s_add_u32 s65, s65, 0
  v_cvt_pk_bf16_f32 v76, v76, v77
  v_cvt_pk_bf16_f32 v77, v78, v79
  v_cvt_pk_bf16_f32 v78, v80, v81
  v_cvt_pk_bf16_f32 v79, v82, v83
  buffer_store_dwordx4 v[76:79], v20, s[12:15], s65 offen sc1
  s_add_u32 s64, s82, 2
  s_and_b32 s64, s64, 31
  s_lshl_b32 s28, s64, 6
  s_add_u32 s32, s28, s27
  v_pk_mul_f32 v[84:85], v[84:85], s[74:75]
  v_pk_mul_f32 v[86:87], v[86:87], s[74:75]
  v_pk_mul_f32 v[88:89], v[88:89], s[74:75]
  v_pk_mul_f32 v[90:91], v[90:91], s[74:75]
  s_lshl_b32 s65, s32, 10
  s_add_u32 s65, s65, 0
  v_cvt_pk_bf16_f32 v84, v84, v85
  v_cvt_pk_bf16_f32 v85, v86, v87
  v_cvt_pk_bf16_f32 v86, v88, v89
  v_cvt_pk_bf16_f32 v87, v90, v91
  buffer_store_dwordx4 v[84:87], v20, s[12:15], s65 offen sc1
  s_add_u32 s64, s82, 1
  s_and_b32 s64, s64, 31
  s_lshl_b32 s28, s64, 6
  s_add_u32 s32, s28, s27
  v_pk_mul_f32 v[92:93], v[92:93], s[74:75]
  v_pk_mul_f32 v[94:95], v[94:95], s[74:75]
  v_pk_mul_f32 v[96:97], v[96:97], s[74:75]
  v_pk_mul_f32 v[98:99], v[98:99], s[74:75]
  s_lshl_b32 s65, s32, 10
  s_add_u32 s65, s65, 0
  v_cvt_pk_bf16_f32 v92, v92, v93
  v_cvt_pk_bf16_f32 v93, v94, v95
  v_cvt_pk_bf16_f32 v94, v96, v97
  v_cvt_pk_bf16_f32 v95, v98, v99
  buffer_store_dwordx4 v[92:95], v20, s[12:15], s65 offen sc1
  s_add_u32 s64, s82, 4
  s_and_b32 s64, s64, 31
  s_lshl_b32 s28, s64, 6
  s_add_u32 s32, s28, s27
  v_pk_mul_f32 v[100:101], v[100:101], s[74:75]
  v_pk_mul_f32 v[102:103], v[102:103], s[74:75]
  v_pk_mul_f32 v[104:105], v[104:105], s[74:75]
  v_pk_mul_f32 v[106:107], v[106:107], s[74:75]
  s_lshl_b32 s65, s32, 10
  s_add_u32 s65, s65, 0
  v_cvt_pk_bf16_f32 v100, v100, v101
  v_cvt_pk_bf16_f32 v101, v102, v103
  v_cvt_pk_bf16_f32 v102, v104, v105
  v_cvt_pk_bf16_f32 v103, v106, v107
  buffer_store_dwordx4 v[100:103], v20, s[12:15], s65 offen sc1
  s_add_u32 s64, s82, 3
  s_and_b32 s64, s64, 31
  s_lshl_b32 s28, s64, 6
  s_add_u32 s32, s28, s27
  v_pk_mul_f32 v[108:109], v[108:109], s[74:75]
  v_pk_mul_f32 v[110:111], v[110:111], s[74:75]
  v_pk_mul_f32 v[112:113], v[112:113], s[74:75]
  v_pk_mul_f32 v[114:115], v[114:115], s[74:75]
  s_lshl_b32 s65, s32, 10
  s_add_u32 s65, s65, 0
  v_cvt_pk_bf16_f32 v108, v108, v109
  v_cvt_pk_bf16_f32 v109, v110, v111
  v_cvt_pk_bf16_f32 v110, v112, v113
  v_cvt_pk_bf16_f32 v111, v114, v115
  buffer_store_dwordx4 v[108:111], v20, s[12:15], s65 offen sc1
  s_add_u32 s64, s82, 6
  s_and_b32 s64, s64, 31
  s_lshl_b32 s28, s64, 6
  s_add_u32 s32, s28, s27
  v_pk_mul_f32 v[116:117], v[116:117], s[74:75]
  v_pk_mul_f32 v[118:119], v[118:119], s[74:75]
  v_pk_mul_f32 v[120:121], v[120:121], s[74:75]
  v_pk_mul_f32 v[122:123], v[122:123], s[74:75]
  s_lshl_b32 s65, s32, 10
  s_add_u32 s65, s65, 0
  v_cvt_pk_bf16_f32 v116, v116, v117
  v_cvt_pk_bf16_f32 v117, v118, v119
  v_cvt_pk_bf16_f32 v118, v120, v121
  v_cvt_pk_bf16_f32 v119, v122, v123
  buffer_store_dwordx4 v[116:119], v20, s[12:15], s65 offen sc1
  s_add_u32 s64, s82, 5
  s_and_b32 s64, s64, 31
  s_lshl_b32 s28, s64, 6
  s_add_u32 s32, s28, s27
  v_pk_mul_f32 v[124:125], v[124:125], s[74:75]
  v_pk_mul_f32 v[126:127], v[126:127], s[74:75]
  v_pk_mul_f32 v[128:129], v[128:129], s[74:75]
  v_pk_mul_f32 v[130:131], v[130:131], s[74:75]
  s_lshl_b32 s65, s32, 10
  s_add_u32 s65, s65, 0
  v_cvt_pk_bf16_f32 v124, v124, v125
  v_cvt_pk_bf16_f32 v125, v126, v127
  v_cvt_pk_bf16_f32 v126, v128, v129
  v_cvt_pk_bf16_f32 v127, v130, v131
  buffer_store_dwordx4 v[124:127], v20, s[12:15], s65 offen sc1
  s_branch gated_mix__linear_attn_block__mha_block__prompt_kernel_e00_kd
gated_mix__linear_attn_block__mha_block__prompt_kernel_e00_k2:
  s_add_u32 s64, s82, 0
  s_and_b32 s64, s64, 31
  s_lshl_b32 s28, s64, 6
  s_add_u32 s32, s28, s27
  v_pk_mul_f32 v[68:69], v[68:69], s[74:75]
  v_pk_mul_f32 v[70:71], v[70:71], s[74:75]
  v_pk_mul_f32 v[72:73], v[72:73], s[74:75]
  v_pk_mul_f32 v[74:75], v[74:75], s[74:75]
  s_lshl_b32 s65, s32, 10
  s_add_u32 s65, s65, 0
  v_cvt_pk_bf16_f32 v68, v68, v69
  v_cvt_pk_bf16_f32 v69, v70, v71
  v_cvt_pk_bf16_f32 v70, v72, v73
  v_cvt_pk_bf16_f32 v71, v74, v75
  buffer_store_dwordx4 v[68:71], v20, s[12:15], s65 offen sc1
  s_add_u32 s64, s82, 11
  s_and_b32 s64, s64, 31
  s_lshl_b32 s28, s64, 6
  s_add_u32 s32, s28, s27
  v_mul_f32 v132, v76, v76
  v_fmac_f32 v132, v77, v77
  v_fmac_f32 v132, v78, v78
  v_fmac_f32 v132, v79, v79
  v_fmac_f32 v132, v80, v80
  v_fmac_f32 v132, v81, v81
  v_fmac_f32 v132, v82, v82
  v_fmac_f32 v132, v83, v83
  v_mov_b32 v134, v132
  s_lshl_b32 s29, s32, 7
  s_add_u32 s29, s29, 19687424
  v_permlane32_swap_b32 v132, v134
  s_mul_i32 s65, s64, 155648
  s_add_u32 s65, s65, s80
  v_add_f32 v132, v132, v134
  buffer_store_dword v132, v7, s[12:15], s29 offen sc1
  v_cvt_pk_bf16_f32 v76, v76, v77
  v_cvt_pk_bf16_f32 v77, v78, v79
  v_cvt_pk_bf16_f32 v78, v80, v81
  v_cvt_pk_bf16_f32 v79, v82, v83
  buffer_store_dwordx4 v[76:79], v20, s[12:15], s65 offen sc1
  s_add_u32 s64, s82, 2
  s_and_b32 s64, s64, 31
  s_lshl_b32 s28, s64, 6
  s_add_u32 s32, s28, s27
  v_pk_mul_f32 v[84:85], v[84:85], s[74:75]
  v_pk_mul_f32 v[86:87], v[86:87], s[74:75]
  v_pk_mul_f32 v[88:89], v[88:89], s[74:75]
  v_pk_mul_f32 v[90:91], v[90:91], s[74:75]
  s_lshl_b32 s65, s32, 10
  s_add_u32 s65, s65, 0
  v_cvt_pk_bf16_f32 v84, v84, v85
  v_cvt_pk_bf16_f32 v85, v86, v87
  v_cvt_pk_bf16_f32 v86, v88, v89
  v_cvt_pk_bf16_f32 v87, v90, v91
  buffer_store_dwordx4 v[84:87], v20, s[12:15], s65 offen sc1
  s_add_u32 s64, s82, 1
  s_and_b32 s64, s64, 31
  s_lshl_b32 s28, s64, 6
  s_add_u32 s32, s28, s27
  v_pk_mul_f32 v[92:93], v[92:93], s[74:75]
  v_pk_mul_f32 v[94:95], v[94:95], s[74:75]
  v_pk_mul_f32 v[96:97], v[96:97], s[74:75]
  v_pk_mul_f32 v[98:99], v[98:99], s[74:75]
  s_lshl_b32 s65, s32, 10
  s_add_u32 s65, s65, 0
  v_cvt_pk_bf16_f32 v92, v92, v93
  v_cvt_pk_bf16_f32 v93, v94, v95
  v_cvt_pk_bf16_f32 v94, v96, v97
  v_cvt_pk_bf16_f32 v95, v98, v99
  buffer_store_dwordx4 v[92:95], v20, s[12:15], s65 offen sc1
  s_add_u32 s64, s82, 4
  s_and_b32 s64, s64, 31
  s_lshl_b32 s28, s64, 6
  s_add_u32 s32, s28, s27
  v_pk_mul_f32 v[100:101], v[100:101], s[74:75]
  v_pk_mul_f32 v[102:103], v[102:103], s[74:75]
  v_pk_mul_f32 v[104:105], v[104:105], s[74:75]
  v_pk_mul_f32 v[106:107], v[106:107], s[74:75]
  s_lshl_b32 s65, s32, 10
  s_add_u32 s65, s65, 0
  v_cvt_pk_bf16_f32 v100, v100, v101
  v_cvt_pk_bf16_f32 v101, v102, v103
  v_cvt_pk_bf16_f32 v102, v104, v105
  v_cvt_pk_bf16_f32 v103, v106, v107
  buffer_store_dwordx4 v[100:103], v20, s[12:15], s65 offen sc1
  s_add_u32 s64, s82, 3
  s_and_b32 s64, s64, 31
  s_lshl_b32 s28, s64, 6
  s_add_u32 s32, s28, s27
  v_pk_mul_f32 v[108:109], v[108:109], s[74:75]
  v_pk_mul_f32 v[110:111], v[110:111], s[74:75]
  v_pk_mul_f32 v[112:113], v[112:113], s[74:75]
  v_pk_mul_f32 v[114:115], v[114:115], s[74:75]
  s_lshl_b32 s65, s32, 10
  s_add_u32 s65, s65, 0
  v_cvt_pk_bf16_f32 v108, v108, v109
  v_cvt_pk_bf16_f32 v109, v110, v111
  v_cvt_pk_bf16_f32 v110, v112, v113
  v_cvt_pk_bf16_f32 v111, v114, v115
  buffer_store_dwordx4 v[108:111], v20, s[12:15], s65 offen sc1
  s_add_u32 s64, s82, 6
  s_and_b32 s64, s64, 31
  s_lshl_b32 s28, s64, 6
  s_add_u32 s32, s28, s27
  v_pk_mul_f32 v[116:117], v[116:117], s[74:75]
  v_pk_mul_f32 v[118:119], v[118:119], s[74:75]
  v_pk_mul_f32 v[120:121], v[120:121], s[74:75]
  v_pk_mul_f32 v[122:123], v[122:123], s[74:75]
  s_lshl_b32 s65, s32, 10
  s_add_u32 s65, s65, 0
  v_cvt_pk_bf16_f32 v116, v116, v117
  v_cvt_pk_bf16_f32 v117, v118, v119
  v_cvt_pk_bf16_f32 v118, v120, v121
  v_cvt_pk_bf16_f32 v119, v122, v123
  buffer_store_dwordx4 v[116:119], v20, s[12:15], s65 offen sc1
  s_add_u32 s64, s82, 5
  s_and_b32 s64, s64, 31
  s_lshl_b32 s28, s64, 6
  s_add_u32 s32, s28, s27
  v_pk_mul_f32 v[124:125], v[124:125], s[74:75]
  v_pk_mul_f32 v[126:127], v[126:127], s[74:75]
  v_pk_mul_f32 v[128:129], v[128:129], s[74:75]
  v_pk_mul_f32 v[130:131], v[130:131], s[74:75]
  s_lshl_b32 s65, s32, 10
  s_add_u32 s65, s65, 0
  v_cvt_pk_bf16_f32 v124, v124, v125
  v_cvt_pk_bf16_f32 v125, v126, v127
  v_cvt_pk_bf16_f32 v126, v128, v129
  v_cvt_pk_bf16_f32 v127, v130, v131
  buffer_store_dwordx4 v[124:127], v20, s[12:15], s65 offen sc1
  s_branch gated_mix__linear_attn_block__mha_block__prompt_kernel_e00_kd
gated_mix__linear_attn_block__mha_block__prompt_kernel_e00_k3:
  s_add_u32 s64, s82, 0
  s_and_b32 s64, s64, 31
  s_lshl_b32 s28, s64, 6
  s_add_u32 s32, s28, s27
  v_mul_f32 v132, v68, v68
  v_fmac_f32 v132, v69, v69
  v_fmac_f32 v132, v70, v70
  v_fmac_f32 v132, v71, v71
  v_fmac_f32 v132, v72, v72
  v_fmac_f32 v132, v73, v73
  v_fmac_f32 v132, v74, v74
  v_fmac_f32 v132, v75, v75
  v_mov_b32 v134, v132
  s_lshl_b32 s29, s32, 7
  s_add_u32 s29, s29, 19687424
  v_permlane32_swap_b32 v132, v134
  s_mul_i32 s65, s64, 155648
  s_add_u32 s65, s65, s80
  v_add_f32 v132, v132, v134
  buffer_store_dword v132, v7, s[12:15], s29 offen sc1
  v_cvt_pk_bf16_f32 v68, v68, v69
  v_cvt_pk_bf16_f32 v69, v70, v71
  v_cvt_pk_bf16_f32 v70, v72, v73
  v_cvt_pk_bf16_f32 v71, v74, v75
  buffer_store_dwordx4 v[68:71], v20, s[12:15], s65 offen sc1
  s_add_u32 s64, s82, 11
  s_and_b32 s64, s64, 31
  s_lshl_b32 s28, s64, 6
  s_add_u32 s32, s28, s27
  v_mul_f32 v132, v76, v76
  v_fmac_f32 v132, v77, v77
  v_fmac_f32 v132, v78, v78
  v_fmac_f32 v132, v79, v79
  v_fmac_f32 v132, v80, v80
  v_fmac_f32 v132, v81, v81
  v_fmac_f32 v132, v82, v82
  v_fmac_f32 v132, v83, v83
  v_mov_b32 v134, v132
  s_lshl_b32 s29, s32, 7
  s_add_u32 s29, s29, 19687424
  v_permlane32_swap_b32 v132, v134
  s_mul_i32 s65, s64, 155648
  s_add_u32 s65, s65, s80
  v_add_f32 v132, v132, v134
  buffer_store_dword v132, v7, s[12:15], s29 offen sc1
  v_cvt_pk_bf16_f32 v76, v76, v77
  v_cvt_pk_bf16_f32 v77, v78, v79
  v_cvt_pk_bf16_f32 v78, v80, v81
  v_cvt_pk_bf16_f32 v79, v82, v83
  buffer_store_dwordx4 v[76:79], v20, s[12:15], s65 offen sc1
  s_add_u32 s64, s82, 2
  s_and_b32 s64, s64, 31
  s_lshl_b32 s28, s64, 6
  s_add_u32 s32, s28, s27
  v_mul_f32 v132, v84, v84
  v_fmac_f32 v132, v85, v85
  v_fmac_f32 v132, v86, v86
  v_fmac_f32 v132, v87, v87
  v_fmac_f32 v132, v88, v88
  v_fmac_f32 v132, v89, v89
  v_fmac_f32 v132, v90, v90
  v_fmac_f32 v132, v91, v91
  v_mov_b32 v134, v132
  s_lshl_b32 s29, s32, 7
  s_add_u32 s29, s29, 19687424
  v_permlane32_swap_b32 v132, v134
  s_mul_i32 s65, s64, 155648
  s_add_u32 s65, s65, s80
  v_add_f32 v132, v132, v134
  buffer_store_dword v132, v7, s[12:15], s29 offen sc1
  v_cvt_pk_bf16_f32 v84, v84, v85
  v_cvt_pk_bf16_f32 v85, v86, v87
  v_cvt_pk_bf16_f32 v86, v88, v89
  v_cvt_pk_bf16_f32 v87, v90, v91
  buffer_store_dwordx4 v[84:87], v20, s[12:15], s65 offen sc1
  s_add_u32 s64, s82, 1
  s_and_b32 s64, s64, 31
  s_lshl_b32 s28, s64, 6
  s_add_u32 s32, s28, s27
  v_mul_f32 v132, v92, v92
  v_fmac_f32 v132, v93, v93
  v_fmac_f32 v132, v94, v94
  v_fmac_f32 v132, v95, v95
  v_fmac_f32 v132, v96, v96
  v_fmac_f32 v132, v97, v97
  v_fmac_f32 v132, v98, v98
  v_fmac_f32 v132, v99, v99
  v_mov_b32 v134, v132
  s_lshl_b32 s29, s32, 7
  s_add_u32 s29, s29, 19687424
  v_permlane32_swap_b32 v132, v134
  s_mul_i32 s65, s64, 155648
  s_add_u32 s65, s65, s80
  v_add_f32 v132, v132, v134
  buffer_store_dword v132, v7, s[12:15], s29 offen sc1
  v_cvt_pk_bf16_f32 v92, v92, v93
  v_cvt_pk_bf16_f32 v93, v94, v95
  v_cvt_pk_bf16_f32 v94, v96, v97
  v_cvt_pk_bf16_f32 v95, v98, v99
  buffer_store_dwordx4 v[92:95], v20, s[12:15], s65 offen sc1
  s_add_u32 s64, s82, 4
  s_and_b32 s64, s64, 31
  s_lshl_b32 s28, s64, 6
  s_add_u32 s32, s28, s27
  v_mul_f32 v132, v100, v100
  v_fmac_f32 v132, v101, v101
  v_fmac_f32 v132, v102, v102
  v_fmac_f32 v132, v103, v103
  v_fmac_f32 v132, v104, v104
  v_fmac_f32 v132, v105, v105
  v_fmac_f32 v132, v106, v106
  v_fmac_f32 v132, v107, v107
  v_mov_b32 v134, v132
  s_lshl_b32 s29, s32, 7
  s_add_u32 s29, s29, 19687424
  v_permlane32_swap_b32 v132, v134
  s_mul_i32 s65, s64, 155648
  s_add_u32 s65, s65, s80
  v_add_f32 v132, v132, v134
  buffer_store_dword v132, v7, s[12:15], s29 offen sc1
  v_cvt_pk_bf16_f32 v100, v100, v101
  v_cvt_pk_bf16_f32 v101, v102, v103
  v_cvt_pk_bf16_f32 v102, v104, v105
  v_cvt_pk_bf16_f32 v103, v106, v107
  buffer_store_dwordx4 v[100:103], v20, s[12:15], s65 offen sc1
  s_add_u32 s64, s82, 3
  s_and_b32 s64, s64, 31
  s_lshl_b32 s28, s64, 6
  s_add_u32 s32, s28, s27
  v_mul_f32 v132, v108, v108
  v_fmac_f32 v132, v109, v109
  v_fmac_f32 v132, v110, v110
  v_fmac_f32 v132, v111, v111
  v_fmac_f32 v132, v112, v112
  v_fmac_f32 v132, v113, v113
  v_fmac_f32 v132, v114, v114
  v_fmac_f32 v132, v115, v115
  v_mov_b32 v134, v132
  s_lshl_b32 s29, s32, 7
  s_add_u32 s29, s29, 19687424
  v_permlane32_swap_b32 v132, v134
  s_mul_i32 s65, s64, 155648
  s_add_u32 s65, s65, s80
  v_add_f32 v132, v132, v134
  buffer_store_dword v132, v7, s[12:15], s29 offen sc1
  v_cvt_pk_bf16_f32 v108, v108, v109
  v_cvt_pk_bf16_f32 v109, v110, v111
  v_cvt_pk_bf16_f32 v110, v112, v113
  v_cvt_pk_bf16_f32 v111, v114, v115
  buffer_store_dwordx4 v[108:111], v20, s[12:15], s65 offen sc1
  s_add_u32 s64, s82, 6
  s_and_b32 s64, s64, 31
  s_lshl_b32 s28, s64, 6
  s_add_u32 s32, s28, s27
  v_mul_f32 v132, v116, v116
  v_fmac_f32 v132, v117, v117
  v_fmac_f32 v132, v118, v118
  v_fmac_f32 v132, v119, v119
  v_fmac_f32 v132, v120, v120
  v_fmac_f32 v132, v121, v121
  v_fmac_f32 v132, v122, v122
  v_fmac_f32 v132, v123, v123
  v_mov_b32 v134, v132
  s_lshl_b32 s29, s32, 7
  s_add_u32 s29, s29, 19687424
  v_permlane32_swap_b32 v132, v134
  s_mul_i32 s65, s64, 155648
  s_add_u32 s65, s65, s80
  v_add_f32 v132, v132, v134
  buffer_store_dword v132, v7, s[12:15], s29 offen sc1
  v_cvt_pk_bf16_f32 v116, v116, v117
  v_cvt_pk_bf16_f32 v117, v118, v119
  v_cvt_pk_bf16_f32 v118, v120, v121
  v_cvt_pk_bf16_f32 v119, v122, v123
  buffer_store_dwordx4 v[116:119], v20, s[12:15], s65 offen sc1
  s_add_u32 s64, s82, 5
  s_and_b32 s64, s64, 31
  s_lshl_b32 s28, s64, 6
  s_add_u32 s32, s28, s27
  v_mul_f32 v132, v124, v124
  v_fmac_f32 v132, v125, v125
  v_fmac_f32 v132, v126, v126
  v_fmac_f32 v132, v127, v127
  v_fmac_f32 v132, v128, v128
  v_fmac_f32 v132, v129, v129
  v_fmac_f32 v132, v130, v130
  v_fmac_f32 v132, v131, v131
  v_mov_b32 v134, v132
  s_lshl_b32 s29, s32, 7
  s_add_u32 s29, s29, 19687424
  v_permlane32_swap_b32 v132, v134
  s_mul_i32 s65, s64, 155648
  s_add_u32 s65, s65, s80
  v_add_f32 v132, v132, v134
  buffer_store_dword v132, v7, s[12:15], s29 offen sc1
  v_cvt_pk_bf16_f32 v124, v124, v125
  v_cvt_pk_bf16_f32 v125, v126, v127
  v_cvt_pk_bf16_f32 v126, v128, v129
  v_cvt_pk_bf16_f32 v127, v130, v131
  buffer_store_dwordx4 v[124:127], v20, s[12:15], s65 offen sc1
  s_branch gated_mix__linear_attn_block__mha_block__prompt_kernel_e00_kd
gated_mix__linear_attn_block__mha_block__prompt_kernel_e00_k5:
  s_add_u32 s64, s82, 0
  s_and_b32 s64, s64, 31
  s_lshl_b32 s28, s64, 6
  s_add_u32 s32, s28, s27
  v_mul_f32 v132, v68, v68
  v_fmac_f32 v132, v69, v69
  v_fmac_f32 v132, v70, v70
  v_fmac_f32 v132, v71, v71
  v_fmac_f32 v132, v72, v72
  v_fmac_f32 v132, v73, v73
  v_fmac_f32 v132, v74, v74
  v_fmac_f32 v132, v75, v75
  v_mov_b32 v134, v132
  s_lshl_b32 s29, s32, 7
  s_add_u32 s29, s29, 19687424
  v_permlane32_swap_b32 v132, v134
  s_mul_i32 s65, s64, 155648
  s_add_u32 s65, s65, s80
  v_add_f32 v132, v132, v134
  buffer_store_dword v132, v7, s[12:15], s29 offen sc1
  v_cvt_pk_bf16_f32 v68, v68, v69
  v_cvt_pk_bf16_f32 v69, v70, v71
  v_cvt_pk_bf16_f32 v70, v72, v73
  v_cvt_pk_bf16_f32 v71, v74, v75
  buffer_store_dwordx4 v[68:71], v20, s[12:15], s65 offen sc1
  s_add_u32 s64, s82, 11
  s_and_b32 s64, s64, 31
  s_lshl_b32 s28, s64, 6
  s_add_u32 s32, s28, s27
  v_pk_mul_f32 v[132:133], v[76:77], s[78:79]
  v_pk_mul_f32 v[134:135], v[78:79], s[78:79]
  v_pk_mul_f32 v[136:137], v[80:81], s[78:79]
  v_pk_mul_f32 v[138:139], v[82:83], s[78:79]
  v_exp_f32_e64 v132, v132 clamp
  v_exp_f32_e64 v133, v133 clamp
  v_exp_f32_e64 v134, v134 clamp
  v_exp_f32_e64 v135, v135 clamp
  v_exp_f32_e64 v136, v136 clamp
  v_exp_f32_e64 v137, v137 clamp
  v_exp_f32_e64 v138, v138 clamp
  v_exp_f32_e64 v139, v139 clamp
  v_max_f32 v76, 0, v76
  v_max_f32 v77, 0, v77
  v_max_f32 v78, 0, v78
  v_max_f32 v79, 0, v79
  v_max_f32 v80, 0, v80
  v_max_f32 v81, 0, v81
  v_max_f32 v82, 0, v82
  v_max_f32 v83, 0, v83
  v_pk_add_f32 v[132:133], v[132:133], s[76:77]
  v_pk_add_f32 v[134:135], v[134:135], s[76:77]
  v_pk_add_f32 v[136:137], v[136:137], s[76:77]
  v_pk_add_f32 v[138:139], v[138:139], s[76:77]
  v_pk_add_f32 v[76:77], v[76:77], v[132:133]
  v_pk_add_f32 v[78:79], v[78:79], v[134:135]
  v_pk_add_f32 v[80:81], v[80:81], v[136:137]
  v_pk_add_f32 v[82:83], v[82:83], v[138:139]
  s_lshl_b32 s65, s32, 10
  s_add_u32 s65, s65, 7340032
  v_cvt_pk_bf16_f32 v76, v76, v77
  v_cvt_pk_bf16_f32 v77, v78, v79
  v_cvt_pk_bf16_f32 v78, v80, v81
  v_cvt_pk_bf16_f32 v79, v82, v83
  buffer_store_dwordx4 v[76:79], v20, s[12:15], s65 offen sc1
  s_add_u32 s64, s82, 2
  s_and_b32 s64, s64, 31
  s_lshl_b32 s28, s64, 6
  s_add_u32 s32, s28, s27
  v_mul_f32 v132, v84, v84
  v_fmac_f32 v132, v85, v85
  v_fmac_f32 v132, v86, v86
  v_fmac_f32 v132, v87, v87
  v_fmac_f32 v132, v88, v88
  v_fmac_f32 v132, v89, v89
  v_fmac_f32 v132, v90, v90
  v_fmac_f32 v132, v91, v91
  v_mov_b32 v134, v132
  s_lshl_b32 s29, s32, 7
  s_add_u32 s29, s29, 19687424
  v_permlane32_swap_b32 v132, v134
  s_mul_i32 s65, s64, 155648
  s_add_u32 s65, s65, s80
  v_add_f32 v132, v132, v134
  buffer_store_dword v132, v7, s[12:15], s29 offen sc1
  v_cvt_pk_bf16_f32 v84, v84, v85
  v_cvt_pk_bf16_f32 v85, v86, v87
  v_cvt_pk_bf16_f32 v86, v88, v89
  v_cvt_pk_bf16_f32 v87, v90, v91
  buffer_store_dwordx4 v[84:87], v20, s[12:15], s65 offen sc1
  s_add_u32 s64, s82, 1
  s_and_b32 s64, s64, 31
  s_lshl_b32 s28, s64, 6
  s_add_u32 s32, s28, s27
  v_mul_f32 v132, v92, v92
  v_fmac_f32 v132, v93, v93
  v_fmac_f32 v132, v94, v94
  v_fmac_f32 v132, v95, v95
  v_fmac_f32 v132, v96, v96
  v_fmac_f32 v132, v97, v97
  v_fmac_f32 v132, v98, v98
  v_fmac_f32 v132, v99, v99
  v_mov_b32 v134, v132
  s_lshl_b32 s29, s32, 7
  s_add_u32 s29, s29, 19687424
  v_permlane32_swap_b32 v132, v134
  s_mul_i32 s65, s64, 155648
  s_add_u32 s65, s65, s80
  v_add_f32 v132, v132, v134
  buffer_store_dword v132, v7, s[12:15], s29 offen sc1
  v_cvt_pk_bf16_f32 v92, v92, v93
  v_cvt_pk_bf16_f32 v93, v94, v95
  v_cvt_pk_bf16_f32 v94, v96, v97
  v_cvt_pk_bf16_f32 v95, v98, v99
  buffer_store_dwordx4 v[92:95], v20, s[12:15], s65 offen sc1
  s_add_u32 s64, s82, 4
  s_and_b32 s64, s64, 31
  s_lshl_b32 s28, s64, 6
  s_add_u32 s32, s28, s27
  v_pk_mul_f32 v[132:133], v[100:101], s[78:79]
  v_pk_mul_f32 v[134:135], v[102:103], s[78:79]
  v_pk_mul_f32 v[136:137], v[104:105], s[78:79]
  v_pk_mul_f32 v[138:139], v[106:107], s[78:79]
  v_exp_f32_e64 v132, v132 clamp
  v_exp_f32_e64 v133, v133 clamp
  v_exp_f32_e64 v134, v134 clamp
  v_exp_f32_e64 v135, v135 clamp
  v_exp_f32_e64 v136, v136 clamp
  v_exp_f32_e64 v137, v137 clamp
  v_exp_f32_e64 v138, v138 clamp
  v_exp_f32_e64 v139, v139 clamp
  v_max_f32 v100, 0, v100
  v_max_f32 v101, 0, v101
  v_max_f32 v102, 0, v102
  v_max_f32 v103, 0, v103
  v_max_f32 v104, 0, v104
  v_max_f32 v105, 0, v105
  v_max_f32 v106, 0, v106
  v_max_f32 v107, 0, v107
  v_pk_add_f32 v[132:133], v[132:133], s[76:77]
  v_pk_add_f32 v[134:135], v[134:135], s[76:77]
  v_pk_add_f32 v[136:137], v[136:137], s[76:77]
  v_pk_add_f32 v[138:139], v[138:139], s[76:77]
  v_pk_add_f32 v[100:101], v[100:101], v[132:133]
  v_pk_add_f32 v[102:103], v[102:103], v[134:135]
  v_pk_add_f32 v[104:105], v[104:105], v[136:137]
  v_pk_add_f32 v[106:107], v[106:107], v[138:139]
  s_lshl_b32 s65, s32, 10
  s_add_u32 s65, s65, 7340032
  v_cvt_pk_bf16_f32 v100, v100, v101
  v_cvt_pk_bf16_f32 v101, v102, v103
  v_cvt_pk_bf16_f32 v102, v104, v105
  v_cvt_pk_bf16_f32 v103, v106, v107
  buffer_store_dwordx4 v[100:103], v20, s[12:15], s65 offen sc1
  s_add_u32 s64, s82, 3
  s_and_b32 s64, s64, 31
  s_lshl_b32 s28, s64, 6
  s_add_u32 s32, s28, s27
  v_mul_f32 v132, v108, v108
  v_fmac_f32 v132, v109, v109
  v_fmac_f32 v132, v110, v110
  v_fmac_f32 v132, v111, v111
  v_fmac_f32 v132, v112, v112
  v_fmac_f32 v132, v113, v113
  v_fmac_f32 v132, v114, v114
  v_fmac_f32 v132, v115, v115
  v_mov_b32 v134, v132
  s_lshl_b32 s29, s32, 7
  s_add_u32 s29, s29, 19687424
  v_permlane32_swap_b32 v132, v134
  s_mul_i32 s65, s64, 155648
  s_add_u32 s65, s65, s80
  v_add_f32 v132, v132, v134
  buffer_store_dword v132, v7, s[12:15], s29 offen sc1
  v_cvt_pk_bf16_f32 v108, v108, v109
  v_cvt_pk_bf16_f32 v109, v110, v111
  v_cvt_pk_bf16_f32 v110, v112, v113
  v_cvt_pk_bf16_f32 v111, v114, v115
  buffer_store_dwordx4 v[108:111], v20, s[12:15], s65 offen sc1
  s_add_u32 s64, s82, 6
  s_and_b32 s64, s64, 31
  s_lshl_b32 s28, s64, 6
  s_add_u32 s32, s28, s27
  v_pk_mul_f32 v[132:133], v[116:117], s[78:79]
  v_pk_mul_f32 v[134:135], v[118:119], s[78:79]
  v_pk_mul_f32 v[136:137], v[120:121], s[78:79]
  v_pk_mul_f32 v[138:139], v[122:123], s[78:79]
  v_exp_f32_e64 v132, v132 clamp
  v_exp_f32_e64 v133, v133 clamp
  v_exp_f32_e64 v134, v134 clamp
  v_exp_f32_e64 v135, v135 clamp
  v_exp_f32_e64 v136, v136 clamp
  v_exp_f32_e64 v137, v137 clamp
  v_exp_f32_e64 v138, v138 clamp
  v_exp_f32_e64 v139, v139 clamp
  v_max_f32 v116, 0, v116
  v_max_f32 v117, 0, v117
  v_max_f32 v118, 0, v118
  v_max_f32 v119, 0, v119
  v_max_f32 v120, 0, v120
  v_max_f32 v121, 0, v121
  v_max_f32 v122, 0, v122
  v_max_f32 v123, 0, v123
  v_pk_add_f32 v[132:133], v[132:133], s[76:77]
  v_pk_add_f32 v[134:135], v[134:135], s[76:77]
  v_pk_add_f32 v[136:137], v[136:137], s[76:77]
  v_pk_add_f32 v[138:139], v[138:139], s[76:77]
  v_pk_add_f32 v[116:117], v[116:117], v[132:133]
  v_pk_add_f32 v[118:119], v[118:119], v[134:135]
  v_pk_add_f32 v[120:121], v[120:121], v[136:137]
  v_pk_add_f32 v[122:123], v[122:123], v[138:139]
  s_lshl_b32 s65, s32, 10
  s_add_u32 s65, s65, 7340032
  v_cvt_pk_bf16_f32 v116, v116, v117
  v_cvt_pk_bf16_f32 v117, v118, v119
  v_cvt_pk_bf16_f32 v118, v120, v121
  v_cvt_pk_bf16_f32 v119, v122, v123
  buffer_store_dwordx4 v[116:119], v20, s[12:15], s65 offen sc1
  s_add_u32 s64, s82, 5
  s_and_b32 s64, s64, 31
  s_lshl_b32 s28, s64, 6
  s_add_u32 s32, s28, s27
  v_pk_mul_f32 v[132:133], v[124:125], s[78:79]
  v_pk_mul_f32 v[134:135], v[126:127], s[78:79]
  v_pk_mul_f32 v[136:137], v[128:129], s[78:79]
  v_pk_mul_f32 v[138:139], v[130:131], s[78:79]
  v_exp_f32_e64 v132, v132 clamp
  v_exp_f32_e64 v133, v133 clamp
  v_exp_f32_e64 v134, v134 clamp
  v_exp_f32_e64 v135, v135 clamp
  v_exp_f32_e64 v136, v136 clamp
  v_exp_f32_e64 v137, v137 clamp
  v_exp_f32_e64 v138, v138 clamp
  v_exp_f32_e64 v139, v139 clamp
  v_max_f32 v124, 0, v124
  v_max_f32 v125, 0, v125
  v_max_f32 v126, 0, v126
  v_max_f32 v127, 0, v127
  v_max_f32 v128, 0, v128
  v_max_f32 v129, 0, v129
  v_max_f32 v130, 0, v130
  v_max_f32 v131, 0, v131
  v_pk_add_f32 v[132:133], v[132:133], s[76:77]
  v_pk_add_f32 v[134:135], v[134:135], s[76:77]
  v_pk_add_f32 v[136:137], v[136:137], s[76:77]
  v_pk_add_f32 v[138:139], v[138:139], s[76:77]
  v_pk_add_f32 v[124:125], v[124:125], v[132:133]
  v_pk_add_f32 v[126:127], v[126:127], v[134:135]
  v_pk_add_f32 v[128:129], v[128:129], v[136:137]
  v_pk_add_f32 v[130:131], v[130:131], v[138:139]
  s_lshl_b32 s65, s32, 10
  s_add_u32 s65, s65, 7340032
  v_cvt_pk_bf16_f32 v124, v124, v125
  v_cvt_pk_bf16_f32 v125, v126, v127
  v_cvt_pk_bf16_f32 v126, v128, v129
  v_cvt_pk_bf16_f32 v127, v130, v131
  buffer_store_dwordx4 v[124:127], v20, s[12:15], s65 offen sc1
  s_branch gated_mix__linear_attn_block__mha_block__prompt_kernel_e00_kd
gated_mix__linear_attn_block__mha_block__prompt_kernel_e00_k6:
  s_add_u32 s64, s82, 0
  s_and_b32 s64, s64, 31
  s_lshl_b32 s28, s64, 6
  s_add_u32 s32, s28, s27
  v_pk_mul_f32 v[132:133], v[68:69], s[78:79]
  v_pk_mul_f32 v[134:135], v[70:71], s[78:79]
  v_pk_mul_f32 v[136:137], v[72:73], s[78:79]
  v_pk_mul_f32 v[138:139], v[74:75], s[78:79]
  v_exp_f32_e64 v132, v132 clamp
  v_exp_f32_e64 v133, v133 clamp
  v_exp_f32_e64 v134, v134 clamp
  v_exp_f32_e64 v135, v135 clamp
  v_exp_f32_e64 v136, v136 clamp
  v_exp_f32_e64 v137, v137 clamp
  v_exp_f32_e64 v138, v138 clamp
  v_exp_f32_e64 v139, v139 clamp
  v_max_f32 v68, 0, v68
  v_max_f32 v69, 0, v69
  v_max_f32 v70, 0, v70
  v_max_f32 v71, 0, v71
  v_max_f32 v72, 0, v72
  v_max_f32 v73, 0, v73
  v_max_f32 v74, 0, v74
  v_max_f32 v75, 0, v75
  v_pk_add_f32 v[132:133], v[132:133], s[76:77]
  v_pk_add_f32 v[134:135], v[134:135], s[76:77]
  v_pk_add_f32 v[136:137], v[136:137], s[76:77]
  v_pk_add_f32 v[138:139], v[138:139], s[76:77]
  v_pk_add_f32 v[68:69], v[68:69], v[132:133]
  v_pk_add_f32 v[70:71], v[70:71], v[134:135]
  v_pk_add_f32 v[72:73], v[72:73], v[136:137]
  v_pk_add_f32 v[74:75], v[74:75], v[138:139]
  s_lshl_b32 s65, s32, 10
  s_add_u32 s65, s65, 7340032
  v_cvt_pk_bf16_f32 v68, v68, v69
  v_cvt_pk_bf16_f32 v69, v70, v71
  v_cvt_pk_bf16_f32 v70, v72, v73
  v_cvt_pk_bf16_f32 v71, v74, v75
  buffer_store_dwordx4 v[68:71], v20, s[12:15], s65 offen sc1
  s_add_u32 s64, s82, 11
  s_and_b32 s64, s64, 31
  s_lshl_b32 s28, s64, 6
  s_add_u32 s32, s28, s27
  v_pk_mul_f32 v[132:133], v[76:77], s[78:79]
  v_pk_mul_f32 v[134:135], v[78:79], s[78:79]
  v_pk_mul_f32 v[136:137], v[80:81], s[78:79]
  v_pk_mul_f32 v[138:139], v[82:83], s[78:79]
  v_exp_f32_e64 v132, v132 clamp
  v_exp_f32_e64 v133, v133 clamp
  v_exp_f32_e64 v134, v134 clamp
  v_exp_f32_e64 v135, v135 clamp
  v_exp_f32_e64 v136, v136 clamp
  v_exp_f32_e64 v137, v137 clamp
  v_exp_f32_e64 v138, v138 clamp
  v_exp_f32_e64 v139, v139 clamp
  v_max_f32 v76, 0, v76
  v_max_f32 v77, 0, v77
  v_max_f32 v78, 0, v78
  v_max_f32 v79, 0, v79
  v_max_f32 v80, 0, v80
  v_max_f32 v81, 0, v81
  v_max_f32 v82, 0, v82
  v_max_f32 v83, 0, v83
  v_pk_add_f32 v[132:133], v[132:133], s[76:77]
  v_pk_add_f32 v[134:135], v[134:135], s[76:77]
  v_pk_add_f32 v[136:137], v[136:137], s[76:77]
  v_pk_add_f32 v[138:139], v[138:139], s[76:77]
  v_pk_add_f32 v[76:77], v[76:77], v[132:133]
  v_pk_add_f32 v[78:79], v[78:79], v[134:135]
  v_pk_add_f32 v[80:81], v[80:81], v[136:137]
  v_pk_add_f32 v[82:83], v[82:83], v[138:139]
  s_lshl_b32 s65, s32, 10
  s_add_u32 s65, s65, 7340032
  v_cvt_pk_bf16_f32 v76, v76, v77
  v_cvt_pk_bf16_f32 v77, v78, v79
  v_cvt_pk_bf16_f32 v78, v80, v81
  v_cvt_pk_bf16_f32 v79, v82, v83
  buffer_store_dwordx4 v[76:79], v20, s[12:15], s65 offen sc1
  s_add_u32 s64, s82, 2
  s_and_b32 s64, s64, 31
  s_lshl_b32 s28, s64, 6
  s_add_u32 s32, s28, s27
  v_pk_mul_f32 v[132:133], v[84:85], s[78:79]
  v_pk_mul_f32 v[134:135], v[86:87], s[78:79]
  v_pk_mul_f32 v[136:137], v[88:89], s[78:79]
  v_pk_mul_f32 v[138:139], v[90:91], s[78:79]
  v_exp_f32_e64 v132, v132 clamp
  v_exp_f32_e64 v133, v133 clamp
  v_exp_f32_e64 v134, v134 clamp
  v_exp_f32_e64 v135, v135 clamp
  v_exp_f32_e64 v136, v136 clamp
  v_exp_f32_e64 v137, v137 clamp
  v_exp_f32_e64 v138, v138 clamp
  v_exp_f32_e64 v139, v139 clamp
  v_max_f32 v84, 0, v84
  v_max_f32 v85, 0, v85
  v_max_f32 v86, 0, v86
  v_max_f32 v87, 0, v87
  v_max_f32 v88, 0, v88
  v_max_f32 v89, 0, v89
  v_max_f32 v90, 0, v90
  v_max_f32 v91, 0, v91
  v_pk_add_f32 v[132:133], v[132:133], s[76:77]
  v_pk_add_f32 v[134:135], v[134:135], s[76:77]
  v_pk_add_f32 v[136:137], v[136:137], s[76:77]
  v_pk_add_f32 v[138:139], v[138:139], s[76:77]
  v_pk_add_f32 v[84:85], v[84:85], v[132:133]
  v_pk_add_f32 v[86:87], v[86:87], v[134:135]
  v_pk_add_f32 v[88:89], v[88:89], v[136:137]
  v_pk_add_f32 v[90:91], v[90:91], v[138:139]
  s_lshl_b32 s65, s32, 10
  s_add_u32 s65, s65, 7340032
  v_cvt_pk_bf16_f32 v84, v84, v85
  v_cvt_pk_bf16_f32 v85, v86, v87
  v_cvt_pk_bf16_f32 v86, v88, v89
  v_cvt_pk_bf16_f32 v87, v90, v91
  buffer_store_dwordx4 v[84:87], v20, s[12:15], s65 offen sc1
  s_add_u32 s64, s82, 1
  s_and_b32 s64, s64, 31
  s_lshl_b32 s28, s64, 6
  s_add_u32 s32, s28, s27
  v_pk_mul_f32 v[132:133], v[92:93], s[78:79]
  v_pk_mul_f32 v[134:135], v[94:95], s[78:79]
  v_pk_mul_f32 v[136:137], v[96:97], s[78:79]
  v_pk_mul_f32 v[138:139], v[98:99], s[78:79]
  v_exp_f32_e64 v132, v132 clamp
  v_exp_f32_e64 v133, v133 clamp
  v_exp_f32_e64 v134, v134 clamp
  v_exp_f32_e64 v135, v135 clamp
  v_exp_f32_e64 v136, v136 clamp
  v_exp_f32_e64 v137, v137 clamp
  v_exp_f32_e64 v138, v138 clamp
  v_exp_f32_e64 v139, v139 clamp
  v_max_f32 v92, 0, v92
  v_max_f32 v93, 0, v93
  v_max_f32 v94, 0, v94
  v_max_f32 v95, 0, v95
  v_max_f32 v96, 0, v96
  v_max_f32 v97, 0, v97
  v_max_f32 v98, 0, v98
  v_max_f32 v99, 0, v99
  v_pk_add_f32 v[132:133], v[132:133], s[76:77]
  v_pk_add_f32 v[134:135], v[134:135], s[76:77]
  v_pk_add_f32 v[136:137], v[136:137], s[76:77]
  v_pk_add_f32 v[138:139], v[138:139], s[76:77]
  v_pk_add_f32 v[92:93], v[92:93], v[132:133]
  v_pk_add_f32 v[94:95], v[94:95], v[134:135]
  v_pk_add_f32 v[96:97], v[96:97], v[136:137]
  v_pk_add_f32 v[98:99], v[98:99], v[138:139]
  s_lshl_b32 s65, s32, 10
  s_add_u32 s65, s65, 7340032
  v_cvt_pk_bf16_f32 v92, v92, v93
  v_cvt_pk_bf16_f32 v93, v94, v95
  v_cvt_pk_bf16_f32 v94, v96, v97
  v_cvt_pk_bf16_f32 v95, v98, v99
  buffer_store_dwordx4 v[92:95], v20, s[12:15], s65 offen sc1
  s_add_u32 s64, s82, 4
  s_and_b32 s64, s64, 31
  s_lshl_b32 s28, s64, 6
  s_add_u32 s32, s28, s27
  v_pk_mul_f32 v[132:133], v[100:101], s[78:79]
  v_pk_mul_f32 v[134:135], v[102:103], s[78:79]
  v_pk_mul_f32 v[136:137], v[104:105], s[78:79]
  v_pk_mul_f32 v[138:139], v[106:107], s[78:79]
  v_exp_f32_e64 v132, v132 clamp
  v_exp_f32_e64 v133, v133 clamp
  v_exp_f32_e64 v134, v134 clamp
  v_exp_f32_e64 v135, v135 clamp
  v_exp_f32_e64 v136, v136 clamp
  v_exp_f32_e64 v137, v137 clamp
  v_exp_f32_e64 v138, v138 clamp
  v_exp_f32_e64 v139, v139 clamp
  v_max_f32 v100, 0, v100
  v_max_f32 v101, 0, v101
  v_max_f32 v102, 0, v102
  v_max_f32 v103, 0, v103
  v_max_f32 v104, 0, v104
  v_max_f32 v105, 0, v105
  v_max_f32 v106, 0, v106
  v_max_f32 v107, 0, v107
  v_pk_add_f32 v[132:133], v[132:133], s[76:77]
  v_pk_add_f32 v[134:135], v[134:135], s[76:77]
  v_pk_add_f32 v[136:137], v[136:137], s[76:77]
  v_pk_add_f32 v[138:139], v[138:139], s[76:77]
  v_pk_add_f32 v[100:101], v[100:101], v[132:133]
  v_pk_add_f32 v[102:103], v[102:103], v[134:135]
  v_pk_add_f32 v[104:105], v[104:105], v[136:137]
  v_pk_add_f32 v[106:107], v[106:107], v[138:139]
  s_lshl_b32 s65, s32, 10
  s_add_u32 s65, s65, 7340032
  v_cvt_pk_bf16_f32 v100, v100, v101
  v_cvt_pk_bf16_f32 v101, v102, v103
  v_cvt_pk_bf16_f32 v102, v104, v105
  v_cvt_pk_bf16_f32 v103, v106, v107
  buffer_store_dwordx4 v[100:103], v20, s[12:15], s65 offen sc1
  s_add_u32 s64, s82, 3
  s_and_b32 s64, s64, 31
  s_lshl_b32 s28, s64, 6
  s_add_u32 s32, s28, s27
  v_pk_mul_f32 v[132:133], v[108:109], s[78:79]
  v_pk_mul_f32 v[134:135], v[110:111], s[78:79]
  v_pk_mul_f32 v[136:137], v[112:113], s[78:79]
  v_pk_mul_f32 v[138:139], v[114:115], s[78:79]
  v_exp_f32_e64 v132, v132 clamp
  v_exp_f32_e64 v133, v133 clamp
  v_exp_f32_e64 v134, v134 clamp
  v_exp_f32_e64 v135, v135 clamp
  v_exp_f32_e64 v136, v136 clamp
  v_exp_f32_e64 v137, v137 clamp
  v_exp_f32_e64 v138, v138 clamp
  v_exp_f32_e64 v139, v139 clamp
  v_max_f32 v108, 0, v108
  v_max_f32 v109, 0, v109
  v_max_f32 v110, 0, v110
  v_max_f32 v111, 0, v111
  v_max_f32 v112, 0, v112
  v_max_f32 v113, 0, v113
  v_max_f32 v114, 0, v114
  v_max_f32 v115, 0, v115
  v_pk_add_f32 v[132:133], v[132:133], s[76:77]
  v_pk_add_f32 v[134:135], v[134:135], s[76:77]
  v_pk_add_f32 v[136:137], v[136:137], s[76:77]
  v_pk_add_f32 v[138:139], v[138:139], s[76:77]
  v_pk_add_f32 v[108:109], v[108:109], v[132:133]
  v_pk_add_f32 v[110:111], v[110:111], v[134:135]
  v_pk_add_f32 v[112:113], v[112:113], v[136:137]
  v_pk_add_f32 v[114:115], v[114:115], v[138:139]
  s_lshl_b32 s65, s32, 10
  s_add_u32 s65, s65, 7340032
  v_cvt_pk_bf16_f32 v108, v108, v109
  v_cvt_pk_bf16_f32 v109, v110, v111
  v_cvt_pk_bf16_f32 v110, v112, v113
  v_cvt_pk_bf16_f32 v111, v114, v115
  buffer_store_dwordx4 v[108:111], v20, s[12:15], s65 offen sc1
  s_add_u32 s64, s82, 6
  s_and_b32 s64, s64, 31
  s_lshl_b32 s28, s64, 6
  s_add_u32 s32, s28, s27
  v_pk_mul_f32 v[132:133], v[116:117], s[78:79]
  v_pk_mul_f32 v[134:135], v[118:119], s[78:79]
  v_pk_mul_f32 v[136:137], v[120:121], s[78:79]
  v_pk_mul_f32 v[138:139], v[122:123], s[78:79]
  v_exp_f32_e64 v132, v132 clamp
  v_exp_f32_e64 v133, v133 clamp
  v_exp_f32_e64 v134, v134 clamp
  v_exp_f32_e64 v135, v135 clamp
  v_exp_f32_e64 v136, v136 clamp
  v_exp_f32_e64 v137, v137 clamp
  v_exp_f32_e64 v138, v138 clamp
  v_exp_f32_e64 v139, v139 clamp
  v_max_f32 v116, 0, v116
  v_max_f32 v117, 0, v117
  v_max_f32 v118, 0, v118
  v_max_f32 v119, 0, v119
  v_max_f32 v120, 0, v120
  v_max_f32 v121, 0, v121
  v_max_f32 v122, 0, v122
  v_max_f32 v123, 0, v123
  v_pk_add_f32 v[132:133], v[132:133], s[76:77]
  v_pk_add_f32 v[134:135], v[134:135], s[76:77]
  v_pk_add_f32 v[136:137], v[136:137], s[76:77]
  v_pk_add_f32 v[138:139], v[138:139], s[76:77]
  v_pk_add_f32 v[116:117], v[116:117], v[132:133]
  v_pk_add_f32 v[118:119], v[118:119], v[134:135]
  v_pk_add_f32 v[120:121], v[120:121], v[136:137]
  v_pk_add_f32 v[122:123], v[122:123], v[138:139]
  s_lshl_b32 s65, s32, 10
  s_add_u32 s65, s65, 7340032
  v_cvt_pk_bf16_f32 v116, v116, v117
  v_cvt_pk_bf16_f32 v117, v118, v119
  v_cvt_pk_bf16_f32 v118, v120, v121
  v_cvt_pk_bf16_f32 v119, v122, v123
  buffer_store_dwordx4 v[116:119], v20, s[12:15], s65 offen sc1
  s_add_u32 s64, s82, 5
  s_and_b32 s64, s64, 31
  s_lshl_b32 s28, s64, 6
  s_add_u32 s32, s28, s27
  v_pk_mul_f32 v[132:133], v[124:125], s[78:79]
  v_pk_mul_f32 v[134:135], v[126:127], s[78:79]
  v_pk_mul_f32 v[136:137], v[128:129], s[78:79]
  v_pk_mul_f32 v[138:139], v[130:131], s[78:79]
  v_exp_f32_e64 v132, v132 clamp
  v_exp_f32_e64 v133, v133 clamp
  v_exp_f32_e64 v134, v134 clamp
  v_exp_f32_e64 v135, v135 clamp
  v_exp_f32_e64 v136, v136 clamp
  v_exp_f32_e64 v137, v137 clamp
  v_exp_f32_e64 v138, v138 clamp
  v_exp_f32_e64 v139, v139 clamp
  v_max_f32 v124, 0, v124
  v_max_f32 v125, 0, v125
  v_max_f32 v126, 0, v126
  v_max_f32 v127, 0, v127
  v_max_f32 v128, 0, v128
  v_max_f32 v129, 0, v129
  v_max_f32 v130, 0, v130
  v_max_f32 v131, 0, v131
  v_pk_add_f32 v[132:133], v[132:133], s[76:77]
  v_pk_add_f32 v[134:135], v[134:135], s[76:77]
  v_pk_add_f32 v[136:137], v[136:137], s[76:77]
  v_pk_add_f32 v[138:139], v[138:139], s[76:77]
  v_pk_add_f32 v[124:125], v[124:125], v[132:133]
  v_pk_add_f32 v[126:127], v[126:127], v[134:135]
  v_pk_add_f32 v[128:129], v[128:129], v[136:137]
  v_pk_add_f32 v[130:131], v[130:131], v[138:139]
  s_lshl_b32 s65, s32, 10
  s_add_u32 s65, s65, 7340032
  v_cvt_pk_bf16_f32 v124, v124, v125
  v_cvt_pk_bf16_f32 v125, v126, v127
  v_cvt_pk_bf16_f32 v126, v128, v129
  v_cvt_pk_bf16_f32 v127, v130, v131
  buffer_store_dwordx4 v[124:127], v20, s[12:15], s65 offen sc1
gated_mix__linear_attn_block__mha_block__prompt_kernel_e00_kd:
  s_barrier
  s_branch gated_mix__linear_attn_block__mha_block__prompt_kernel_c2
gated_mix__linear_attn_block__mha_block__prompt_kernel_v01:
  s_barrier
  ds_read_b128 v[28:31], v16
  ds_read_b64_tr_b16 v[36:37], v12 offset:0
  ds_read_b64_tr_b16 v[38:39], v12 offset:2048
  ds_read_b64_tr_b16 v[40:41], v13 offset:0
  ds_read_b64_tr_b16 v[42:43], v13 offset:2048
  ds_read_b64_tr_b16 v[44:45], v14 offset:0
  ds_read_b64_tr_b16 v[46:47], v14 offset:2048
  s_mov_b32 s38, 0
gated_mix__linear_attn_block__mha_block__prompt_kernel_g01_loop:
  ds_read_b128 v[32:35], v17
  ds_read_b64_tr_b16 v[52:53], v12 offset:8192
  ds_read_b64_tr_b16 v[54:55], v12 offset:10240
  ds_read_b64_tr_b16 v[56:57], v13 offset:8192
  ds_read_b64_tr_b16 v[58:59], v13 offset:10240
  ds_read_b64_tr_b16 v[60:61], v14 offset:8192
  ds_read_b64_tr_b16 v[62:63], v14 offset:10240
  s_waitcnt lgkmcnt(7)
  v_mfma_f32_32x32x16_bf16 v[68:83], v[36:39], v[28:31], v[68:83]
  v_mfma_f32_32x32x16_bf16 v[84:99], v[40:43], v[28:31], v[84:99]
  v_mfma_f32_32x32x16_bf16 v[100:115], v[44:47], v[28:31], v[100:115]
  ds_read_b128 v[28:31], v18
  ds_read_b64_tr_b16 v[36:37], v12 offset:16384
  ds_read_b64_tr_b16 v[38:39], v12 offset:18432
  ds_read_b64_tr_b16 v[40:41], v13 offset:16384
  ds_read_b64_tr_b16 v[42:43], v13 offset:18432
  ds_read_b64_tr_b16 v[44:45], v14 offset:16384
  ds_read_b64_tr_b16 v[46:47], v14 offset:18432
  s_waitcnt lgkmcnt(7)
  v_mfma_f32_32x32x16_bf16 v[68:83], v[52:55], v[32:35], v[68:83]
  v_mfma_f32_32x32x16_bf16 v[84:99], v[56:59], v[32:35], v[84:99]
  v_mfma_f32_32x32x16_bf16 v[100:115], v[60:63], v[32:35], v[100:115]
  ds_read_b128 v[32:35], v19
  ds_read_b64_tr_b16 v[52:53], v12 offset:24576
  ds_read_b64_tr_b16 v[54:55], v12 offset:26624
  ds_read_b64_tr_b16 v[56:57], v13 offset:24576
  ds_read_b64_tr_b16 v[58:59], v13 offset:26624
  ds_read_b64_tr_b16 v[60:61], v14 offset:24576
  ds_read_b64_tr_b16 v[62:63], v14 offset:26624
  s_waitcnt lgkmcnt(7)
  v_mfma_f32_32x32x16_bf16 v[68:83], v[36:39], v[28:31], v[68:83]
  v_mfma_f32_32x32x16_bf16 v[84:99], v[40:43], v[28:31], v[84:99]
  v_mfma_f32_32x32x16_bf16 v[100:115], v[44:47], v[28:31], v[100:115]
  s_waitcnt lgkmcnt(0)
  s_barrier
  v_add_u32 v12, 49152, v12
  v_add_u32 v13, 49152, v13
  v_add_u32 v14, 49152, v14
  v_add_u32 v16, 49152, v16
  v_add_u32 v17, 49152, v17
  v_add_u32 v18, 49152, v18
  v_add_u32 v19, 49152, v19
  ds_read_b128 v[28:31], v16
  ds_read_b64_tr_b16 v[36:37], v12 offset:0
  ds_read_b64_tr_b16 v[38:39], v12 offset:2048
  ds_read_b64_tr_b16 v[40:41], v13 offset:0
  ds_read_b64_tr_b16 v[42:43], v13 offset:2048
  ds_read_b64_tr_b16 v[44:45], v14 offset:0
  ds_read_b64_tr_b16 v[46:47], v14 offset:2048
  v_mfma_f32_32x32x16_bf16 v[68:83], v[52:55], v[32:35], v[68:83]
  v_mfma_f32_32x32x16_bf16 v[84:99], v[56:59], v[32:35], v[84:99]
  v_mfma_f32_32x32x16_bf16 v[100:115], v[60:63], v[32:35], v[100:115]
  ds_read_b128 v[32:35], v17
  ds_read_b64_tr_b16 v[52:53], v12 offset:8192
  ds_read_b64_tr_b16 v[54:55], v12 offset:10240
  ds_read_b64_tr_b16 v[56:57], v13 offset:8192
  ds_read_b64_tr_b16 v[58:59], v13 offset:10240
  ds_read_b64_tr_b16 v[60:61], v14 offset:8192
  ds_read_b64_tr_b16 v[62:63], v14 offset:10240
  s_waitcnt lgkmcnt(7)
  v_mfma_f32_32x32x16_bf16 v[68:83], v[36:39], v[28:31], v[68:83]
  v_mfma_f32_32x32x16_bf16 v[84:99], v[40:43], v[28:31], v[84:99]
  v_mfma_f32_32x32x16_bf16 v[100:115], v[44:47], v[28:31], v[100:115]
  ds_read_b128 v[28:31], v18
  ds_read_b64_tr_b16 v[36:37], v12 offset:16384
  ds_read_b64_tr_b16 v[38:39], v12 offset:18432
  ds_read_b64_tr_b16 v[40:41], v13 offset:16384
  ds_read_b64_tr_b16 v[42:43], v13 offset:18432
  ds_read_b64_tr_b16 v[44:45], v14 offset:16384
  ds_read_b64_tr_b16 v[46:47], v14 offset:18432
  s_waitcnt lgkmcnt(7)
  v_mfma_f32_32x32x16_bf16 v[68:83], v[52:55], v[32:35], v[68:83]
  v_mfma_f32_32x32x16_bf16 v[84:99], v[56:59], v[32:35], v[84:99]
  v_mfma_f32_32x32x16_bf16 v[100:115], v[60:63], v[32:35], v[100:115]
  ds_read_b128 v[32:35], v19
  ds_read_b64_tr_b16 v[52:53], v12 offset:24576
  ds_read_b64_tr_b16 v[54:55], v12 offset:26624
  ds_read_b64_tr_b16 v[56:57], v13 offset:24576
  ds_read_b64_tr_b16 v[58:59], v13 offset:26624
  ds_read_b64_tr_b16 v[60:61], v14 offset:24576
  ds_read_b64_tr_b16 v[62:63], v14 offset:26624
  s_waitcnt lgkmcnt(7)
  v_mfma_f32_32x32x16_bf16 v[68:83], v[36:39], v[28:31], v[68:83]
  v_mfma_f32_32x32x16_bf16 v[84:99], v[40:43], v[28:31], v[84:99]
  v_mfma_f32_32x32x16_bf16 v[100:115], v[44:47], v[28:31], v[100:115]
  s_waitcnt lgkmcnt(0)
  s_barrier
  v_add_u32 v12, 49152, v12
  v_add_u32 v13, 49152, v13
  v_add_u32 v14, 49152, v14
  v_add_u32 v16, 49152, v16
  v_add_u32 v17, 49152, v17
  v_add_u32 v18, 49152, v18
  v_add_u32 v19, 49152, v19
  ds_read_b128 v[28:31], v16
  ds_read_b64_tr_b16 v[36:37], v12 offset:0
  ds_read_b64_tr_b16 v[38:39], v12 offset:2048
  ds_read_b64_tr_b16 v[40:41], v13 offset:0
  ds_read_b64_tr_b16 v[42:43], v13 offset:2048
  ds_read_b64_tr_b16 v[44:45], v14 offset:0
  ds_read_b64_tr_b16 v[46:47], v14 offset:2048
  v_mfma_f32_32x32x16_bf16 v[68:83], v[52:55], v[32:35], v[68:83]
  v_mfma_f32_32x32x16_bf16 v[84:99], v[56:59], v[32:35], v[84:99]
  v_mfma_f32_32x32x16_bf16 v[100:115], v[60:63], v[32:35], v[100:115]
  ds_read_b128 v[32:35], v17
  ds_read_b64_tr_b16 v[52:53], v12 offset:8192
  ds_read_b64_tr_b16 v[54:55], v12 offset:10240
  ds_read_b64_tr_b16 v[56:57], v13 offset:8192
  ds_read_b64_tr_b16 v[58:59], v13 offset:10240
  ds_read_b64_tr_b16 v[60:61], v14 offset:8192
  ds_read_b64_tr_b16 v[62:63], v14 offset:10240
  s_waitcnt lgkmcnt(7)
  v_mfma_f32_32x32x16_bf16 v[68:83], v[36:39], v[28:31], v[68:83]
  v_mfma_f32_32x32x16_bf16 v[84:99], v[40:43], v[28:31], v[84:99]
  v_mfma_f32_32x32x16_bf16 v[100:115], v[44:47], v[28:31], v[100:115]
  ds_read_b128 v[28:31], v18
  ds_read_b64_tr_b16 v[36:37], v12 offset:16384
  ds_read_b64_tr_b16 v[38:39], v12 offset:18432
  ds_read_b64_tr_b16 v[40:41], v13 offset:16384
  ds_read_b64_tr_b16 v[42:43], v13 offset:18432
  ds_read_b64_tr_b16 v[44:45], v14 offset:16384
  ds_read_b64_tr_b16 v[46:47], v14 offset:18432
  s_waitcnt lgkmcnt(7)
  v_mfma_f32_32x32x16_bf16 v[68:83], v[52:55], v[32:35], v[68:83]
  v_mfma_f32_32x32x16_bf16 v[84:99], v[56:59], v[32:35], v[84:99]
  v_mfma_f32_32x32x16_bf16 v[100:115], v[60:63], v[32:35], v[100:115]
  ds_read_b128 v[32:35], v19
  ds_read_b64_tr_b16 v[52:53], v12 offset:24576
  ds_read_b64_tr_b16 v[54:55], v12 offset:26624
  ds_read_b64_tr_b16 v[56:57], v13 offset:24576
  ds_read_b64_tr_b16 v[58:59], v13 offset:26624
  ds_read_b64_tr_b16 v[60:61], v14 offset:24576
  ds_read_b64_tr_b16 v[62:63], v14 offset:26624
  s_waitcnt lgkmcnt(7)
  v_mfma_f32_32x32x16_bf16 v[68:83], v[36:39], v[28:31], v[68:83]
  v_mfma_f32_32x32x16_bf16 v[84:99], v[40:43], v[28:31], v[84:99]
  v_mfma_f32_32x32x16_bf16 v[100:115], v[44:47], v[28:31], v[100:115]
  s_waitcnt lgkmcnt(0)
  s_cmp_eq_u32 s38, 2
  s_cbranch_scc1 gated_mix__linear_attn_block__mha_block__prompt_kernel_g01_last
  s_barrier
  v_add_u32 v12, 4294868992, v12
  v_add_u32 v13, 4294868992, v13
  v_add_u32 v14, 4294868992, v14
  v_add_u32 v16, 4294868992, v16
  v_add_u32 v17, 4294868992, v17
  v_add_u32 v18, 4294868992, v18
  v_add_u32 v19, 4294868992, v19
  s_add_u32 s38, s38, 1
  ds_read_b128 v[28:31], v16
  ds_read_b64_tr_b16 v[36:37], v12 offset:0
  ds_read_b64_tr_b16 v[38:39], v12 offset:2048
  ds_read_b64_tr_b16 v[40:41], v13 offset:0
  ds_read_b64_tr_b16 v[42:43], v13 offset:2048
  ds_read_b64_tr_b16 v[44:45], v14 offset:0
  ds_read_b64_tr_b16 v[46:47], v14 offset:2048
  v_mfma_f32_32x32x16_bf16 v[68:83], v[52:55], v[32:35], v[68:83]
  v_mfma_f32_32x32x16_bf16 v[84:99], v[56:59], v[32:35], v[84:99]
  v_mfma_f32_32x32x16_bf16 v[100:115], v[60:63], v[32:35], v[100:115]
  s_branch gated_mix__linear_attn_block__mha_block__prompt_kernel_g01_loop
gated_mix__linear_attn_block__mha_block__prompt_kernel_g01_last:
  s_barrier
  v_mfma_f32_32x32x16_bf16 v[68:83], v[52:55], v[32:35], v[68:83]
  v_mfma_f32_32x32x16_bf16 v[84:99], v[56:59], v[32:35], v[84:99]
  v_mfma_f32_32x32x16_bf16 v[100:115], v[60:63], v[32:35], v[100:115]
  s_nop 15
  s_nop 3
  s_mov_b32 s78, 1069066811
  s_mov_b32 s79, 1069066811
  s_mov_b32 s76, 897988541
  s_mov_b32 s77, 897988541
  v_cmp_gt_u32 vcc, 32, v1
  v_mov_b32 v7, 2130706432
  s_lshr_b32 s28, s27, 3
  s_mul_i32 s28, s28, 19456
  s_add_u32 s28, s28, 2359296
  v_cndmask_b32 v7, v7, v23, vcc
  s_and_b32 s29, s27, 7
  s_lshl_b32 s30, s29, 10
  s_add_u32 s80, s28, s30
  s_lshl_b32 s30, s29, 7
  s_add_u32 s81, s28, s30
  s_add_u32 s81, s81, 8192
  s_mul_i32 s82, s42, 12
  s_mov_b32 s74, 1051597459
  s_mov_b32 s75, 1051597459
  v_lshlrev_b32 v2, 14, v22
  v_add_u32 v2, v23, v2
  v_mul_u32_u24 v3, 311296, v22
  v_add_u32 v3, v23, v3
  s_cmp_eq_u32 s42, 2
  s_cbranch_scc1 gated_mix__linear_attn_block__mha_block__prompt_kernel_e01_k2
  s_cmp_eq_u32 s42, 5
  s_cbranch_scc1 gated_mix__linear_attn_block__mha_block__prompt_kernel_e01_k5
  s_cmp_gt_u32 s42, 5
  s_cbranch_scc1 gated_mix__linear_attn_block__mha_block__prompt_kernel_e01_k6
  s_cmp_gt_u32 s42, 2
  s_cbranch_scc1 gated_mix__linear_attn_block__mha_block__prompt_kernel_e01_k3
  s_add_u32 s64, s82, 8
  s_and_b32 s64, s64, 31
  s_lshl_b32 s28, s64, 6
  s_add_u32 s32, s28, s27
  v_pk_mul_f32 v[68:69], v[68:69], s[74:75]
  v_pk_mul_f32 v[70:71], v[70:71], s[74:75]
  v_pk_mul_f32 v[72:73], v[72:73], s[74:75]
  v_pk_mul_f32 v[74:75], v[74:75], s[74:75]
  s_lshl_b32 s65, s32, 10
  s_add_u32 s65, s65, 0
  v_cvt_pk_bf16_f32 v68, v68, v69
  v_cvt_pk_bf16_f32 v69, v70, v71
  v_cvt_pk_bf16_f32 v70, v72, v73
  v_cvt_pk_bf16_f32 v71, v74, v75
  buffer_store_dwordx4 v[68:71], v20, s[12:15], s65 offen sc1
  s_add_u32 s64, s82, 7
  s_and_b32 s64, s64, 31
  s_lshl_b32 s28, s64, 6
  s_add_u32 s32, s28, s27
  v_pk_mul_f32 v[76:77], v[76:77], s[74:75]
  v_pk_mul_f32 v[78:79], v[78:79], s[74:75]
  v_pk_mul_f32 v[80:81], v[80:81], s[74:75]
  v_pk_mul_f32 v[82:83], v[82:83], s[74:75]
  s_lshl_b32 s65, s32, 10
  s_add_u32 s65, s65, 0
  v_cvt_pk_bf16_f32 v76, v76, v77
  v_cvt_pk_bf16_f32 v77, v78, v79
  v_cvt_pk_bf16_f32 v78, v80, v81
  v_cvt_pk_bf16_f32 v79, v82, v83
  buffer_store_dwordx4 v[76:79], v20, s[12:15], s65 offen sc1
  s_add_u32 s64, s82, 10
  s_and_b32 s64, s64, 31
  s_lshl_b32 s28, s64, 6
  s_add_u32 s32, s28, s27
  v_pk_mul_f32 v[84:85], v[84:85], s[74:75]
  v_pk_mul_f32 v[86:87], v[86:87], s[74:75]
  v_pk_mul_f32 v[88:89], v[88:89], s[74:75]
  v_pk_mul_f32 v[90:91], v[90:91], s[74:75]
  s_lshl_b32 s65, s32, 10
  s_add_u32 s65, s65, 0
  v_cvt_pk_bf16_f32 v84, v84, v85
  v_cvt_pk_bf16_f32 v85, v86, v87
  v_cvt_pk_bf16_f32 v86, v88, v89
  v_cvt_pk_bf16_f32 v87, v90, v91
  buffer_store_dwordx4 v[84:87], v20, s[12:15], s65 offen sc1
  s_add_u32 s64, s82, 9
  s_and_b32 s64, s64, 31
  s_lshl_b32 s28, s64, 6
  s_add_u32 s32, s28, s27
  v_pk_mul_f32 v[92:93], v[92:93], s[74:75]
  v_pk_mul_f32 v[94:95], v[94:95], s[74:75]
  v_pk_mul_f32 v[96:97], v[96:97], s[74:75]
  v_pk_mul_f32 v[98:99], v[98:99], s[74:75]
  s_lshl_b32 s65, s32, 10
  s_add_u32 s65, s65, 0
  v_cvt_pk_bf16_f32 v92, v92, v93
  v_cvt_pk_bf16_f32 v93, v94, v95
  v_cvt_pk_bf16_f32 v94, v96, v97
  v_cvt_pk_bf16_f32 v95, v98, v99
  buffer_store_dwordx4 v[92:95], v20, s[12:15], s65 offen sc1
  s_cmp_lg_u32 s23, 0
  s_cbranch_scc1 gated_mix__linear_attn_block__mha_block__prompt_kernel_e01_g_33
  v_mul_f32 v132, 0xbfb8aa3b, v112
  v_exp_f32 v132, v132
  s_lshl_b32 s28, s27, 7
  s_add_u32 s28, s28, 14960640
  v_add_f32 v132, 1.0, v132
  v_rcp_f32 v132, v132
  s_nop 0
  buffer_store_dword v132, v7, s[12:15], s28 offen sc1
  s_nop 1
gated_mix__linear_attn_block__mha_block__prompt_kernel_e01_g_33:
  s_add_u32 s64, s82, 0
  s_and_b32 s64, s64, 31
  s_lshl_b32 s28, s64, 6
  s_add_u32 s32, s28, s27
  s_lshl_b32 s31, s32, 7
  v_pk_mul_f32 v[100:101], v[100:101], s[74:75]
  v_pk_mul_f32 v[102:103], v[102:103], s[74:75]
  s_add_u32 s65, s31, 2097152
  s_add_u32 s32, s65, 8192
  v_cvt_pk_bf16_f32 v100, v100, v101
  v_cvt_pk_bf16_f32 v101, v102, v103
  buffer_store_dword v100, v2, s[12:15], s65 offen sc1
  buffer_store_dword v101, v2, s[12:15], s32 offen sc1
  s_add_u32 s64, s82, 4
  s_and_b32 s64, s64, 31
  s_lshl_b32 s28, s64, 6
  s_add_u32 s32, s28, s27
  s_lshl_b32 s31, s32, 7
  v_pk_mul_f32 v[104:105], v[104:105], s[74:75]
  v_pk_mul_f32 v[106:107], v[106:107], s[74:75]
  s_add_u32 s65, s31, 2097152
  s_add_u32 s32, s65, 8192
  v_cvt_pk_bf16_f32 v104, v104, v105
  v_cvt_pk_bf16_f32 v105, v106, v107
  buffer_store_dword v104, v2, s[12:15], s65 offen sc1
  buffer_store_dword v105, v2, s[12:15], s32 offen sc1
  s_add_u32 s64, s82, 8
  s_and_b32 s64, s64, 31
  s_lshl_b32 s28, s64, 6
  s_add_u32 s32, s28, s27
  s_lshl_b32 s31, s32, 7
  v_pk_mul_f32 v[108:109], v[108:109], s[74:75]
  v_pk_mul_f32 v[110:111], v[110:111], s[74:75]
  s_add_u32 s65, s31, 2097152
  s_add_u32 s32, s65, 8192
  v_cvt_pk_bf16_f32 v108, v108, v109
  v_cvt_pk_bf16_f32 v109, v110, v111
  buffer_store_dword v108, v2, s[12:15], s65 offen sc1
  buffer_store_dword v109, v2, s[12:15], s32 offen sc1
  s_branch gated_mix__linear_attn_block__mha_block__prompt_kernel_e01_kd
gated_mix__linear_attn_block__mha_block__prompt_kernel_e01_k2:
  s_add_u32 s64, s82, 8
  s_and_b32 s64, s64, 31
  s_lshl_b32 s28, s64, 6
  s_add_u32 s32, s28, s27
  v_mul_f32 v132, v68, v68
  v_fmac_f32 v132, v69, v69
  v_fmac_f32 v132, v70, v70
  v_fmac_f32 v132, v71, v71
  v_fmac_f32 v132, v72, v72
  v_fmac_f32 v132, v73, v73
  v_fmac_f32 v132, v74, v74
  v_fmac_f32 v132, v75, v75
  v_mov_b32 v134, v132
  s_lshl_b32 s29, s32, 7
  s_add_u32 s29, s29, 19687424
  v_permlane32_swap_b32 v132, v134
  s_mul_i32 s65, s64, 155648
  s_add_u32 s65, s65, s80
  v_add_f32 v132, v132, v134
  buffer_store_dword v132, v7, s[12:15], s29 offen sc1
  v_cvt_pk_bf16_f32 v68, v68, v69
  v_cvt_pk_bf16_f32 v69, v70, v71
  v_cvt_pk_bf16_f32 v70, v72, v73
  v_cvt_pk_bf16_f32 v71, v74, v75
  buffer_store_dwordx4 v[68:71], v20, s[12:15], s65 offen sc1
  s_add_u32 s64, s82, 7
  s_and_b32 s64, s64, 31
  s_lshl_b32 s28, s64, 6
  s_add_u32 s32, s28, s27
  v_pk_mul_f32 v[76:77], v[76:77], s[74:75]
  v_pk_mul_f32 v[78:79], v[78:79], s[74:75]
  v_pk_mul_f32 v[80:81], v[80:81], s[74:75]
  v_pk_mul_f32 v[82:83], v[82:83], s[74:75]
  s_lshl_b32 s65, s32, 10
  s_add_u32 s65, s65, 0
  v_cvt_pk_bf16_f32 v76, v76, v77
  v_cvt_pk_bf16_f32 v77, v78, v79
  v_cvt_pk_bf16_f32 v78, v80, v81
  v_cvt_pk_bf16_f32 v79, v82, v83
  buffer_store_dwordx4 v[76:79], v20, s[12:15], s65 offen sc1
  s_add_u32 s64, s82, 10
  s_and_b32 s64, s64, 31
  s_lshl_b32 s28, s64, 6
  s_add_u32 s32, s28, s27
  v_mul_f32 v132, v84, v84
  v_fmac_f32 v132, v85, v85
  v_fmac_f32 v132, v86, v86
  v_fmac_f32 v132, v87, v87
  v_fmac_f32 v132, v88, v88
  v_fmac_f32 v132, v89, v89
  v_fmac_f32 v132, v90, v90
  v_fmac_f32 v132, v91, v91
  v_mov_b32 v134, v132
  s_lshl_b32 s29, s32, 7
  s_add_u32 s29, s29, 19687424
  v_permlane32_swap_b32 v132, v134
  s_mul_i32 s65, s64, 155648
  s_add_u32 s65, s65, s80
  v_add_f32 v132, v132, v134
  buffer_store_dword v132, v7, s[12:15], s29 offen sc1
  v_cvt_pk_bf16_f32 v84, v84, v85
  v_cvt_pk_bf16_f32 v85, v86, v87
  v_cvt_pk_bf16_f32 v86, v88, v89
  v_cvt_pk_bf16_f32 v87, v90, v91
  buffer_store_dwordx4 v[84:87], v20, s[12:15], s65 offen sc1
  s_add_u32 s64, s82, 9
  s_and_b32 s64, s64, 31
  s_lshl_b32 s28, s64, 6
  s_add_u32 s32, s28, s27
  v_mul_f32 v132, v92, v92
  v_fmac_f32 v132, v93, v93
  v_fmac_f32 v132, v94, v94
  v_fmac_f32 v132, v95, v95
  v_fmac_f32 v132, v96, v96
  v_fmac_f32 v132, v97, v97
  v_fmac_f32 v132, v98, v98
  v_fmac_f32 v132, v99, v99
  v_mov_b32 v134, v132
  s_lshl_b32 s29, s32, 7
  s_add_u32 s29, s29, 19687424
  v_permlane32_swap_b32 v132, v134
  s_mul_i32 s65, s64, 155648
  s_add_u32 s65, s65, s80
  v_add_f32 v132, v132, v134
  buffer_store_dword v132, v7, s[12:15], s29 offen sc1
  v_cvt_pk_bf16_f32 v92, v92, v93
  v_cvt_pk_bf16_f32 v93, v94, v95
  v_cvt_pk_bf16_f32 v94, v96, v97
  v_cvt_pk_bf16_f32 v95, v98, v99
  buffer_store_dwordx4 v[92:95], v20, s[12:15], s65 offen sc1
  s_add_u32 s64, s82, 0
  s_and_b32 s64, s64, 31
  s_lshl_b32 s28, s64, 6
  s_add_u32 s32, s28, s27
  s_lshl_b32 s31, s32, 7
  v_pk_mul_f32 v[100:101], v[100:101], s[74:75]
  v_pk_mul_f32 v[102:103], v[102:103], s[74:75]
  s_add_u32 s65, s31, 2097152
  s_add_u32 s32, s65, 8192
  v_cvt_pk_bf16_f32 v100, v100, v101
  v_cvt_pk_bf16_f32 v101, v102, v103
  buffer_store_dword v100, v2, s[12:15], s65 offen sc1
  buffer_store_dword v101, v2, s[12:15], s32 offen sc1
  s_add_u32 s64, s82, 4
  s_and_b32 s64, s64, 31
  s_lshl_b32 s28, s64, 6
  s_add_u32 s32, s28, s27
  s_lshl_b32 s31, s32, 7
  v_pk_mul_f32 v[104:105], v[104:105], s[74:75]
  v_pk_mul_f32 v[106:107], v[106:107], s[74:75]
  s_add_u32 s65, s31, 2097152
  s_add_u32 s32, s65, 8192
  v_cvt_pk_bf16_f32 v104, v104, v105
  v_cvt_pk_bf16_f32 v105, v106, v107
  buffer_store_dword v104, v2, s[12:15], s65 offen sc1
  buffer_store_dword v105, v2, s[12:15], s32 offen sc1
  s_add_u32 s64, s82, 8
  s_and_b32 s64, s64, 31
  s_lshl_b32 s28, s64, 6
  s_add_u32 s32, s28, s27
  s_lshl_b32 s31, s32, 7
  v_mul_f32 v132, v108, v108
  v_mul_f32 v133, v110, v110
  v_fmac_f32 v132, v109, v109
  v_fmac_f32 v133, v111, v111
  s_add_u32 s29, s31, 19949568
  s_add_u32 s30, s29, 8192
  buffer_store_dword v132, v2, s[12:15], s29 offen sc1
  buffer_store_dword v133, v2, s[12:15], s30 offen sc1
  s_mul_i32 s65, s64, 155648
  s_add_u32 s65, s65, s81
  s_add_u32 s32, s65, 155648
  v_cvt_pk_bf16_f32 v108, v108, v109
  v_cvt_pk_bf16_f32 v109, v110, v111
  buffer_store_dword v108, v3, s[12:15], s65 offen sc1
  buffer_store_dword v109, v3, s[12:15], s32 offen sc1
  s_branch gated_mix__linear_attn_block__mha_block__prompt_kernel_e01_kd
gated_mix__linear_attn_block__mha_block__prompt_kernel_e01_k3:
  s_add_u32 s64, s82, 8
  s_and_b32 s64, s64, 31
  s_lshl_b32 s28, s64, 6
  s_add_u32 s32, s28, s27
  v_mul_f32 v132, v68, v68
  v_fmac_f32 v132, v69, v69
  v_fmac_f32 v132, v70, v70
  v_fmac_f32 v132, v71, v71
  v_fmac_f32 v132, v72, v72
  v_fmac_f32 v132, v73, v73
  v_fmac_f32 v132, v74, v74
  v_fmac_f32 v132, v75, v75
  v_mov_b32 v134, v132
  s_lshl_b32 s29, s32, 7
  s_add_u32 s29, s29, 19687424
  v_permlane32_swap_b32 v132, v134
  s_mul_i32 s65, s64, 155648
  s_add_u32 s65, s65, s80
  v_add_f32 v132, v132, v134
  buffer_store_dword v132, v7, s[12:15], s29 offen sc1
  v_cvt_pk_bf16_f32 v68, v68, v69
  v_cvt_pk_bf16_f32 v69, v70, v71
  v_cvt_pk_bf16_f32 v70, v72, v73
  v_cvt_pk_bf16_f32 v71, v74, v75
  buffer_store_dwordx4 v[68:71], v20, s[12:15], s65 offen sc1
  s_add_u32 s64, s82, 7
  s_and_b32 s64, s64, 31
  s_lshl_b32 s28, s64, 6
  s_add_u32 s32, s28, s27
  v_mul_f32 v132, v76, v76
  v_fmac_f32 v132, v77, v77
  v_fmac_f32 v132, v78, v78
  v_fmac_f32 v132, v79, v79
  v_fmac_f32 v132, v80, v80
  v_fmac_f32 v132, v81, v81
  v_fmac_f32 v132, v82, v82
  v_fmac_f32 v132, v83, v83
  v_mov_b32 v134, v132
  s_lshl_b32 s29, s32, 7
  s_add_u32 s29, s29, 19687424
  v_permlane32_swap_b32 v132, v134
  s_mul_i32 s65, s64, 155648
  s_add_u32 s65, s65, s80
  v_add_f32 v132, v132, v134
  buffer_store_dword v132, v7, s[12:15], s29 offen sc1
  v_cvt_pk_bf16_f32 v76, v76, v77
  v_cvt_pk_bf16_f32 v77, v78, v79
  v_cvt_pk_bf16_f32 v78, v80, v81
  v_cvt_pk_bf16_f32 v79, v82, v83
  buffer_store_dwordx4 v[76:79], v20, s[12:15], s65 offen sc1
  s_add_u32 s64, s82, 10
  s_and_b32 s64, s64, 31
  s_lshl_b32 s28, s64, 6
  s_add_u32 s32, s28, s27
  v_mul_f32 v132, v84, v84
  v_fmac_f32 v132, v85, v85
  v_fmac_f32 v132, v86, v86
  v_fmac_f32 v132, v87, v87
  v_fmac_f32 v132, v88, v88
  v_fmac_f32 v132, v89, v89
  v_fmac_f32 v132, v90, v90
  v_fmac_f32 v132, v91, v91
  v_mov_b32 v134, v132
  s_lshl_b32 s29, s32, 7
  s_add_u32 s29, s29, 19687424
  v_permlane32_swap_b32 v132, v134
  s_mul_i32 s65, s64, 155648
  s_add_u32 s65, s65, s80
  v_add_f32 v132, v132, v134
  buffer_store_dword v132, v7, s[12:15], s29 offen sc1
  v_cvt_pk_bf16_f32 v84, v84, v85
  v_cvt_pk_bf16_f32 v85, v86, v87
  v_cvt_pk_bf16_f32 v86, v88, v89
  v_cvt_pk_bf16_f32 v87, v90, v91
  buffer_store_dwordx4 v[84:87], v20, s[12:15], s65 offen sc1
  s_add_u32 s64, s82, 9
  s_and_b32 s64, s64, 31
  s_lshl_b32 s28, s64, 6
  s_add_u32 s32, s28, s27
  v_mul_f32 v132, v92, v92
  v_fmac_f32 v132, v93, v93
  v_fmac_f32 v132, v94, v94
  v_fmac_f32 v132, v95, v95
  v_fmac_f32 v132, v96, v96
  v_fmac_f32 v132, v97, v97
  v_fmac_f32 v132, v98, v98
  v_fmac_f32 v132, v99, v99
  v_mov_b32 v134, v132
  s_lshl_b32 s29, s32, 7
  s_add_u32 s29, s29, 19687424
  v_permlane32_swap_b32 v132, v134
  s_mul_i32 s65, s64, 155648
  s_add_u32 s65, s65, s80
  v_add_f32 v132, v132, v134
  buffer_store_dword v132, v7, s[12:15], s29 offen sc1
  v_cvt_pk_bf16_f32 v92, v92, v93
  v_cvt_pk_bf16_f32 v93, v94, v95
  v_cvt_pk_bf16_f32 v94, v96, v97
  v_cvt_pk_bf16_f32 v95, v98, v99
  buffer_store_dwordx4 v[92:95], v20, s[12:15], s65 offen sc1
  s_add_u32 s64, s82, 0
  s_and_b32 s64, s64, 31
  s_lshl_b32 s28, s64, 6
  s_add_u32 s32, s28, s27
  s_lshl_b32 s31, s32, 7
  v_mul_f32 v132, v100, v100
  v_mul_f32 v133, v102, v102
  v_fmac_f32 v132, v101, v101
  v_fmac_f32 v133, v103, v103
  s_add_u32 s29, s31, 19949568
  s_add_u32 s30, s29, 8192
  buffer_store_dword v132, v2, s[12:15], s29 offen sc1
  buffer_store_dword v133, v2, s[12:15], s30 offen sc1
  s_mul_i32 s65, s64, 155648
  s_add_u32 s65, s65, s81
  s_add_u32 s32, s65, 155648
  v_cvt_pk_bf16_f32 v100, v100, v101
  v_cvt_pk_bf16_f32 v101, v102, v103
  buffer_store_dword v100, v3, s[12:15], s65 offen sc1
  buffer_store_dword v101, v3, s[12:15], s32 offen sc1
  s_add_u32 s64, s82, 4
  s_and_b32 s64, s64, 31
  s_lshl_b32 s28, s64, 6
  s_add_u32 s32, s28, s27
  s_lshl_b32 s31, s32, 7
  v_mul_f32 v132, v104, v104
  v_mul_f32 v133, v106, v106
  v_fmac_f32 v132, v105, v105
  v_fmac_f32 v133, v107, v107
  s_add_u32 s29, s31, 19949568
  s_add_u32 s30, s29, 8192
  buffer_store_dword v132, v2, s[12:15], s29 offen sc1
  buffer_store_dword v133, v2, s[12:15], s30 offen sc1
  s_mul_i32 s65, s64, 155648
  s_add_u32 s65, s65, s81
  s_add_u32 s32, s65, 155648
  v_cvt_pk_bf16_f32 v104, v104, v105
  v_cvt_pk_bf16_f32 v105, v106, v107
  buffer_store_dword v104, v3, s[12:15], s65 offen sc1
  buffer_store_dword v105, v3, s[12:15], s32 offen sc1
  s_add_u32 s64, s82, 8
  s_and_b32 s64, s64, 31
  s_lshl_b32 s28, s64, 6
  s_add_u32 s32, s28, s27
  s_lshl_b32 s31, s32, 7
  v_mul_f32 v132, v108, v108
  v_mul_f32 v133, v110, v110
  v_fmac_f32 v132, v109, v109
  v_fmac_f32 v133, v111, v111
  s_add_u32 s29, s31, 19949568
  s_add_u32 s30, s29, 8192
  buffer_store_dword v132, v2, s[12:15], s29 offen sc1
  buffer_store_dword v133, v2, s[12:15], s30 offen sc1
  s_mul_i32 s65, s64, 155648
  s_add_u32 s65, s65, s81
  s_add_u32 s32, s65, 155648
  v_cvt_pk_bf16_f32 v108, v108, v109
  v_cvt_pk_bf16_f32 v109, v110, v111
  buffer_store_dword v108, v3, s[12:15], s65 offen sc1
  buffer_store_dword v109, v3, s[12:15], s32 offen sc1
  s_branch gated_mix__linear_attn_block__mha_block__prompt_kernel_e01_kd
gated_mix__linear_attn_block__mha_block__prompt_kernel_e01_k5:
  s_add_u32 s64, s82, 8
  s_and_b32 s64, s64, 31
  s_lshl_b32 s28, s64, 6
  s_add_u32 s32, s28, s27
  v_pk_mul_f32 v[132:133], v[68:69], s[78:79]
  v_pk_mul_f32 v[134:135], v[70:71], s[78:79]
  v_pk_mul_f32 v[136:137], v[72:73], s[78:79]
  v_pk_mul_f32 v[138:139], v[74:75], s[78:79]
  v_exp_f32_e64 v132, v132 clamp
  v_exp_f32_e64 v133, v133 clamp
  v_exp_f32_e64 v134, v134 clamp
  v_exp_f32_e64 v135, v135 clamp
  v_exp_f32_e64 v136, v136 clamp
  v_exp_f32_e64 v137, v137 clamp
  v_exp_f32_e64 v138, v138 clamp
  v_exp_f32_e64 v139, v139 clamp
  v_max_f32 v68, 0, v68
  v_max_f32 v69, 0, v69
  v_max_f32 v70, 0, v70
  v_max_f32 v71, 0, v71
  v_max_f32 v72, 0, v72
  v_max_f32 v73, 0, v73
  v_max_f32 v74, 0, v74
  v_max_f32 v75, 0, v75
  v_pk_add_f32 v[132:133], v[132:133], s[76:77]
  v_pk_add_f32 v[134:135], v[134:135], s[76:77]
  v_pk_add_f32 v[136:137], v[136:137], s[76:77]
  v_pk_add_f32 v[138:139], v[138:139], s[76:77]
  v_pk_add_f32 v[68:69], v[68:69], v[132:133]
  v_pk_add_f32 v[70:71], v[70:71], v[134:135]
  v_pk_add_f32 v[72:73], v[72:73], v[136:137]
  v_pk_add_f32 v[74:75], v[74:75], v[138:139]
  s_lshl_b32 s65, s32, 10
  s_add_u32 s65, s65, 7340032
  v_cvt_pk_bf16_f32 v68, v68, v69
  v_cvt_pk_bf16_f32 v69, v70, v71
  v_cvt_pk_bf16_f32 v70, v72, v73
  v_cvt_pk_bf16_f32 v71, v74, v75
  buffer_store_dwordx4 v[68:71], v20, s[12:15], s65 offen sc1
  s_add_u32 s64, s82, 7
  s_and_b32 s64, s64, 31
  s_lshl_b32 s28, s64, 6
  s_add_u32 s32, s28, s27
  v_pk_mul_f32 v[132:133], v[76:77], s[78:79]
  v_pk_mul_f32 v[134:135], v[78:79], s[78:79]
  v_pk_mul_f32 v[136:137], v[80:81], s[78:79]
  v_pk_mul_f32 v[138:139], v[82:83], s[78:79]
  v_exp_f32_e64 v132, v132 clamp
  v_exp_f32_e64 v133, v133 clamp
  v_exp_f32_e64 v134, v134 clamp
  v_exp_f32_e64 v135, v135 clamp
  v_exp_f32_e64 v136, v136 clamp
  v_exp_f32_e64 v137, v137 clamp
  v_exp_f32_e64 v138, v138 clamp
  v_exp_f32_e64 v139, v139 clamp
  v_max_f32 v76, 0, v76
  v_max_f32 v77, 0, v77
  v_max_f32 v78, 0, v78
  v_max_f32 v79, 0, v79
  v_max_f32 v80, 0, v80
  v_max_f32 v81, 0, v81
  v_max_f32 v82, 0, v82
  v_max_f32 v83, 0, v83
  v_pk_add_f32 v[132:133], v[132:133], s[76:77]
  v_pk_add_f32 v[134:135], v[134:135], s[76:77]
  v_pk_add_f32 v[136:137], v[136:137], s[76:77]
  v_pk_add_f32 v[138:139], v[138:139], s[76:77]
  v_pk_add_f32 v[76:77], v[76:77], v[132:133]
  v_pk_add_f32 v[78:79], v[78:79], v[134:135]
  v_pk_add_f32 v[80:81], v[80:81], v[136:137]
  v_pk_add_f32 v[82:83], v[82:83], v[138:139]
  s_lshl_b32 s65, s32, 10
  s_add_u32 s65, s65, 7340032
  v_cvt_pk_bf16_f32 v76, v76, v77
  v_cvt_pk_bf16_f32 v77, v78, v79
  v_cvt_pk_bf16_f32 v78, v80, v81
  v_cvt_pk_bf16_f32 v79, v82, v83
  buffer_store_dwordx4 v[76:79], v20, s[12:15], s65 offen sc1
  s_add_u32 s64, s82, 10
  s_and_b32 s64, s64, 31
  s_lshl_b32 s28, s64, 6
  s_add_u32 s32, s28, s27
  v_pk_mul_f32 v[132:133], v[84:85], s[78:79]
  v_pk_mul_f32 v[134:135], v[86:87], s[78:79]
  v_pk_mul_f32 v[136:137], v[88:89], s[78:79]
  v_pk_mul_f32 v[138:139], v[90:91], s[78:79]
  v_exp_f32_e64 v132, v132 clamp
  v_exp_f32_e64 v133, v133 clamp
  v_exp_f32_e64 v134, v134 clamp
  v_exp_f32_e64 v135, v135 clamp
  v_exp_f32_e64 v136, v136 clamp
  v_exp_f32_e64 v137, v137 clamp
  v_exp_f32_e64 v138, v138 clamp
  v_exp_f32_e64 v139, v139 clamp
  v_max_f32 v84, 0, v84
  v_max_f32 v85, 0, v85
  v_max_f32 v86, 0, v86
  v_max_f32 v87, 0, v87
  v_max_f32 v88, 0, v88
  v_max_f32 v89, 0, v89
  v_max_f32 v90, 0, v90
  v_max_f32 v91, 0, v91
  v_pk_add_f32 v[132:133], v[132:133], s[76:77]
  v_pk_add_f32 v[134:135], v[134:135], s[76:77]
  v_pk_add_f32 v[136:137], v[136:137], s[76:77]
  v_pk_add_f32 v[138:139], v[138:139], s[76:77]
  v_pk_add_f32 v[84:85], v[84:85], v[132:133]
  v_pk_add_f32 v[86:87], v[86:87], v[134:135]
  v_pk_add_f32 v[88:89], v[88:89], v[136:137]
  v_pk_add_f32 v[90:91], v[90:91], v[138:139]
  s_lshl_b32 s65, s32, 10
  s_add_u32 s65, s65, 7340032
  v_cvt_pk_bf16_f32 v84, v84, v85
  v_cvt_pk_bf16_f32 v85, v86, v87
  v_cvt_pk_bf16_f32 v86, v88, v89
  v_cvt_pk_bf16_f32 v87, v90, v91
  buffer_store_dwordx4 v[84:87], v20, s[12:15], s65 offen sc1
  s_add_u32 s64, s82, 9
  s_and_b32 s64, s64, 31
  s_lshl_b32 s28, s64, 6
  s_add_u32 s32, s28, s27
  v_pk_mul_f32 v[132:133], v[92:93], s[78:79]
  v_pk_mul_f32 v[134:135], v[94:95], s[78:79]
  v_pk_mul_f32 v[136:137], v[96:97], s[78:79]
  v_pk_mul_f32 v[138:139], v[98:99], s[78:79]
  v_exp_f32_e64 v132, v132 clamp
  v_exp_f32_e64 v133, v133 clamp
  v_exp_f32_e64 v134, v134 clamp
  v_exp_f32_e64 v135, v135 clamp
  v_exp_f32_e64 v136, v136 clamp
  v_exp_f32_e64 v137, v137 clamp
  v_exp_f32_e64 v138, v138 clamp
  v_exp_f32_e64 v139, v139 clamp
  v_max_f32 v92, 0, v92
  v_max_f32 v93, 0, v93
  v_max_f32 v94, 0, v94
  v_max_f32 v95, 0, v95
  v_max_f32 v96, 0, v96
  v_max_f32 v97, 0, v97
  v_max_f32 v98, 0, v98
  v_max_f32 v99, 0, v99
  v_pk_add_f32 v[132:133], v[132:133], s[76:77]
  v_pk_add_f32 v[134:135], v[134:135], s[76:77]
  v_pk_add_f32 v[136:137], v[136:137], s[76:77]
  v_pk_add_f32 v[138:139], v[138:139], s[76:77]
  v_pk_add_f32 v[92:93], v[92:93], v[132:133]
  v_pk_add_f32 v[94:95], v[94:95], v[134:135]
  v_pk_add_f32 v[96:97], v[96:97], v[136:137]
  v_pk_add_f32 v[98:99], v[98:99], v[138:139]
  s_lshl_b32 s65, s32, 10
  s_add_u32 s65, s65, 7340032
  v_cvt_pk_bf16_f32 v92, v92, v93
  v_cvt_pk_bf16_f32 v93, v94, v95
  v_cvt_pk_bf16_f32 v94, v96, v97
  v_cvt_pk_bf16_f32 v95, v98, v99
  buffer_store_dwordx4 v[92:95], v20, s[12:15], s65 offen sc1
  s_add_u32 s64, s82, 0
  s_and_b32 s64, s64, 31
  s_lshl_b32 s28, s64, 6
  s_add_u32 s32, s28, s27
  s_lshl_b32 s31, s32, 7
  v_mul_f32 v132, v100, v100
  v_mul_f32 v133, v102, v102
  v_fmac_f32 v132, v101, v101
  v_fmac_f32 v133, v103, v103
  s_add_u32 s29, s31, 19949568
  s_add_u32 s30, s29, 8192
  buffer_store_dword v132, v2, s[12:15], s29 offen sc1
  buffer_store_dword v133, v2, s[12:15], s30 offen sc1
  s_mul_i32 s65, s64, 155648
  s_add_u32 s65, s65, s81
  s_add_u32 s32, s65, 155648
  v_cvt_pk_bf16_f32 v100, v100, v101
  v_cvt_pk_bf16_f32 v101, v102, v103
  buffer_store_dword v100, v3, s[12:15], s65 offen sc1
  buffer_store_dword v101, v3, s[12:15], s32 offen sc1
  s_add_u32 s64, s82, 4
  s_and_b32 s64, s64, 31
  s_lshl_b32 s28, s64, 6
  s_add_u32 s32, s28, s27
  s_lshl_b32 s31, s32, 7
  v_pk_mul_f32 v[132:133], v[104:105], s[78:79]
  v_pk_mul_f32 v[134:135], v[106:107], s[78:79]
  v_exp_f32_e64 v132, v132 clamp
  v_exp_f32_e64 v133, v133 clamp
  v_exp_f32_e64 v134, v134 clamp
  v_exp_f32_e64 v135, v135 clamp
  v_max_f32 v104, 0, v104
  v_max_f32 v105, 0, v105
  v_max_f32 v106, 0, v106
  v_max_f32 v107, 0, v107
  v_pk_add_f32 v[132:133], v[132:133], s[76:77]
  v_pk_add_f32 v[134:135], v[134:135], s[76:77]
  v_pk_add_f32 v[104:105], v[104:105], v[132:133]
  v_pk_add_f32 v[106:107], v[106:107], v[134:135]
  s_add_u32 s65, s31, 9437184
  s_add_u32 s32, s65, 8192
  v_cvt_pk_bf16_f32 v104, v104, v105
  v_cvt_pk_bf16_f32 v105, v106, v107
  buffer_store_dword v104, v2, s[12:15], s65 offen sc1
  buffer_store_dword v105, v2, s[12:15], s32 offen sc1
  s_add_u32 s64, s82, 8
  s_and_b32 s64, s64, 31
  s_lshl_b32 s28, s64, 6
  s_add_u32 s32, s28, s27
  s_lshl_b32 s31, s32, 7
  v_pk_mul_f32 v[132:133], v[108:109], s[78:79]
  v_pk_mul_f32 v[134:135], v[110:111], s[78:79]
  v_exp_f32_e64 v132, v132 clamp
  v_exp_f32_e64 v133, v133 clamp
  v_exp_f32_e64 v134, v134 clamp
  v_exp_f32_e64 v135, v135 clamp
  v_max_f32 v108, 0, v108
  v_max_f32 v109, 0, v109
  v_max_f32 v110, 0, v110
  v_max_f32 v111, 0, v111
  v_pk_add_f32 v[132:133], v[132:133], s[76:77]
  v_pk_add_f32 v[134:135], v[134:135], s[76:77]
  v_pk_add_f32 v[108:109], v[108:109], v[132:133]
  v_pk_add_f32 v[110:111], v[110:111], v[134:135]
  s_add_u32 s65, s31, 9437184
  s_add_u32 s32, s65, 8192
  v_cvt_pk_bf16_f32 v108, v108, v109
  v_cvt_pk_bf16_f32 v109, v110, v111
  buffer_store_dword v108, v2, s[12:15], s65 offen sc1
  buffer_store_dword v109, v2, s[12:15], s32 offen sc1
  s_branch gated_mix__linear_attn_block__mha_block__prompt_kernel_e01_kd
gated_mix__linear_attn_block__mha_block__prompt_kernel_e01_k6:
  s_add_u32 s64, s82, 8
  s_and_b32 s64, s64, 31
  s_lshl_b32 s28, s64, 6
  s_add_u32 s32, s28, s27
  v_pk_mul_f32 v[132:133], v[68:69], s[78:79]
  v_pk_mul_f32 v[134:135], v[70:71], s[78:79]
  v_pk_mul_f32 v[136:137], v[72:73], s[78:79]
  v_pk_mul_f32 v[138:139], v[74:75], s[78:79]
  v_exp_f32_e64 v132, v132 clamp
  v_exp_f32_e64 v133, v133 clamp
  v_exp_f32_e64 v134, v134 clamp
  v_exp_f32_e64 v135, v135 clamp
  v_exp_f32_e64 v136, v136 clamp
  v_exp_f32_e64 v137, v137 clamp
  v_exp_f32_e64 v138, v138 clamp
  v_exp_f32_e64 v139, v139 clamp
  v_max_f32 v68, 0, v68
  v_max_f32 v69, 0, v69
  v_max_f32 v70, 0, v70
  v_max_f32 v71, 0, v71
  v_max_f32 v72, 0, v72
  v_max_f32 v73, 0, v73
  v_max_f32 v74, 0, v74
  v_max_f32 v75, 0, v75
  v_pk_add_f32 v[132:133], v[132:133], s[76:77]
  v_pk_add_f32 v[134:135], v[134:135], s[76:77]
  v_pk_add_f32 v[136:137], v[136:137], s[76:77]
  v_pk_add_f32 v[138:139], v[138:139], s[76:77]
  v_pk_add_f32 v[68:69], v[68:69], v[132:133]
  v_pk_add_f32 v[70:71], v[70:71], v[134:135]
  v_pk_add_f32 v[72:73], v[72:73], v[136:137]
  v_pk_add_f32 v[74:75], v[74:75], v[138:139]
  s_lshl_b32 s65, s32, 10
  s_add_u32 s65, s65, 7340032
  v_cvt_pk_bf16_f32 v68, v68, v69
  v_cvt_pk_bf16_f32 v69, v70, v71
  v_cvt_pk_bf16_f32 v70, v72, v73
  v_cvt_pk_bf16_f32 v71, v74, v75
  buffer_store_dwordx4 v[68:71], v20, s[12:15], s65 offen sc1
  s_add_u32 s64, s82, 7
  s_and_b32 s64, s64, 31
  s_lshl_b32 s28, s64, 6
  s_add_u32 s32, s28, s27
  v_pk_mul_f32 v[132:133], v[76:77], s[78:79]
  v_pk_mul_f32 v[134:135], v[78:79], s[78:79]
  v_pk_mul_f32 v[136:137], v[80:81], s[78:79]
  v_pk_mul_f32 v[138:139], v[82:83], s[78:79]
  v_exp_f32_e64 v132, v132 clamp
  v_exp_f32_e64 v133, v133 clamp
  v_exp_f32_e64 v134, v134 clamp
  v_exp_f32_e64 v135, v135 clamp
  v_exp_f32_e64 v136, v136 clamp
  v_exp_f32_e64 v137, v137 clamp
  v_exp_f32_e64 v138, v138 clamp
  v_exp_f32_e64 v139, v139 clamp
  v_max_f32 v76, 0, v76
  v_max_f32 v77, 0, v77
  v_max_f32 v78, 0, v78
  v_max_f32 v79, 0, v79
  v_max_f32 v80, 0, v80
  v_max_f32 v81, 0, v81
  v_max_f32 v82, 0, v82
  v_max_f32 v83, 0, v83
  v_pk_add_f32 v[132:133], v[132:133], s[76:77]
  v_pk_add_f32 v[134:135], v[134:135], s[76:77]
  v_pk_add_f32 v[136:137], v[136:137], s[76:77]
  v_pk_add_f32 v[138:139], v[138:139], s[76:77]
  v_pk_add_f32 v[76:77], v[76:77], v[132:133]
  v_pk_add_f32 v[78:79], v[78:79], v[134:135]
  v_pk_add_f32 v[80:81], v[80:81], v[136:137]
  v_pk_add_f32 v[82:83], v[82:83], v[138:139]
  s_lshl_b32 s65, s32, 10
  s_add_u32 s65, s65, 7340032
  v_cvt_pk_bf16_f32 v76, v76, v77
  v_cvt_pk_bf16_f32 v77, v78, v79
  v_cvt_pk_bf16_f32 v78, v80, v81
  v_cvt_pk_bf16_f32 v79, v82, v83
  buffer_store_dwordx4 v[76:79], v20, s[12:15], s65 offen sc1
  s_add_u32 s64, s82, 10
  s_and_b32 s64, s64, 31
  s_lshl_b32 s28, s64, 6
  s_add_u32 s32, s28, s27
  v_pk_mul_f32 v[132:133], v[84:85], s[78:79]
  v_pk_mul_f32 v[134:135], v[86:87], s[78:79]
  v_pk_mul_f32 v[136:137], v[88:89], s[78:79]
  v_pk_mul_f32 v[138:139], v[90:91], s[78:79]
  v_exp_f32_e64 v132, v132 clamp
  v_exp_f32_e64 v133, v133 clamp
  v_exp_f32_e64 v134, v134 clamp
  v_exp_f32_e64 v135, v135 clamp
  v_exp_f32_e64 v136, v136 clamp
  v_exp_f32_e64 v137, v137 clamp
  v_exp_f32_e64 v138, v138 clamp
  v_exp_f32_e64 v139, v139 clamp
  v_max_f32 v84, 0, v84
  v_max_f32 v85, 0, v85
  v_max_f32 v86, 0, v86
  v_max_f32 v87, 0, v87
  v_max_f32 v88, 0, v88
  v_max_f32 v89, 0, v89
  v_max_f32 v90, 0, v90
  v_max_f32 v91, 0, v91
  v_pk_add_f32 v[132:133], v[132:133], s[76:77]
  v_pk_add_f32 v[134:135], v[134:135], s[76:77]
  v_pk_add_f32 v[136:137], v[136:137], s[76:77]
  v_pk_add_f32 v[138:139], v[138:139], s[76:77]
  v_pk_add_f32 v[84:85], v[84:85], v[132:133]
  v_pk_add_f32 v[86:87], v[86:87], v[134:135]
  v_pk_add_f32 v[88:89], v[88:89], v[136:137]
  v_pk_add_f32 v[90:91], v[90:91], v[138:139]
  s_lshl_b32 s65, s32, 10
  s_add_u32 s65, s65, 7340032
  v_cvt_pk_bf16_f32 v84, v84, v85
  v_cvt_pk_bf16_f32 v85, v86, v87
  v_cvt_pk_bf16_f32 v86, v88, v89
  v_cvt_pk_bf16_f32 v87, v90, v91
  buffer_store_dwordx4 v[84:87], v20, s[12:15], s65 offen sc1
  s_add_u32 s64, s82, 9
  s_and_b32 s64, s64, 31
  s_lshl_b32 s28, s64, 6
  s_add_u32 s32, s28, s27
  v_pk_mul_f32 v[132:133], v[92:93], s[78:79]
  v_pk_mul_f32 v[134:135], v[94:95], s[78:79]
  v_pk_mul_f32 v[136:137], v[96:97], s[78:79]
  v_pk_mul_f32 v[138:139], v[98:99], s[78:79]
  v_exp_f32_e64 v132, v132 clamp
  v_exp_f32_e64 v133, v133 clamp
  v_exp_f32_e64 v134, v134 clamp
  v_exp_f32_e64 v135, v135 clamp
  v_exp_f32_e64 v136, v136 clamp
  v_exp_f32_e64 v137, v137 clamp
  v_exp_f32_e64 v138, v138 clamp
  v_exp_f32_e64 v139, v139 clamp
  v_max_f32 v92, 0, v92
  v_max_f32 v93, 0, v93
  v_max_f32 v94, 0, v94
  v_max_f32 v95, 0, v95
  v_max_f32 v96, 0, v96
  v_max_f32 v97, 0, v97
  v_max_f32 v98, 0, v98
  v_max_f32 v99, 0, v99
  v_pk_add_f32 v[132:133], v[132:133], s[76:77]
  v_pk_add_f32 v[134:135], v[134:135], s[76:77]
  v_pk_add_f32 v[136:137], v[136:137], s[76:77]
  v_pk_add_f32 v[138:139], v[138:139], s[76:77]
  v_pk_add_f32 v[92:93], v[92:93], v[132:133]
  v_pk_add_f32 v[94:95], v[94:95], v[134:135]
  v_pk_add_f32 v[96:97], v[96:97], v[136:137]
  v_pk_add_f32 v[98:99], v[98:99], v[138:139]
  s_lshl_b32 s65, s32, 10
  s_add_u32 s65, s65, 7340032
  v_cvt_pk_bf16_f32 v92, v92, v93
  v_cvt_pk_bf16_f32 v93, v94, v95
  v_cvt_pk_bf16_f32 v94, v96, v97
  v_cvt_pk_bf16_f32 v95, v98, v99
  buffer_store_dwordx4 v[92:95], v20, s[12:15], s65 offen sc1
  s_add_u32 s64, s82, 0
  s_and_b32 s64, s64, 31
  s_lshl_b32 s28, s64, 6
  s_add_u32 s32, s28, s27
  s_lshl_b32 s31, s32, 7
  v_pk_mul_f32 v[132:133], v[100:101], s[78:79]
  v_pk_mul_f32 v[134:135], v[102:103], s[78:79]
  v_exp_f32_e64 v132, v132 clamp
  v_exp_f32_e64 v133, v133 clamp
  v_exp_f32_e64 v134, v134 clamp
  v_exp_f32_e64 v135, v135 clamp
  v_max_f32 v100, 0, v100
  v_max_f32 v101, 0, v101
  v_max_f32 v102, 0, v102
  v_max_f32 v103, 0, v103
  v_pk_add_f32 v[132:133], v[132:133], s[76:77]
  v_pk_add_f32 v[134:135], v[134:135], s[76:77]
  v_pk_add_f32 v[100:101], v[100:101], v[132:133]
  v_pk_add_f32 v[102:103], v[102:103], v[134:135]
  s_add_u32 s65, s31, 9437184
  s_add_u32 s32, s65, 8192
  v_cvt_pk_bf16_f32 v100, v100, v101
  v_cvt_pk_bf16_f32 v101, v102, v103
  buffer_store_dword v100, v2, s[12:15], s65 offen sc1
  buffer_store_dword v101, v2, s[12:15], s32 offen sc1
  s_add_u32 s64, s82, 4
  s_and_b32 s64, s64, 31
  s_lshl_b32 s28, s64, 6
  s_add_u32 s32, s28, s27
  s_lshl_b32 s31, s32, 7
  v_pk_mul_f32 v[132:133], v[104:105], s[78:79]
  v_pk_mul_f32 v[134:135], v[106:107], s[78:79]
  v_exp_f32_e64 v132, v132 clamp
  v_exp_f32_e64 v133, v133 clamp
  v_exp_f32_e64 v134, v134 clamp
  v_exp_f32_e64 v135, v135 clamp
  v_max_f32 v104, 0, v104
  v_max_f32 v105, 0, v105
  v_max_f32 v106, 0, v106
  v_max_f32 v107, 0, v107
  v_pk_add_f32 v[132:133], v[132:133], s[76:77]
  v_pk_add_f32 v[134:135], v[134:135], s[76:77]
  v_pk_add_f32 v[104:105], v[104:105], v[132:133]
  v_pk_add_f32 v[106:107], v[106:107], v[134:135]
  s_add_u32 s65, s31, 9437184
  s_add_u32 s32, s65, 8192
  v_cvt_pk_bf16_f32 v104, v104, v105
  v_cvt_pk_bf16_f32 v105, v106, v107
  buffer_store_dword v104, v2, s[12:15], s65 offen sc1
  buffer_store_dword v105, v2, s[12:15], s32 offen sc1
  s_add_u32 s64, s82, 8
  s_and_b32 s64, s64, 31
  s_lshl_b32 s28, s64, 6
  s_add_u32 s32, s28, s27
  s_lshl_b32 s31, s32, 7
  v_pk_mul_f32 v[132:133], v[108:109], s[78:79]
  v_pk_mul_f32 v[134:135], v[110:111], s[78:79]
  v_exp_f32_e64 v132, v132 clamp
  v_exp_f32_e64 v133, v133 clamp
  v_exp_f32_e64 v134, v134 clamp
  v_exp_f32_e64 v135, v135 clamp
  v_max_f32 v108, 0, v108
  v_max_f32 v109, 0, v109
  v_max_f32 v110, 0, v110
  v_max_f32 v111, 0, v111
  v_pk_add_f32 v[132:133], v[132:133], s[76:77]
  v_pk_add_f32 v[134:135], v[134:135], s[76:77]
  v_pk_add_f32 v[108:109], v[108:109], v[132:133]
  v_pk_add_f32 v[110:111], v[110:111], v[134:135]
  s_add_u32 s65, s31, 9437184
  s_add_u32 s32, s65, 8192
  v_cvt_pk_bf16_f32 v108, v108, v109
  v_cvt_pk_bf16_f32 v109, v110, v111
  buffer_store_dword v108, v2, s[12:15], s65 offen sc1
  buffer_store_dword v109, v2, s[12:15], s32 offen sc1
gated_mix__linear_attn_block__mha_block__prompt_kernel_e01_kd:
  s_barrier
  s_branch gated_mix__linear_attn_block__mha_block__prompt_kernel_c2
gated_mix__linear_attn_block__mha_block__prompt_kernel_v10:
  v_mul_u32_u24 v7, 320, v22
  s_mul_i32 s28, s25, 1280
  v_add_u32 v7, s28, v7
  v_and_b32 v3, 15, v21
  v_lshlrev_b32 v3, 4, v3
  v_add_u32 v3, v3, v7
  v_cmp_gt_u32 vcc, 16, v21
  v_mov_b32 v2, 56320
  v_mov_b32 v140, 0
  v_cndmask_b32 v2, v2, v140, vcc
  v_add_u32 v140, v2, v3
  v_mov_b32 v2, 5120
  v_mov_b32 v141, 10240
  v_cndmask_b32 v2, v2, v141, vcc
  v_add_u32 v141, v2, v3
  v_mov_b32 v2, 15360
  v_mov_b32 v142, 20480
  v_cndmask_b32 v2, v2, v142, vcc
  v_add_u32 v142, v2, v3
  v_mov_b32 v2, 25600
  v_mov_b32 v143, 30720
  v_cndmask_b32 v2, v2, v143, vcc
  v_add_u32 v143, v2, v3
  s_barrier
  ds_read_b128 v[28:31], v16
  ds_read_b64_tr_b16 v[36:37], v12 offset:0
  ds_read_b64_tr_b16 v[38:39], v12 offset:2048
  ds_read_b64_tr_b16 v[40:41], v13 offset:0
  ds_read_b64_tr_b16 v[42:43], v13 offset:2048
  ds_read_b64_tr_b16 v[44:45], v14 offset:0
  ds_read_b64_tr_b16 v[46:47], v14 offset:2048
  ds_read_b64_tr_b16 v[48:49], v15 offset:0
  ds_read_b64_tr_b16 v[50:51], v15 offset:2048
  s_mov_b32 s38, 0
gated_mix__linear_attn_block__mha_block__prompt_kernel_g10_loop:
  ds_read_b128 v[32:35], v17
  ds_read_b64_tr_b16 v[52:53], v12 offset:8192
  ds_read_b64_tr_b16 v[54:55], v12 offset:10240
  ds_read_b64_tr_b16 v[56:57], v13 offset:8192
  ds_read_b64_tr_b16 v[58:59], v13 offset:10240
  ds_read_b64_tr_b16 v[60:61], v14 offset:8192
  ds_read_b64_tr_b16 v[62:63], v14 offset:10240
  ds_read_b64_tr_b16 v[64:65], v15 offset:8192
  ds_read_b64_tr_b16 v[66:67], v15 offset:10240
  s_waitcnt lgkmcnt(9)
  v_mfma_f32_32x32x16_bf16 v[68:83], v[28:31], v[36:39], v[68:83]
  v_mfma_f32_32x32x16_bf16 v[84:99], v[28:31], v[40:43], v[84:99]
  v_mfma_f32_32x32x16_bf16 v[100:115], v[28:31], v[44:47], v[100:115]
  v_mfma_f32_32x32x16_bf16 v[116:131], v[28:31], v[48:51], v[116:131]
  ds_read_b128 v[28:31], v18
  ds_read_b64_tr_b16 v[36:37], v12 offset:16384
  ds_read_b64_tr_b16 v[38:39], v12 offset:18432
  ds_read_b64_tr_b16 v[40:41], v13 offset:16384
  ds_read_b64_tr_b16 v[42:43], v13 offset:18432
  ds_read_b64_tr_b16 v[44:45], v14 offset:16384
  ds_read_b64_tr_b16 v[46:47], v14 offset:18432
  ds_read_b64_tr_b16 v[48:49], v15 offset:16384
  ds_read_b64_tr_b16 v[50:51], v15 offset:18432
  s_waitcnt lgkmcnt(9)
  v_mfma_f32_32x32x16_bf16 v[68:83], v[32:35], v[52:55], v[68:83]
  v_mfma_f32_32x32x16_bf16 v[84:99], v[32:35], v[56:59], v[84:99]
  v_mfma_f32_32x32x16_bf16 v[100:115], v[32:35], v[60:63], v[100:115]
  v_mfma_f32_32x32x16_bf16 v[116:131], v[32:35], v[64:67], v[116:131]
  ds_read_b128 v[32:35], v19
  ds_read_b64_tr_b16 v[52:53], v12 offset:24576
  ds_read_b64_tr_b16 v[54:55], v12 offset:26624
  ds_read_b64_tr_b16 v[56:57], v13 offset:24576
  ds_read_b64_tr_b16 v[58:59], v13 offset:26624
  ds_read_b64_tr_b16 v[60:61], v14 offset:24576
  ds_read_b64_tr_b16 v[62:63], v14 offset:26624
  ds_read_b64_tr_b16 v[64:65], v15 offset:24576
  ds_read_b64_tr_b16 v[66:67], v15 offset:26624
  s_waitcnt lgkmcnt(9)
  v_mfma_f32_32x32x16_bf16 v[68:83], v[28:31], v[36:39], v[68:83]
  v_mfma_f32_32x32x16_bf16 v[84:99], v[28:31], v[40:43], v[84:99]
  v_mfma_f32_32x32x16_bf16 v[100:115], v[28:31], v[44:47], v[100:115]
  v_mfma_f32_32x32x16_bf16 v[116:131], v[28:31], v[48:51], v[116:131]
  s_waitcnt lgkmcnt(0)
  s_barrier
  v_add_u32 v12, 49152, v12
  v_add_u32 v13, 49152, v13
  v_add_u32 v14, 49152, v14
  v_add_u32 v15, 49152, v15
  v_add_u32 v16, 49152, v16
  v_add_u32 v17, 49152, v17
  v_add_u32 v18, 49152, v18
  v_add_u32 v19, 49152, v19
  ds_read_b128 v[28:31], v16
  ds_read_b64_tr_b16 v[36:37], v12 offset:0
  ds_read_b64_tr_b16 v[38:39], v12 offset:2048
  ds_read_b64_tr_b16 v[40:41], v13 offset:0
  ds_read_b64_tr_b16 v[42:43], v13 offset:2048
  ds_read_b64_tr_b16 v[44:45], v14 offset:0
  ds_read_b64_tr_b16 v[46:47], v14 offset:2048
  ds_read_b64_tr_b16 v[48:49], v15 offset:0
  ds_read_b64_tr_b16 v[50:51], v15 offset:2048
  v_mfma_f32_32x32x16_bf16 v[68:83], v[32:35], v[52:55], v[68:83]
  v_mfma_f32_32x32x16_bf16 v[84:99], v[32:35], v[56:59], v[84:99]
  v_mfma_f32_32x32x16_bf16 v[100:115], v[32:35], v[60:63], v[100:115]
  v_mfma_f32_32x32x16_bf16 v[116:131], v[32:35], v[64:67], v[116:131]
  ds_read_b128 v[32:35], v17
  ds_read_b64_tr_b16 v[52:53], v12 offset:8192
  ds_read_b64_tr_b16 v[54:55], v12 offset:10240
  ds_read_b64_tr_b16 v[56:57], v13 offset:8192
  ds_read_b64_tr_b16 v[58:59], v13 offset:10240
  ds_read_b64_tr_b16 v[60:61], v14 offset:8192
  ds_read_b64_tr_b16 v[62:63], v14 offset:10240
  ds_read_b64_tr_b16 v[64:65], v15 offset:8192
  ds_read_b64_tr_b16 v[66:67], v15 offset:10240
  s_waitcnt lgkmcnt(9)
  v_mfma_f32_32x32x16_bf16 v[68:83], v[28:31], v[36:39], v[68:83]
  v_mfma_f32_32x32x16_bf16 v[84:99], v[28:31], v[40:43], v[84:99]
  v_mfma_f32_32x32x16_bf16 v[100:115], v[28:31], v[44:47], v[100:115]
  v_mfma_f32_32x32x16_bf16 v[116:131], v[28:31], v[48:51], v[116:131]
  ds_read_b128 v[28:31], v18
  ds_read_b64_tr_b16 v[36:37], v12 offset:16384
  ds_read_b64_tr_b16 v[38:39], v12 offset:18432
  ds_read_b64_tr_b16 v[40:41], v13 offset:16384
  ds_read_b64_tr_b16 v[42:43], v13 offset:18432
  ds_read_b64_tr_b16 v[44:45], v14 offset:16384
  ds_read_b64_tr_b16 v[46:47], v14 offset:18432
  ds_read_b64_tr_b16 v[48:49], v15 offset:16384
  ds_read_b64_tr_b16 v[50:51], v15 offset:18432
  s_waitcnt lgkmcnt(9)
  v_mfma_f32_32x32x16_bf16 v[68:83], v[32:35], v[52:55], v[68:83]
  v_mfma_f32_32x32x16_bf16 v[84:99], v[32:35], v[56:59], v[84:99]
  v_mfma_f32_32x32x16_bf16 v[100:115], v[32:35], v[60:63], v[100:115]
  v_mfma_f32_32x32x16_bf16 v[116:131], v[32:35], v[64:67], v[116:131]
  ds_read_b128 v[32:35], v19
  ds_read_b64_tr_b16 v[52:53], v12 offset:24576
  ds_read_b64_tr_b16 v[54:55], v12 offset:26624
  ds_read_b64_tr_b16 v[56:57], v13 offset:24576
  ds_read_b64_tr_b16 v[58:59], v13 offset:26624
  ds_read_b64_tr_b16 v[60:61], v14 offset:24576
  ds_read_b64_tr_b16 v[62:63], v14 offset:26624
  ds_read_b64_tr_b16 v[64:65], v15 offset:24576
  ds_read_b64_tr_b16 v[66:67], v15 offset:26624
  s_waitcnt lgkmcnt(9)
  v_mfma_f32_32x32x16_bf16 v[68:83], v[28:31], v[36:39], v[68:83]
  v_mfma_f32_32x32x16_bf16 v[84:99], v[28:31], v[40:43], v[84:99]
  v_mfma_f32_32x32x16_bf16 v[100:115], v[28:31], v[44:47], v[100:115]
  v_mfma_f32_32x32x16_bf16 v[116:131], v[28:31], v[48:51], v[116:131]
  s_waitcnt lgkmcnt(0)
  s_barrier
  v_add_u32 v12, 49152, v12
  v_add_u32 v13, 49152, v13
  v_add_u32 v14, 49152, v14
  v_add_u32 v15, 49152, v15
  v_add_u32 v16, 49152, v16
  v_add_u32 v17, 49152, v17
  v_add_u32 v18, 49152, v18
  v_add_u32 v19, 49152, v19
  ds_read_b128 v[28:31], v16
  ds_read_b64_tr_b16 v[36:37], v12 offset:0
  ds_read_b64_tr_b16 v[38:39], v12 offset:2048
  ds_read_b64_tr_b16 v[40:41], v13 offset:0
  ds_read_b64_tr_b16 v[42:43], v13 offset:2048
  ds_read_b64_tr_b16 v[44:45], v14 offset:0
  ds_read_b64_tr_b16 v[46:47], v14 offset:2048
  ds_read_b64_tr_b16 v[48:49], v15 offset:0
  ds_read_b64_tr_b16 v[50:51], v15 offset:2048
  v_mfma_f32_32x32x16_bf16 v[68:83], v[32:35], v[52:55], v[68:83]
  v_mfma_f32_32x32x16_bf16 v[84:99], v[32:35], v[56:59], v[84:99]
  v_mfma_f32_32x32x16_bf16 v[100:115], v[32:35], v[60:63], v[100:115]
  v_mfma_f32_32x32x16_bf16 v[116:131], v[32:35], v[64:67], v[116:131]
  ds_read_b128 v[32:35], v17
  ds_read_b64_tr_b16 v[52:53], v12 offset:8192
  ds_read_b64_tr_b16 v[54:55], v12 offset:10240
  ds_read_b64_tr_b16 v[56:57], v13 offset:8192
  ds_read_b64_tr_b16 v[58:59], v13 offset:10240
  ds_read_b64_tr_b16 v[60:61], v14 offset:8192
  ds_read_b64_tr_b16 v[62:63], v14 offset:10240
  ds_read_b64_tr_b16 v[64:65], v15 offset:8192
  ds_read_b64_tr_b16 v[66:67], v15 offset:10240
  s_waitcnt lgkmcnt(9)
  v_mfma_f32_32x32x16_bf16 v[68:83], v[28:31], v[36:39], v[68:83]
  v_mfma_f32_32x32x16_bf16 v[84:99], v[28:31], v[40:43], v[84:99]
  v_mfma_f32_32x32x16_bf16 v[100:115], v[28:31], v[44:47], v[100:115]
  v_mfma_f32_32x32x16_bf16 v[116:131], v[28:31], v[48:51], v[116:131]
  ds_read_b128 v[28:31], v18
  ds_read_b64_tr_b16 v[36:37], v12 offset:16384
  ds_read_b64_tr_b16 v[38:39], v12 offset:18432
  ds_read_b64_tr_b16 v[40:41], v13 offset:16384
  ds_read_b64_tr_b16 v[42:43], v13 offset:18432
  ds_read_b64_tr_b16 v[44:45], v14 offset:16384
  ds_read_b64_tr_b16 v[46:47], v14 offset:18432
  ds_read_b64_tr_b16 v[48:49], v15 offset:16384
  ds_read_b64_tr_b16 v[50:51], v15 offset:18432
  s_waitcnt lgkmcnt(9)
  v_mfma_f32_32x32x16_bf16 v[68:83], v[32:35], v[52:55], v[68:83]
  v_mfma_f32_32x32x16_bf16 v[84:99], v[32:35], v[56:59], v[84:99]
  v_mfma_f32_32x32x16_bf16 v[100:115], v[32:35], v[60:63], v[100:115]
  v_mfma_f32_32x32x16_bf16 v[116:131], v[32:35], v[64:67], v[116:131]
  ds_read_b128 v[32:35], v19
  ds_read_b64_tr_b16 v[52:53], v12 offset:24576
  ds_read_b64_tr_b16 v[54:55], v12 offset:26624
  ds_read_b64_tr_b16 v[56:57], v13 offset:24576
  ds_read_b64_tr_b16 v[58:59], v13 offset:26624
  ds_read_b64_tr_b16 v[60:61], v14 offset:24576
  ds_read_b64_tr_b16 v[62:63], v14 offset:26624
  ds_read_b64_tr_b16 v[64:65], v15 offset:24576
  ds_read_b64_tr_b16 v[66:67], v15 offset:26624
  s_waitcnt lgkmcnt(9)
  v_mfma_f32_32x32x16_bf16 v[68:83], v[28:31], v[36:39], v[68:83]
  v_mfma_f32_32x32x16_bf16 v[84:99], v[28:31], v[40:43], v[84:99]
  v_mfma_f32_32x32x16_bf16 v[100:115], v[28:31], v[44:47], v[100:115]
  v_mfma_f32_32x32x16_bf16 v[116:131], v[28:31], v[48:51], v[116:131]
  s_waitcnt lgkmcnt(0)
  s_cmp_eq_u32 s38, 2
  s_cbranch_scc1 gated_mix__linear_attn_block__mha_block__prompt_kernel_g10_last
  s_barrier
  v_add_u32 v12, 4294868992, v12
  v_add_u32 v13, 4294868992, v13
  v_add_u32 v14, 4294868992, v14
  v_add_u32 v15, 4294868992, v15
  v_add_u32 v16, 4294868992, v16
  v_add_u32 v17, 4294868992, v17
  v_add_u32 v18, 4294868992, v18
  v_add_u32 v19, 4294868992, v19
  s_add_u32 s38, s38, 1
  ds_read_b128 v[28:31], v16
  ds_read_b64_tr_b16 v[36:37], v12 offset:0
  ds_read_b64_tr_b16 v[38:39], v12 offset:2048
  ds_read_b64_tr_b16 v[40:41], v13 offset:0
  ds_read_b64_tr_b16 v[42:43], v13 offset:2048
  ds_read_b64_tr_b16 v[44:45], v14 offset:0
  ds_read_b64_tr_b16 v[46:47], v14 offset:2048
  ds_read_b64_tr_b16 v[48:49], v15 offset:0
  ds_read_b64_tr_b16 v[50:51], v15 offset:2048
  v_mfma_f32_32x32x16_bf16 v[68:83], v[32:35], v[52:55], v[68:83]
  v_mfma_f32_32x32x16_bf16 v[84:99], v[32:35], v[56:59], v[84:99]
  v_mfma_f32_32x32x16_bf16 v[100:115], v[32:35], v[60:63], v[100:115]
  v_mfma_f32_32x32x16_bf16 v[116:131], v[32:35], v[64:67], v[116:131]
  s_branch gated_mix__linear_attn_block__mha_block__prompt_kernel_g10_loop
gated_mix__linear_attn_block__mha_block__prompt_kernel_g10_last:
  s_barrier
  v_mfma_f32_32x32x16_bf16 v[68:83], v[32:35], v[52:55], v[68:83]
  v_mfma_f32_32x32x16_bf16 v[84:99], v[32:35], v[56:59], v[84:99]
  v_mfma_f32_32x32x16_bf16 v[100:115], v[32:35], v[60:63], v[100:115]
  v_mfma_f32_32x32x16_bf16 v[116:131], v[32:35], v[64:67], v[116:131]
  s_nop 15
  s_nop 3
  s_mov_b32 s78, 1069066811
  s_mov_b32 s79, 1069066811
  s_mov_b32 s76, 897988541
  s_mov_b32 s77, 897988541
  s_lshr_b32 s28, s22, 1
  s_mul_i32 s28, s28, 19456
  s_and_b32 s29, s22, 1
  s_mul_i32 s29, s29, 5120
  s_add_u32 s82, s28, s29
  s_add_u32 s82, s82, 2368512
  s_mul_i32 s83, s22, 5120
  s_add_u32 s83, s83, 12321792
  s_mul_i32 s32, s42, 12
  s_cmp_eq_u32 s42, 5
  s_cbranch_scc1 gated_mix__linear_attn_block__mha_block__prompt_kernel_e10_c5
  s_cmp_gt_u32 s42, 5
  s_cbranch_scc1 gated_mix__linear_attn_block__mha_block__prompt_kernel_e10_c6
  v_cvt_pk_bf16_f32 v68, v68, v69
  v_cvt_pk_bf16_f32 v69, v70, v71
  v_cvt_pk_bf16_f32 v70, v72, v73
  v_cvt_pk_bf16_f32 v71, v74, v75
  v_cvt_pk_bf16_f32 v76, v76, v77
  v_cvt_pk_bf16_f32 v77, v78, v79
  v_cvt_pk_bf16_f32 v78, v80, v81
  v_cvt_pk_bf16_f32 v79, v82, v83
  ds_write_b128 v140, v[68:71]
  ds_write_b128 v140, v[76:79] offset:640
  v_cvt_pk_bf16_f32 v84, v84, v85
  v_cvt_pk_bf16_f32 v85, v86, v87
  v_cvt_pk_bf16_f32 v86, v88, v89
  v_cvt_pk_bf16_f32 v87, v90, v91
  v_cvt_pk_bf16_f32 v92, v92, v93
  v_cvt_pk_bf16_f32 v93, v94, v95
  v_cvt_pk_bf16_f32 v94, v96, v97
  v_cvt_pk_bf16_f32 v95, v98, v99
  ds_write_b128 v141, v[84:87]
  ds_write_b128 v141, v[92:95] offset:640
  v_cvt_pk_bf16_f32 v100, v100, v101
  v_cvt_pk_bf16_f32 v101, v102, v103
  v_cvt_pk_bf16_f32 v102, v104, v105
  v_cvt_pk_bf16_f32 v103, v106, v107
  v_cvt_pk_bf16_f32 v108, v108, v109
  v_cvt_pk_bf16_f32 v109, v110, v111
  v_cvt_pk_bf16_f32 v110, v112, v113
  v_cvt_pk_bf16_f32 v111, v114, v115
  ds_write_b128 v142, v[100:103]
  ds_write_b128 v142, v[108:111] offset:640
  v_cvt_pk_bf16_f32 v116, v116, v117
  v_cvt_pk_bf16_f32 v117, v118, v119
  v_cvt_pk_bf16_f32 v118, v120, v121
  v_cvt_pk_bf16_f32 v119, v122, v123
  v_cvt_pk_bf16_f32 v124, v124, v125
  v_cvt_pk_bf16_f32 v125, v126, v127
  v_cvt_pk_bf16_f32 v126, v128, v129
  v_cvt_pk_bf16_f32 v127, v130, v131
  ds_write_b128 v143, v[116:119]
  ds_write_b128 v143, v[124:127] offset:640
  s_branch gated_mix__linear_attn_block__mha_block__prompt_kernel_e10_cd
gated_mix__linear_attn_block__mha_block__prompt_kernel_e10_c5:
  v_cmp_le_u32 vcc, 16, v21
  s_nop 1
  v_mov_b32 v136, v68
  v_mov_b32 v137, v69
  v_mov_b32 v138, v70
  v_mov_b32 v139, v71
  v_pk_mul_f32 v[132:133], v[136:137], s[78:79]
  v_pk_mul_f32 v[134:135], v[138:139], s[78:79]
  v_exp_f32_e64 v132, v132 clamp
  v_exp_f32_e64 v133, v133 clamp
  v_exp_f32_e64 v134, v134 clamp
  v_exp_f32_e64 v135, v135 clamp
  v_max_f32 v136, 0, v136
  v_max_f32 v137, 0, v137
  v_max_f32 v138, 0, v138
  v_max_f32 v139, 0, v139
  v_pk_add_f32 v[132:133], v[132:133], s[76:77]
  v_pk_add_f32 v[134:135], v[134:135], s[76:77]
  v_pk_add_f32 v[136:137], v[136:137], v[132:133]
  v_pk_add_f32 v[138:139], v[138:139], v[134:135]
  v_cndmask_b32 v68, v68, v136, vcc
  v_cndmask_b32 v69, v69, v137, vcc
  v_cndmask_b32 v70, v70, v138, vcc
  v_cndmask_b32 v71, v71, v139, vcc
  v_mov_b32 v136, v72
  v_mov_b32 v137, v73
  v_mov_b32 v138, v74
  v_mov_b32 v139, v75
  v_pk_mul_f32 v[132:133], v[136:137], s[78:79]
  v_pk_mul_f32 v[134:135], v[138:139], s[78:79]
  v_exp_f32_e64 v132, v132 clamp
  v_exp_f32_e64 v133, v133 clamp
  v_exp_f32_e64 v134, v134 clamp
  v_exp_f32_e64 v135, v135 clamp
  v_max_f32 v136, 0, v136
  v_max_f32 v137, 0, v137
  v_max_f32 v138, 0, v138
  v_max_f32 v139, 0, v139
  v_pk_add_f32 v[132:133], v[132:133], s[76:77]
  v_pk_add_f32 v[134:135], v[134:135], s[76:77]
  v_pk_add_f32 v[136:137], v[136:137], v[132:133]
  v_pk_add_f32 v[138:139], v[138:139], v[134:135]
  v_cndmask_b32 v72, v72, v136, vcc
  v_cndmask_b32 v73, v73, v137, vcc
  v_cndmask_b32 v74, v74, v138, vcc
  v_cndmask_b32 v75, v75, v139, vcc
  v_mov_b32 v136, v76
  v_mov_b32 v137, v77
  v_mov_b32 v138, v78
  v_mov_b32 v139, v79
  v_pk_mul_f32 v[132:133], v[136:137], s[78:79]
  v_pk_mul_f32 v[134:135], v[138:139], s[78:79]
  v_exp_f32_e64 v132, v132 clamp
  v_exp_f32_e64 v133, v133 clamp
  v_exp_f32_e64 v134, v134 clamp
  v_exp_f32_e64 v135, v135 clamp
  v_max_f32 v136, 0, v136
  v_max_f32 v137, 0, v137
  v_max_f32 v138, 0, v138
  v_max_f32 v139, 0, v139
  v_pk_add_f32 v[132:133], v[132:133], s[76:77]
  v_pk_add_f32 v[134:135], v[134:135], s[76:77]
  v_pk_add_f32 v[136:137], v[136:137], v[132:133]
  v_pk_add_f32 v[138:139], v[138:139], v[134:135]
  v_cndmask_b32 v76, v76, v136, vcc
  v_cndmask_b32 v77, v77, v137, vcc
  v_cndmask_b32 v78, v78, v138, vcc
  v_cndmask_b32 v79, v79, v139, vcc
  v_mov_b32 v136, v80
  v_mov_b32 v137, v81
  v_mov_b32 v138, v82
  v_mov_b32 v139, v83
  v_pk_mul_f32 v[132:133], v[136:137], s[78:79]
  v_pk_mul_f32 v[134:135], v[138:139], s[78:79]
  v_exp_f32_e64 v132, v132 clamp
  v_exp_f32_e64 v133, v133 clamp
  v_exp_f32_e64 v134, v134 clamp
  v_exp_f32_e64 v135, v135 clamp
  v_max_f32 v136, 0, v136
  v_max_f32 v137, 0, v137
  v_max_f32 v138, 0, v138
  v_max_f32 v139, 0, v139
  v_pk_add_f32 v[132:133], v[132:133], s[76:77]
  v_pk_add_f32 v[134:135], v[134:135], s[76:77]
  v_pk_add_f32 v[136:137], v[136:137], v[132:133]
  v_pk_add_f32 v[138:139], v[138:139], v[134:135]
  v_cndmask_b32 v80, v80, v136, vcc
  v_cndmask_b32 v81, v81, v137, vcc
  v_cndmask_b32 v82, v82, v138, vcc
  v_cndmask_b32 v83, v83, v139, vcc
  v_cvt_pk_bf16_f32 v68, v68, v69
  v_cvt_pk_bf16_f32 v69, v70, v71
  v_cvt_pk_bf16_f32 v70, v72, v73
  v_cvt_pk_bf16_f32 v71, v74, v75
  v_cvt_pk_bf16_f32 v76, v76, v77
  v_cvt_pk_bf16_f32 v77, v78, v79
  v_cvt_pk_bf16_f32 v78, v80, v81
  v_cvt_pk_bf16_f32 v79, v82, v83
  ds_write_b128 v140, v[68:71]
  ds_write_b128 v140, v[76:79] offset:640
  v_cvt_pk_bf16_f32 v84, v84, v85
  v_cvt_pk_bf16_f32 v85, v86, v87
  v_cvt_pk_bf16_f32 v86, v88, v89
  v_cvt_pk_bf16_f32 v87, v90, v91
  v_cvt_pk_bf16_f32 v92, v92, v93
  v_cvt_pk_bf16_f32 v93, v94, v95
  v_cvt_pk_bf16_f32 v94, v96, v97
  v_cvt_pk_bf16_f32 v95, v98, v99
  ds_write_b128 v141, v[84:87]
  ds_write_b128 v141, v[92:95] offset:640
  v_cmp_gt_u32 vcc, 16, v21
  s_nop 1
  v_mov_b32 v136, v100
  v_mov_b32 v137, v101
  v_mov_b32 v138, v102
  v_mov_b32 v139, v103
  v_pk_mul_f32 v[132:133], v[136:137], s[78:79]
  v_pk_mul_f32 v[134:135], v[138:139], s[78:79]
  v_exp_f32_e64 v132, v132 clamp
  v_exp_f32_e64 v133, v133 clamp
  v_exp_f32_e64 v134, v134 clamp
  v_exp_f32_e64 v135, v135 clamp
  v_max_f32 v136, 0, v136
  v_max_f32 v137, 0, v137
  v_max_f32 v138, 0, v138
  v_max_f32 v139, 0, v139
  v_pk_add_f32 v[132:133], v[132:133], s[76:77]
  v_pk_add_f32 v[134:135], v[134:135], s[76:77]
  v_pk_add_f32 v[136:137], v[136:137], v[132:133]
  v_pk_add_f32 v[138:139], v[138:139], v[134:135]
  v_cndmask_b32 v100, v100, v136, vcc
  v_cndmask_b32 v101, v101, v137, vcc
  v_cndmask_b32 v102, v102, v138, vcc
  v_cndmask_b32 v103, v103, v139, vcc
  v_mov_b32 v136, v104
  v_mov_b32 v137, v105
  v_mov_b32 v138, v106
  v_mov_b32 v139, v107
  v_pk_mul_f32 v[132:133], v[136:137], s[78:79]
  v_pk_mul_f32 v[134:135], v[138:139], s[78:79]
  v_exp_f32_e64 v132, v132 clamp
  v_exp_f32_e64 v133, v133 clamp
  v_exp_f32_e64 v134, v134 clamp
  v_exp_f32_e64 v135, v135 clamp
  v_max_f32 v136, 0, v136
  v_max_f32 v137, 0, v137
  v_max_f32 v138, 0, v138
  v_max_f32 v139, 0, v139
  v_pk_add_f32 v[132:133], v[132:133], s[76:77]
  v_pk_add_f32 v[134:135], v[134:135], s[76:77]
  v_pk_add_f32 v[136:137], v[136:137], v[132:133]
  v_pk_add_f32 v[138:139], v[138:139], v[134:135]
  v_cndmask_b32 v104, v104, v136, vcc
  v_cndmask_b32 v105, v105, v137, vcc
  v_cndmask_b32 v106, v106, v138, vcc
  v_cndmask_b32 v107, v107, v139, vcc
  v_mov_b32 v136, v108
  v_mov_b32 v137, v109
  v_mov_b32 v138, v110
  v_mov_b32 v139, v111
  v_pk_mul_f32 v[132:133], v[136:137], s[78:79]
  v_pk_mul_f32 v[134:135], v[138:139], s[78:79]
  v_exp_f32_e64 v132, v132 clamp
  v_exp_f32_e64 v133, v133 clamp
  v_exp_f32_e64 v134, v134 clamp
  v_exp_f32_e64 v135, v135 clamp
  v_max_f32 v136, 0, v136
  v_max_f32 v137, 0, v137
  v_max_f32 v138, 0, v138
  v_max_f32 v139, 0, v139
  v_pk_add_f32 v[132:133], v[132:133], s[76:77]
  v_pk_add_f32 v[134:135], v[134:135], s[76:77]
  v_pk_add_f32 v[136:137], v[136:137], v[132:133]
  v_pk_add_f32 v[138:139], v[138:139], v[134:135]
  v_cndmask_b32 v108, v108, v136, vcc
  v_cndmask_b32 v109, v109, v137, vcc
  v_cndmask_b32 v110, v110, v138, vcc
  v_cndmask_b32 v111, v111, v139, vcc
  v_mov_b32 v136, v112
  v_mov_b32 v137, v113
  v_mov_b32 v138, v114
  v_mov_b32 v139, v115
  v_pk_mul_f32 v[132:133], v[136:137], s[78:79]
  v_pk_mul_f32 v[134:135], v[138:139], s[78:79]
  v_exp_f32_e64 v132, v132 clamp
  v_exp_f32_e64 v133, v133 clamp
  v_exp_f32_e64 v134, v134 clamp
  v_exp_f32_e64 v135, v135 clamp
  v_max_f32 v136, 0, v136
  v_max_f32 v137, 0, v137
  v_max_f32 v138, 0, v138
  v_max_f32 v139, 0, v139
  v_pk_add_f32 v[132:133], v[132:133], s[76:77]
  v_pk_add_f32 v[134:135], v[134:135], s[76:77]
  v_pk_add_f32 v[136:137], v[136:137], v[132:133]
  v_pk_add_f32 v[138:139], v[138:139], v[134:135]
  v_cndmask_b32 v112, v112, v136, vcc
  v_cndmask_b32 v113, v113, v137, vcc
  v_cndmask_b32 v114, v114, v138, vcc
  v_cndmask_b32 v115, v115, v139, vcc
  v_cvt_pk_bf16_f32 v100, v100, v101
  v_cvt_pk_bf16_f32 v101, v102, v103
  v_cvt_pk_bf16_f32 v102, v104, v105
  v_cvt_pk_bf16_f32 v103, v106, v107
  v_cvt_pk_bf16_f32 v108, v108, v109
  v_cvt_pk_bf16_f32 v109, v110, v111
  v_cvt_pk_bf16_f32 v110, v112, v113
  v_cvt_pk_bf16_f32 v111, v114, v115
  ds_write_b128 v142, v[100:103]
  ds_write_b128 v142, v[108:111] offset:640
  v_pk_mul_f32 v[132:133], v[116:117], s[78:79]
  v_pk_mul_f32 v[134:135], v[118:119], s[78:79]
  v_pk_mul_f32 v[136:137], v[120:121], s[78:79]
  v_pk_mul_f32 v[138:139], v[122:123], s[78:79]
  v_exp_f32_e64 v132, v132 clamp
  v_exp_f32_e64 v133, v133 clamp
  v_exp_f32_e64 v134, v134 clamp
  v_exp_f32_e64 v135, v135 clamp
  v_exp_f32_e64 v136, v136 clamp
  v_exp_f32_e64 v137, v137 clamp
  v_exp_f32_e64 v138, v138 clamp
  v_exp_f32_e64 v139, v139 clamp
  v_max_f32 v116, 0, v116
  v_max_f32 v117, 0, v117
  v_max_f32 v118, 0, v118
  v_max_f32 v119, 0, v119
  v_max_f32 v120, 0, v120
  v_max_f32 v121, 0, v121
  v_max_f32 v122, 0, v122
  v_max_f32 v123, 0, v123
  v_pk_add_f32 v[132:133], v[132:133], s[76:77]
  v_pk_add_f32 v[134:135], v[134:135], s[76:77]
  v_pk_add_f32 v[136:137], v[136:137], s[76:77]
  v_pk_add_f32 v[138:139], v[138:139], s[76:77]
  v_pk_add_f32 v[116:117], v[116:117], v[132:133]
  v_pk_add_f32 v[118:119], v[118:119], v[134:135]
  v_pk_add_f32 v[120:121], v[120:121], v[136:137]
  v_pk_add_f32 v[122:123], v[122:123], v[138:139]
  v_pk_mul_f32 v[132:133], v[124:125], s[78:79]
  v_pk_mul_f32 v[134:135], v[126:127], s[78:79]
  v_pk_mul_f32 v[136:137], v[128:129], s[78:79]
  v_pk_mul_f32 v[138:139], v[130:131], s[78:79]
  v_exp_f32_e64 v132, v132 clamp
  v_exp_f32_e64 v133, v133 clamp
  v_exp_f32_e64 v134, v134 clamp
  v_exp_f32_e64 v135, v135 clamp
  v_exp_f32_e64 v136, v136 clamp
  v_exp_f32_e64 v137, v137 clamp
  v_exp_f32_e64 v138, v138 clamp
  v_exp_f32_e64 v139, v139 clamp
  v_max_f32 v124, 0, v124
  v_max_f32 v125, 0, v125
  v_max_f32 v126, 0, v126
  v_max_f32 v127, 0, v127
  v_max_f32 v128, 0, v128
  v_max_f32 v129, 0, v129
  v_max_f32 v130, 0, v130
  v_max_f32 v131, 0, v131
  v_pk_add_f32 v[132:133], v[132:133], s[76:77]
  v_pk_add_f32 v[134:135], v[134:135], s[76:77]
  v_pk_add_f32 v[136:137], v[136:137], s[76:77]
  v_pk_add_f32 v[138:139], v[138:139], s[76:77]
  v_pk_add_f32 v[124:125], v[124:125], v[132:133]
  v_pk_add_f32 v[126:127], v[126:127], v[134:135]
  v_pk_add_f32 v[128:129], v[128:129], v[136:137]
  v_pk_add_f32 v[130:131], v[130:131], v[138:139]
  v_cvt_pk_bf16_f32 v116, v116, v117
  v_cvt_pk_bf16_f32 v117, v118, v119
  v_cvt_pk_bf16_f32 v118, v120, v121
  v_cvt_pk_bf16_f32 v119, v122, v123
  v_cvt_pk_bf16_f32 v124, v124, v125
  v_cvt_pk_bf16_f32 v125, v126, v127
  v_cvt_pk_bf16_f32 v126, v128, v129
  v_cvt_pk_bf16_f32 v127, v130, v131
  ds_write_b128 v143, v[116:119]
  ds_write_b128 v143, v[124:127] offset:640
  s_branch gated_mix__linear_attn_block__mha_block__prompt_kernel_e10_cd
gated_mix__linear_attn_block__mha_block__prompt_kernel_e10_c6:
  v_pk_mul_f32 v[132:133], v[68:69], s[78:79]
  v_pk_mul_f32 v[134:135], v[70:71], s[78:79]
  v_pk_mul_f32 v[136:137], v[72:73], s[78:79]
  v_pk_mul_f32 v[138:139], v[74:75], s[78:79]
  v_exp_f32_e64 v132, v132 clamp
  v_exp_f32_e64 v133, v133 clamp
  v_exp_f32_e64 v134, v134 clamp
  v_exp_f32_e64 v135, v135 clamp
  v_exp_f32_e64 v136, v136 clamp
  v_exp_f32_e64 v137, v137 clamp
  v_exp_f32_e64 v138, v138 clamp
  v_exp_f32_e64 v139, v139 clamp
  v_max_f32 v68, 0, v68
  v_max_f32 v69, 0, v69
  v_max_f32 v70, 0, v70
  v_max_f32 v71, 0, v71
  v_max_f32 v72, 0, v72
  v_max_f32 v73, 0, v73
  v_max_f32 v74, 0, v74
  v_max_f32 v75, 0, v75
  v_pk_add_f32 v[132:133], v[132:133], s[76:77]
  v_pk_add_f32 v[134:135], v[134:135], s[76:77]
  v_pk_add_f32 v[136:137], v[136:137], s[76:77]
  v_pk_add_f32 v[138:139], v[138:139], s[76:77]
  v_pk_add_f32 v[68:69], v[68:69], v[132:133]
  v_pk_add_f32 v[70:71], v[70:71], v[134:135]
  v_pk_add_f32 v[72:73], v[72:73], v[136:137]
  v_pk_add_f32 v[74:75], v[74:75], v[138:139]
  v_pk_mul_f32 v[132:133], v[76:77], s[78:79]
  v_pk_mul_f32 v[134:135], v[78:79], s[78:79]
  v_pk_mul_f32 v[136:137], v[80:81], s[78:79]
  v_pk_mul_f32 v[138:139], v[82:83], s[78:79]
  v_exp_f32_e64 v132, v132 clamp
  v_exp_f32_e64 v133, v133 clamp
  v_exp_f32_e64 v134, v134 clamp
  v_exp_f32_e64 v135, v135 clamp
  v_exp_f32_e64 v136, v136 clamp
  v_exp_f32_e64 v137, v137 clamp
  v_exp_f32_e64 v138, v138 clamp
  v_exp_f32_e64 v139, v139 clamp
  v_max_f32 v76, 0, v76
  v_max_f32 v77, 0, v77
  v_max_f32 v78, 0, v78
  v_max_f32 v79, 0, v79
  v_max_f32 v80, 0, v80
  v_max_f32 v81, 0, v81
  v_max_f32 v82, 0, v82
  v_max_f32 v83, 0, v83
  v_pk_add_f32 v[132:133], v[132:133], s[76:77]
  v_pk_add_f32 v[134:135], v[134:135], s[76:77]
  v_pk_add_f32 v[136:137], v[136:137], s[76:77]
  v_pk_add_f32 v[138:139], v[138:139], s[76:77]
  v_pk_add_f32 v[76:77], v[76:77], v[132:133]
  v_pk_add_f32 v[78:79], v[78:79], v[134:135]
  v_pk_add_f32 v[80:81], v[80:81], v[136:137]
  v_pk_add_f32 v[82:83], v[82:83], v[138:139]
  v_cvt_pk_bf16_f32 v68, v68, v69
  v_cvt_pk_bf16_f32 v69, v70, v71
  v_cvt_pk_bf16_f32 v70, v72, v73
  v_cvt_pk_bf16_f32 v71, v74, v75
  v_cvt_pk_bf16_f32 v76, v76, v77
  v_cvt_pk_bf16_f32 v77, v78, v79
  v_cvt_pk_bf16_f32 v78, v80, v81
  v_cvt_pk_bf16_f32 v79, v82, v83
  ds_write_b128 v140, v[68:71]
  ds_write_b128 v140, v[76:79] offset:640
  v_pk_mul_f32 v[132:133], v[84:85], s[78:79]
  v_pk_mul_f32 v[134:135], v[86:87], s[78:79]
  v_pk_mul_f32 v[136:137], v[88:89], s[78:79]
  v_pk_mul_f32 v[138:139], v[90:91], s[78:79]
  v_exp_f32_e64 v132, v132 clamp
  v_exp_f32_e64 v133, v133 clamp
  v_exp_f32_e64 v134, v134 clamp
  v_exp_f32_e64 v135, v135 clamp
  v_exp_f32_e64 v136, v136 clamp
  v_exp_f32_e64 v137, v137 clamp
  v_exp_f32_e64 v138, v138 clamp
  v_exp_f32_e64 v139, v139 clamp
  v_max_f32 v84, 0, v84
  v_max_f32 v85, 0, v85
  v_max_f32 v86, 0, v86
  v_max_f32 v87, 0, v87
  v_max_f32 v88, 0, v88
  v_max_f32 v89, 0, v89
  v_max_f32 v90, 0, v90
  v_max_f32 v91, 0, v91
  v_pk_add_f32 v[132:133], v[132:133], s[76:77]
  v_pk_add_f32 v[134:135], v[134:135], s[76:77]
  v_pk_add_f32 v[136:137], v[136:137], s[76:77]
  v_pk_add_f32 v[138:139], v[138:139], s[76:77]
  v_pk_add_f32 v[84:85], v[84:85], v[132:133]
  v_pk_add_f32 v[86:87], v[86:87], v[134:135]
  v_pk_add_f32 v[88:89], v[88:89], v[136:137]
  v_pk_add_f32 v[90:91], v[90:91], v[138:139]
  v_pk_mul_f32 v[132:133], v[92:93], s[78:79]
  v_pk_mul_f32 v[134:135], v[94:95], s[78:79]
  v_pk_mul_f32 v[136:137], v[96:97], s[78:79]
  v_pk_mul_f32 v[138:139], v[98:99], s[78:79]
  v_exp_f32_e64 v132, v132 clamp
  v_exp_f32_e64 v133, v133 clamp
  v_exp_f32_e64 v134, v134 clamp
  v_exp_f32_e64 v135, v135 clamp
  v_exp_f32_e64 v136, v136 clamp
  v_exp_f32_e64 v137, v137 clamp
  v_exp_f32_e64 v138, v138 clamp
  v_exp_f32_e64 v139, v139 clamp
  v_max_f32 v92, 0, v92
  v_max_f32 v93, 0, v93
  v_max_f32 v94, 0, v94
  v_max_f32 v95, 0, v95
  v_max_f32 v96, 0, v96
  v_max_f32 v97, 0, v97
  v_max_f32 v98, 0, v98
  v_max_f32 v99, 0, v99
  v_pk_add_f32 v[132:133], v[132:133], s[76:77]
  v_pk_add_f32 v[134:135], v[134:135], s[76:77]
  v_pk_add_f32 v[136:137], v[136:137], s[76:77]
  v_pk_add_f32 v[138:139], v[138:139], s[76:77]
  v_pk_add_f32 v[92:93], v[92:93], v[132:133]
  v_pk_add_f32 v[94:95], v[94:95], v[134:135]
  v_pk_add_f32 v[96:97], v[96:97], v[136:137]
  v_pk_add_f32 v[98:99], v[98:99], v[138:139]
  v_cvt_pk_bf16_f32 v84, v84, v85
  v_cvt_pk_bf16_f32 v85, v86, v87
  v_cvt_pk_bf16_f32 v86, v88, v89
  v_cvt_pk_bf16_f32 v87, v90, v91
  v_cvt_pk_bf16_f32 v92, v92, v93
  v_cvt_pk_bf16_f32 v93, v94, v95
  v_cvt_pk_bf16_f32 v94, v96, v97
  v_cvt_pk_bf16_f32 v95, v98, v99
  ds_write_b128 v141, v[84:87]
  ds_write_b128 v141, v[92:95] offset:640
  v_pk_mul_f32 v[132:133], v[100:101], s[78:79]
  v_pk_mul_f32 v[134:135], v[102:103], s[78:79]
  v_pk_mul_f32 v[136:137], v[104:105], s[78:79]
  v_pk_mul_f32 v[138:139], v[106:107], s[78:79]
  v_exp_f32_e64 v132, v132 clamp
  v_exp_f32_e64 v133, v133 clamp
  v_exp_f32_e64 v134, v134 clamp
  v_exp_f32_e64 v135, v135 clamp
  v_exp_f32_e64 v136, v136 clamp
  v_exp_f32_e64 v137, v137 clamp
  v_exp_f32_e64 v138, v138 clamp
  v_exp_f32_e64 v139, v139 clamp
  v_max_f32 v100, 0, v100
  v_max_f32 v101, 0, v101
  v_max_f32 v102, 0, v102
  v_max_f32 v103, 0, v103
  v_max_f32 v104, 0, v104
  v_max_f32 v105, 0, v105
  v_max_f32 v106, 0, v106
  v_max_f32 v107, 0, v107
  v_pk_add_f32 v[132:133], v[132:133], s[76:77]
  v_pk_add_f32 v[134:135], v[134:135], s[76:77]
  v_pk_add_f32 v[136:137], v[136:137], s[76:77]
  v_pk_add_f32 v[138:139], v[138:139], s[76:77]
  v_pk_add_f32 v[100:101], v[100:101], v[132:133]
  v_pk_add_f32 v[102:103], v[102:103], v[134:135]
  v_pk_add_f32 v[104:105], v[104:105], v[136:137]
  v_pk_add_f32 v[106:107], v[106:107], v[138:139]
  v_pk_mul_f32 v[132:133], v[108:109], s[78:79]
  v_pk_mul_f32 v[134:135], v[110:111], s[78:79]
  v_pk_mul_f32 v[136:137], v[112:113], s[78:79]
  v_pk_mul_f32 v[138:139], v[114:115], s[78:79]
  v_exp_f32_e64 v132, v132 clamp
  v_exp_f32_e64 v133, v133 clamp
  v_exp_f32_e64 v134, v134 clamp
  v_exp_f32_e64 v135, v135 clamp
  v_exp_f32_e64 v136, v136 clamp
  v_exp_f32_e64 v137, v137 clamp
  v_exp_f32_e64 v138, v138 clamp
  v_exp_f32_e64 v139, v139 clamp
  v_max_f32 v108, 0, v108
  v_max_f32 v109, 0, v109
  v_max_f32 v110, 0, v110
  v_max_f32 v111, 0, v111
  v_max_f32 v112, 0, v112
  v_max_f32 v113, 0, v113
  v_max_f32 v114, 0, v114
  v_max_f32 v115, 0, v115
  v_pk_add_f32 v[132:133], v[132:133], s[76:77]
  v_pk_add_f32 v[134:135], v[134:135], s[76:77]
  v_pk_add_f32 v[136:137], v[136:137], s[76:77]
  v_pk_add_f32 v[138:139], v[138:139], s[76:77]
  v_pk_add_f32 v[108:109], v[108:109], v[132:133]
  v_pk_add_f32 v[110:111], v[110:111], v[134:135]
  v_pk_add_f32 v[112:113], v[112:113], v[136:137]
  v_pk_add_f32 v[114:115], v[114:115], v[138:139]
  v_cvt_pk_bf16_f32 v100, v100, v101
  v_cvt_pk_bf16_f32 v101, v102, v103
  v_cvt_pk_bf16_f32 v102, v104, v105
  v_cvt_pk_bf16_f32 v103, v106, v107
  v_cvt_pk_bf16_f32 v108, v108, v109
  v_cvt_pk_bf16_f32 v109, v110, v111
  v_cvt_pk_bf16_f32 v110, v112, v113
  v_cvt_pk_bf16_f32 v111, v114, v115
  ds_write_b128 v142, v[100:103]
  ds_write_b128 v142, v[108:111] offset:640
  v_pk_mul_f32 v[132:133], v[116:117], s[78:79]
  v_pk_mul_f32 v[134:135], v[118:119], s[78:79]
  v_pk_mul_f32 v[136:137], v[120:121], s[78:79]
  v_pk_mul_f32 v[138:139], v[122:123], s[78:79]
  v_exp_f32_e64 v132, v132 clamp
  v_exp_f32_e64 v133, v133 clamp
  v_exp_f32_e64 v134, v134 clamp
  v_exp_f32_e64 v135, v135 clamp
  v_exp_f32_e64 v136, v136 clamp
  v_exp_f32_e64 v137, v137 clamp
  v_exp_f32_e64 v138, v138 clamp
  v_exp_f32_e64 v139, v139 clamp
  v_max_f32 v116, 0, v116
  v_max_f32 v117, 0, v117
  v_max_f32 v118, 0, v118
  v_max_f32 v119, 0, v119
  v_max_f32 v120, 0, v120
  v_max_f32 v121, 0, v121
  v_max_f32 v122, 0, v122
  v_max_f32 v123, 0, v123
  v_pk_add_f32 v[132:133], v[132:133], s[76:77]
  v_pk_add_f32 v[134:135], v[134:135], s[76:77]
  v_pk_add_f32 v[136:137], v[136:137], s[76:77]
  v_pk_add_f32 v[138:139], v[138:139], s[76:77]
  v_pk_add_f32 v[116:117], v[116:117], v[132:133]
  v_pk_add_f32 v[118:119], v[118:119], v[134:135]
  v_pk_add_f32 v[120:121], v[120:121], v[136:137]
  v_pk_add_f32 v[122:123], v[122:123], v[138:139]
  v_pk_mul_f32 v[132:133], v[124:125], s[78:79]
  v_pk_mul_f32 v[134:135], v[126:127], s[78:79]
  v_pk_mul_f32 v[136:137], v[128:129], s[78:79]
  v_pk_mul_f32 v[138:139], v[130:131], s[78:79]
  v_exp_f32_e64 v132, v132 clamp
  v_exp_f32_e64 v133, v133 clamp
  v_exp_f32_e64 v134, v134 clamp
  v_exp_f32_e64 v135, v135 clamp
  v_exp_f32_e64 v136, v136 clamp
  v_exp_f32_e64 v137, v137 clamp
  v_exp_f32_e64 v138, v138 clamp
  v_exp_f32_e64 v139, v139 clamp
  v_max_f32 v124, 0, v124
  v_max_f32 v125, 0, v125
  v_max_f32 v126, 0, v126
  v_max_f32 v127, 0, v127
  v_max_f32 v128, 0, v128
  v_max_f32 v129, 0, v129
  v_max_f32 v130, 0, v130
  v_max_f32 v131, 0, v131
  v_pk_add_f32 v[132:133], v[132:133], s[76:77]
  v_pk_add_f32 v[134:135], v[134:135], s[76:77]
  v_pk_add_f32 v[136:137], v[136:137], s[76:77]
  v_pk_add_f32 v[138:139], v[138:139], s[76:77]
  v_pk_add_f32 v[124:125], v[124:125], v[132:133]
  v_pk_add_f32 v[126:127], v[126:127], v[134:135]
  v_pk_add_f32 v[128:129], v[128:129], v[136:137]
  v_pk_add_f32 v[130:131], v[130:131], v[138:139]
  v_cvt_pk_bf16_f32 v116, v116, v117
  v_cvt_pk_bf16_f32 v117, v118, v119
  v_cvt_pk_bf16_f32 v118, v120, v121
  v_cvt_pk_bf16_f32 v119, v122, v123
  v_cvt_pk_bf16_f32 v124, v124, v125
  v_cvt_pk_bf16_f32 v125, v126, v127
  v_cvt_pk_bf16_f32 v126, v128, v129
  v_cvt_pk_bf16_f32 v127, v130, v131
  ds_write_b128 v143, v[116:119]
  ds_write_b128 v143, v[124:127] offset:640
gated_mix__linear_attn_block__mha_block__prompt_kernel_e10_cd:
  s_waitcnt lgkmcnt(0)
  s_barrier
  s_add_u32 s28, s24, 0
  s_lshl_b32 s29, s28, 10
  v_add_u32 v2, s29, v20
  ds_read_b128 v[68:71], v2
  s_add_u32 s28, s24, 8
  s_lshl_b32 s29, s28, 10
  v_add_u32 v2, s29, v20
  ds_read_b128 v[72:75], v2
  s_add_u32 s28, s24, 16
  s_lshl_b32 s29, s28, 10
  v_add_u32 v2, s29, v20
  ds_read_b128 v[76:79], v2
  s_add_u32 s28, s24, 24
  s_lshl_b32 s29, s28, 10
  v_add_u32 v2, s29, v20
  ds_read_b128 v[80:83], v2
  s_add_u32 s28, s24, 32
  s_lshl_b32 s29, s28, 10
  v_add_u32 v2, s29, v20
  ds_read_b128 v[84:87], v2
  s_add_u32 s28, s24, 40
  s_lshl_b32 s29, s28, 10
  v_add_u32 v2, s29, v20
  ds_read_b128 v[88:91], v2
  s_add_u32 s28, s24, 48
  s_lshl_b32 s29, s28, 10
  v_add_u32 v2, s29, v20
  ds_read_b128 v[92:95], v2
  s_cmp_ge_u32 s24, 4
  s_cbranch_scc1 gated_mix__linear_attn_block__mha_block__prompt_kernel_e10_c_41
  s_add_u32 s28, s24, 56
  s_lshl_b32 s29, s28, 10
  v_add_u32 v2, s29, v20
  ds_read_b128 v[96:99], v2
gated_mix__linear_attn_block__mha_block__prompt_kernel_e10_c_41:
  s_add_u32 s28, s24, 0
  s_mul_i32 s29, s28, 13108
  s_lshr_b32 s29, s29, 16
  s_mul_i32 s30, s29, 5
  s_sub_u32 s30, s28, s30
  s_add_u32 s29, s29, s32
  s_lshr_b32 s49, s29, 5
  s_and_b32 s64, s29, 31
  s_mul_i32 s65, s64, 81920
  s_add_u32 s65, s65, s83
  s_cmp_eq_u32 s49, 2
  s_cselect_b32 s31, 4292344832, 0
  s_add_u32 s65, s65, s31
  s_mul_i32 s31, s64, 155648
  s_add_u32 s31, s31, s82
  s_cmp_eq_u32 s49, 0
  s_cselect_b32 s65, s31, s65
  s_lshl_b32 s30, s30, 10
  s_add_u32 s65, s65, s30
  s_waitcnt lgkmcnt(6)
  buffer_store_dwordx4 v[68:71], v20, s[12:15], s65 offen sc1
  s_add_u32 s28, s24, 8
  s_mul_i32 s29, s28, 13108
  s_lshr_b32 s29, s29, 16
  s_mul_i32 s30, s29, 5
  s_sub_u32 s30, s28, s30
  s_add_u32 s29, s29, s32
  s_lshr_b32 s49, s29, 5
  s_and_b32 s64, s29, 31
  s_mul_i32 s65, s64, 81920
  s_add_u32 s65, s65, s83
  s_cmp_eq_u32 s49, 2
  s_cselect_b32 s31, 4292344832, 0
  s_add_u32 s65, s65, s31
  s_mul_i32 s31, s64, 155648
  s_add_u32 s31, s31, s82
  s_cmp_eq_u32 s49, 0
  s_cselect_b32 s65, s31, s65
  s_lshl_b32 s30, s30, 10
  s_add_u32 s65, s65, s30
  s_waitcnt lgkmcnt(5)
  buffer_store_dwordx4 v[72:75], v20, s[12:15], s65 offen sc1
  s_add_u32 s28, s24, 16
  s_mul_i32 s29, s28, 13108
  s_lshr_b32 s29, s29, 16
  s_mul_i32 s30, s29, 5
  s_sub_u32 s30, s28, s30
  s_add_u32 s29, s29, s32
  s_lshr_b32 s49, s29, 5
  s_and_b32 s64, s29, 31
  s_mul_i32 s65, s64, 81920
  s_add_u32 s65, s65, s83
  s_cmp_eq_u32 s49, 2
  s_cselect_b32 s31, 4292344832, 0
  s_add_u32 s65, s65, s31
  s_mul_i32 s31, s64, 155648
  s_add_u32 s31, s31, s82
  s_cmp_eq_u32 s49, 0
  s_cselect_b32 s65, s31, s65
  s_lshl_b32 s30, s30, 10
  s_add_u32 s65, s65, s30
  s_waitcnt lgkmcnt(4)
  buffer_store_dwordx4 v[76:79], v20, s[12:15], s65 offen sc1
  s_add_u32 s28, s24, 24
  s_mul_i32 s29, s28, 13108
  s_lshr_b32 s29, s29, 16
  s_mul_i32 s30, s29, 5
  s_sub_u32 s30, s28, s30
  s_add_u32 s29, s29, s32
  s_lshr_b32 s49, s29, 5
  s_and_b32 s64, s29, 31
  s_mul_i32 s65, s64, 81920
  s_add_u32 s65, s65, s83
  s_cmp_eq_u32 s49, 2
  s_cselect_b32 s31, 4292344832, 0
  s_add_u32 s65, s65, s31
  s_mul_i32 s31, s64, 155648
  s_add_u32 s31, s31, s82
  s_cmp_eq_u32 s49, 0
  s_cselect_b32 s65, s31, s65
  s_lshl_b32 s30, s30, 10
  s_add_u32 s65, s65, s30
  s_waitcnt lgkmcnt(3)
  buffer_store_dwordx4 v[80:83], v20, s[12:15], s65 offen sc1
  s_add_u32 s28, s24, 32
  s_mul_i32 s29, s28, 13108
  s_lshr_b32 s29, s29, 16
  s_mul_i32 s30, s29, 5
  s_sub_u32 s30, s28, s30
  s_add_u32 s29, s29, s32
  s_lshr_b32 s49, s29, 5
  s_and_b32 s64, s29, 31
  s_mul_i32 s65, s64, 81920
  s_add_u32 s65, s65, s83
  s_cmp_eq_u32 s49, 2
  s_cselect_b32 s31, 4292344832, 0
  s_add_u32 s65, s65, s31
  s_mul_i32 s31, s64, 155648
  s_add_u32 s31, s31, s82
  s_cmp_eq_u32 s49, 0
  s_cselect_b32 s65, s31, s65
  s_lshl_b32 s30, s30, 10
  s_add_u32 s65, s65, s30
  s_waitcnt lgkmcnt(2)
  buffer_store_dwordx4 v[84:87], v20, s[12:15], s65 offen sc1
  s_add_u32 s28, s24, 40
  s_mul_i32 s29, s28, 13108
  s_lshr_b32 s29, s29, 16
  s_mul_i32 s30, s29, 5
  s_sub_u32 s30, s28, s30
  s_add_u32 s29, s29, s32
  s_lshr_b32 s49, s29, 5
  s_and_b32 s64, s29, 31
  s_mul_i32 s65, s64, 81920
  s_add_u32 s65, s65, s83
  s_cmp_eq_u32 s49, 2
  s_cselect_b32 s31, 4292344832, 0
  s_add_u32 s65, s65, s31
  s_mul_i32 s31, s64, 155648
  s_add_u32 s31, s31, s82
  s_cmp_eq_u32 s49, 0
  s_cselect_b32 s65, s31, s65
  s_lshl_b32 s30, s30, 10
  s_add_u32 s65, s65, s30
  s_waitcnt lgkmcnt(1)
  buffer_store_dwordx4 v[88:91], v20, s[12:15], s65 offen sc1
  s_add_u32 s28, s24, 48
  s_mul_i32 s29, s28, 13108
  s_lshr_b32 s29, s29, 16
  s_mul_i32 s30, s29, 5
  s_sub_u32 s30, s28, s30
  s_add_u32 s29, s29, s32
  s_lshr_b32 s49, s29, 5
  s_and_b32 s64, s29, 31
  s_mul_i32 s65, s64, 81920
  s_add_u32 s65, s65, s83
  s_cmp_eq_u32 s49, 2
  s_cselect_b32 s31, 4292344832, 0
  s_add_u32 s65, s65, s31
  s_mul_i32 s31, s64, 155648
  s_add_u32 s31, s31, s82
  s_cmp_eq_u32 s49, 0
  s_cselect_b32 s65, s31, s65
  s_lshl_b32 s30, s30, 10
  s_add_u32 s65, s65, s30
  s_waitcnt lgkmcnt(0)
  buffer_store_dwordx4 v[92:95], v20, s[12:15], s65 offen sc1
  s_cmp_ge_u32 s24, 4
  s_cbranch_scc1 gated_mix__linear_attn_block__mha_block__prompt_kernel_e10_d_49
  s_add_u32 s28, s24, 56
  s_mul_i32 s29, s28, 13108
  s_lshr_b32 s29, s29, 16
  s_mul_i32 s30, s29, 5
  s_sub_u32 s30, s28, s30
  s_add_u32 s29, s29, s32
  s_lshr_b32 s49, s29, 5
  s_and_b32 s64, s29, 31
  s_mul_i32 s65, s64, 81920
  s_add_u32 s65, s65, s83
  s_cmp_eq_u32 s49, 2
  s_cselect_b32 s31, 4292344832, 0
  s_add_u32 s65, s65, s31
  s_mul_i32 s31, s64, 155648
  s_add_u32 s31, s31, s82
  s_cmp_eq_u32 s49, 0
  s_cselect_b32 s65, s31, s65
  s_lshl_b32 s30, s30, 10
  s_add_u32 s65, s65, s30
  s_waitcnt lgkmcnt(0)
  buffer_store_dwordx4 v[96:99], v20, s[12:15], s65 offen sc1
gated_mix__linear_attn_block__mha_block__prompt_kernel_e10_d_49:
  s_branch gated_mix__linear_attn_block__mha_block__prompt_kernel_c2
gated_mix__linear_attn_block__mha_block__prompt_kernel_v11:
  v_mul_u32_u24 v7, 320, v22
  s_mul_i32 s28, s25, 1280
  v_add_u32 v7, s28, v7
  v_and_b32 v3, 15, v21
  v_lshlrev_b32 v3, 4, v3
  v_add_u32 v3, v3, v7
  v_cmp_gt_u32 vcc, 16, v21
  v_mov_b32 v2, 35840
  v_mov_b32 v140, 40960
  v_cndmask_b32 v2, v2, v140, vcc
  v_add_u32 v140, v2, v3
  v_mov_b32 v2, 46080
  v_mov_b32 v141, 51200
  v_cndmask_b32 v2, v2, v141, vcc
  v_add_u32 v141, v2, v3
  v_lshrrev_b32 v2, 2, v21
  v_lshlrev_b32 v2, 1, v2
  v_bfe_u32 v3, v21, 1, 1
  v_add_u32 v2, v2, v3
  v_mul_u32_u24 v2, 5120, v2
  v_and_b32 v3, 1, v21
  v_lshlrev_b32 v3, 4, v3
  v_add_u32 v2, v2, v3
  v_add_u32 v2, 256, v2
  v_add_u32 v2, v2, v7
  v_cmp_gt_u32 vcc, 24, v21
  v_mov_b32 v3, 0x10000000
  v_mul_u32_u24 v144, 5120, v21
  v_cndmask_b32 v142, v3, v2, vcc
  v_add_u32 v144, 288, v144
  v_add_u32 v144, v144, v7
  v_cmp_gt_u32 vcc, 12, v21
  s_nop 1
  v_cndmask_b32 v144, v3, v144, vcc
  s_barrier
  ds_read_b128 v[28:31], v16
  ds_read_b64_tr_b16 v[36:37], v12 offset:0
  ds_read_b64_tr_b16 v[38:39], v12 offset:2048
  ds_read_b64_tr_b16 v[40:41], v13 offset:0
  ds_read_b64_tr_b16 v[42:43], v13 offset:2048
  ds_read_b64_tr_b16 v[44:45], v14 offset:0
  ds_read_b64_tr_b16 v[46:47], v14 offset:2048
  s_mov_b32 s38, 0
gated_mix__linear_attn_block__mha_block__prompt_kernel_g11_loop:
  ds_read_b128 v[32:35], v17
  ds_read_b64_tr_b16 v[52:53], v12 offset:8192
  ds_read_b64_tr_b16 v[54:55], v12 offset:10240
  ds_read_b64_tr_b16 v[56:57], v13 offset:8192
  ds_read_b64_tr_b16 v[58:59], v13 offset:10240
  ds_read_b64_tr_b16 v[60:61], v14 offset:8192
  ds_read_b64_tr_b16 v[62:63], v14 offset:10240
  s_waitcnt lgkmcnt(7)
  v_mfma_f32_32x32x16_bf16 v[68:83], v[28:31], v[36:39], v[68:83]
  v_mfma_f32_32x32x16_bf16 v[84:99], v[28:31], v[40:43], v[84:99]
  v_mfma_f32_32x32x16_bf16 v[100:115], v[28:31], v[44:47], v[100:115]
  ds_read_b128 v[28:31], v18
  ds_read_b64_tr_b16 v[36:37], v12 offset:16384
  ds_read_b64_tr_b16 v[38:39], v12 offset:18432
  ds_read_b64_tr_b16 v[40:41], v13 offset:16384
  ds_read_b64_tr_b16 v[42:43], v13 offset:18432
  ds_read_b64_tr_b16 v[44:45], v14 offset:16384
  ds_read_b64_tr_b16 v[46:47], v14 offset:18432
  s_waitcnt lgkmcnt(7)
  v_mfma_f32_32x32x16_bf16 v[68:83], v[32:35], v[52:55], v[68:83]
  v_mfma_f32_32x32x16_bf16 v[84:99], v[32:35], v[56:59], v[84:99]
  v_mfma_f32_32x32x16_bf16 v[100:115], v[32:35], v[60:63], v[100:115]
  ds_read_b128 v[32:35], v19
  ds_read_b64_tr_b16 v[52:53], v12 offset:24576
  ds_read_b64_tr_b16 v[54:55], v12 offset:26624
  ds_read_b64_tr_b16 v[56:57], v13 offset:24576
  ds_read_b64_tr_b16 v[58:59], v13 offset:26624
  ds_read_b64_tr_b16 v[60:61], v14 offset:24576
  ds_read_b64_tr_b16 v[62:63], v14 offset:26624
  s_waitcnt lgkmcnt(7)
  v_mfma_f32_32x32x16_bf16 v[68:83], v[28:31], v[36:39], v[68:83]
  v_mfma_f32_32x32x16_bf16 v[84:99], v[28:31], v[40:43], v[84:99]
  v_mfma_f32_32x32x16_bf16 v[100:115], v[28:31], v[44:47], v[100:115]
  s_waitcnt lgkmcnt(0)
  s_barrier
  v_add_u32 v12, 49152, v12
  v_add_u32 v13, 49152, v13
  v_add_u32 v14, 49152, v14
  v_add_u32 v16, 49152, v16
  v_add_u32 v17, 49152, v17
  v_add_u32 v18, 49152, v18
  v_add_u32 v19, 49152, v19
  ds_read_b128 v[28:31], v16
  ds_read_b64_tr_b16 v[36:37], v12 offset:0
  ds_read_b64_tr_b16 v[38:39], v12 offset:2048
  ds_read_b64_tr_b16 v[40:41], v13 offset:0
  ds_read_b64_tr_b16 v[42:43], v13 offset:2048
  ds_read_b64_tr_b16 v[44:45], v14 offset:0
  ds_read_b64_tr_b16 v[46:47], v14 offset:2048
  v_mfma_f32_32x32x16_bf16 v[68:83], v[32:35], v[52:55], v[68:83]
  v_mfma_f32_32x32x16_bf16 v[84:99], v[32:35], v[56:59], v[84:99]
  v_mfma_f32_32x32x16_bf16 v[100:115], v[32:35], v[60:63], v[100:115]
  ds_read_b128 v[32:35], v17
  ds_read_b64_tr_b16 v[52:53], v12 offset:8192
  ds_read_b64_tr_b16 v[54:55], v12 offset:10240
  ds_read_b64_tr_b16 v[56:57], v13 offset:8192
  ds_read_b64_tr_b16 v[58:59], v13 offset:10240
  ds_read_b64_tr_b16 v[60:61], v14 offset:8192
  ds_read_b64_tr_b16 v[62:63], v14 offset:10240
  s_waitcnt lgkmcnt(7)
  v_mfma_f32_32x32x16_bf16 v[68:83], v[28:31], v[36:39], v[68:83]
  v_mfma_f32_32x32x16_bf16 v[84:99], v[28:31], v[40:43], v[84:99]
  v_mfma_f32_32x32x16_bf16 v[100:115], v[28:31], v[44:47], v[100:115]
  ds_read_b128 v[28:31], v18
  ds_read_b64_tr_b16 v[36:37], v12 offset:16384
  ds_read_b64_tr_b16 v[38:39], v12 offset:18432
  ds_read_b64_tr_b16 v[40:41], v13 offset:16384
  ds_read_b64_tr_b16 v[42:43], v13 offset:18432
  ds_read_b64_tr_b16 v[44:45], v14 offset:16384
  ds_read_b64_tr_b16 v[46:47], v14 offset:18432
  s_waitcnt lgkmcnt(7)
  v_mfma_f32_32x32x16_bf16 v[68:83], v[32:35], v[52:55], v[68:83]
  v_mfma_f32_32x32x16_bf16 v[84:99], v[32:35], v[56:59], v[84:99]
  v_mfma_f32_32x32x16_bf16 v[100:115], v[32:35], v[60:63], v[100:115]
  ds_read_b128 v[32:35], v19
  ds_read_b64_tr_b16 v[52:53], v12 offset:24576
  ds_read_b64_tr_b16 v[54:55], v12 offset:26624
  ds_read_b64_tr_b16 v[56:57], v13 offset:24576
  ds_read_b64_tr_b16 v[58:59], v13 offset:26624
  ds_read_b64_tr_b16 v[60:61], v14 offset:24576
  ds_read_b64_tr_b16 v[62:63], v14 offset:26624
  s_waitcnt lgkmcnt(7)
  v_mfma_f32_32x32x16_bf16 v[68:83], v[28:31], v[36:39], v[68:83]
  v_mfma_f32_32x32x16_bf16 v[84:99], v[28:31], v[40:43], v[84:99]
  v_mfma_f32_32x32x16_bf16 v[100:115], v[28:31], v[44:47], v[100:115]
  s_waitcnt lgkmcnt(0)
  s_barrier
  v_add_u32 v12, 49152, v12
  v_add_u32 v13, 49152, v13
  v_add_u32 v14, 49152, v14
  v_add_u32 v16, 49152, v16
  v_add_u32 v17, 49152, v17
  v_add_u32 v18, 49152, v18
  v_add_u32 v19, 49152, v19
  ds_read_b128 v[28:31], v16
  ds_read_b64_tr_b16 v[36:37], v12 offset:0
  ds_read_b64_tr_b16 v[38:39], v12 offset:2048
  ds_read_b64_tr_b16 v[40:41], v13 offset:0
  ds_read_b64_tr_b16 v[42:43], v13 offset:2048
  ds_read_b64_tr_b16 v[44:45], v14 offset:0
  ds_read_b64_tr_b16 v[46:47], v14 offset:2048
  v_mfma_f32_32x32x16_bf16 v[68:83], v[32:35], v[52:55], v[68:83]
  v_mfma_f32_32x32x16_bf16 v[84:99], v[32:35], v[56:59], v[84:99]
  v_mfma_f32_32x32x16_bf16 v[100:115], v[32:35], v[60:63], v[100:115]
  ds_read_b128 v[32:35], v17
  ds_read_b64_tr_b16 v[52:53], v12 offset:8192
  ds_read_b64_tr_b16 v[54:55], v12 offset:10240
  ds_read_b64_tr_b16 v[56:57], v13 offset:8192
  ds_read_b64_tr_b16 v[58:59], v13 offset:10240
  ds_read_b64_tr_b16 v[60:61], v14 offset:8192
  ds_read_b64_tr_b16 v[62:63], v14 offset:10240
  s_waitcnt lgkmcnt(7)
  v_mfma_f32_32x32x16_bf16 v[68:83], v[28:31], v[36:39], v[68:83]
  v_mfma_f32_32x32x16_bf16 v[84:99], v[28:31], v[40:43], v[84:99]
  v_mfma_f32_32x32x16_bf16 v[100:115], v[28:31], v[44:47], v[100:115]
  ds_read_b128 v[28:31], v18
  ds_read_b64_tr_b16 v[36:37], v12 offset:16384
  ds_read_b64_tr_b16 v[38:39], v12 offset:18432
  ds_read_b64_tr_b16 v[40:41], v13 offset:16384
  ds_read_b64_tr_b16 v[42:43], v13 offset:18432
  ds_read_b64_tr_b16 v[44:45], v14 offset:16384
  ds_read_b64_tr_b16 v[46:47], v14 offset:18432
  s_waitcnt lgkmcnt(7)
  v_mfma_f32_32x32x16_bf16 v[68:83], v[32:35], v[52:55], v[68:83]
  v_mfma_f32_32x32x16_bf16 v[84:99], v[32:35], v[56:59], v[84:99]
  v_mfma_f32_32x32x16_bf16 v[100:115], v[32:35], v[60:63], v[100:115]
  ds_read_b128 v[32:35], v19
  ds_read_b64_tr_b16 v[52:53], v12 offset:24576
  ds_read_b64_tr_b16 v[54:55], v12 offset:26624
  ds_read_b64_tr_b16 v[56:57], v13 offset:24576
  ds_read_b64_tr_b16 v[58:59], v13 offset:26624
  ds_read_b64_tr_b16 v[60:61], v14 offset:24576
  ds_read_b64_tr_b16 v[62:63], v14 offset:26624
  s_waitcnt lgkmcnt(7)
  v_mfma_f32_32x32x16_bf16 v[68:83], v[28:31], v[36:39], v[68:83]
  v_mfma_f32_32x32x16_bf16 v[84:99], v[28:31], v[40:43], v[84:99]
  v_mfma_f32_32x32x16_bf16 v[100:115], v[28:31], v[44:47], v[100:115]
  s_waitcnt lgkmcnt(0)
  s_cmp_eq_u32 s38, 2
  s_cbranch_scc1 gated_mix__linear_attn_block__mha_block__prompt_kernel_g11_last
  s_barrier
  v_add_u32 v12, 4294868992, v12
  v_add_u32 v13, 4294868992, v13
  v_add_u32 v14, 4294868992, v14
  v_add_u32 v16, 4294868992, v16
  v_add_u32 v17, 4294868992, v17
  v_add_u32 v18, 4294868992, v18
  v_add_u32 v19, 4294868992, v19
  s_add_u32 s38, s38, 1
  ds_read_b128 v[28:31], v16
  ds_read_b64_tr_b16 v[36:37], v12 offset:0
  ds_read_b64_tr_b16 v[38:39], v12 offset:2048
  ds_read_b64_tr_b16 v[40:41], v13 offset:0
  ds_read_b64_tr_b16 v[42:43], v13 offset:2048
  ds_read_b64_tr_b16 v[44:45], v14 offset:0
  ds_read_b64_tr_b16 v[46:47], v14 offset:2048
  v_mfma_f32_32x32x16_bf16 v[68:83], v[32:35], v[52:55], v[68:83]
  v_mfma_f32_32x32x16_bf16 v[84:99], v[32:35], v[56:59], v[84:99]
  v_mfma_f32_32x32x16_bf16 v[100:115], v[32:35], v[60:63], v[100:115]
  s_branch gated_mix__linear_attn_block__mha_block__prompt_kernel_g11_loop
gated_mix__linear_attn_block__mha_block__prompt_kernel_g11_last:
  s_barrier
  v_mfma_f32_32x32x16_bf16 v[68:83], v[32:35], v[52:55], v[68:83]
  v_mfma_f32_32x32x16_bf16 v[84:99], v[32:35], v[56:59], v[84:99]
  v_mfma_f32_32x32x16_bf16 v[100:115], v[32:35], v[60:63], v[100:115]
  s_nop 15
  s_nop 3
  s_mov_b32 s78, 1069066811
  s_mov_b32 s79, 1069066811
  s_mov_b32 s76, 897988541
  s_mov_b32 s77, 897988541
  s_lshr_b32 s28, s22, 1
  s_mul_i32 s28, s28, 19456
  s_and_b32 s29, s22, 1
  s_mul_i32 s29, s29, 5120
  s_add_u32 s82, s28, s29
  s_add_u32 s82, s82, 2368512
  s_mul_i32 s83, s22, 5120
  s_add_u32 s83, s83, 12321792
  s_mul_i32 s32, s42, 12
  s_cmp_eq_u32 s42, 5
  s_cbranch_scc1 gated_mix__linear_attn_block__mha_block__prompt_kernel_e11_c5
  s_cmp_gt_u32 s42, 5
  s_cbranch_scc1 gated_mix__linear_attn_block__mha_block__prompt_kernel_e11_c6
  v_cvt_pk_bf16_f32 v68, v68, v69
  v_cvt_pk_bf16_f32 v69, v70, v71
  v_cvt_pk_bf16_f32 v70, v72, v73
  v_cvt_pk_bf16_f32 v71, v74, v75
  v_cvt_pk_bf16_f32 v76, v76, v77
  v_cvt_pk_bf16_f32 v77, v78, v79
  v_cvt_pk_bf16_f32 v78, v80, v81
  v_cvt_pk_bf16_f32 v79, v82, v83
  ds_write_b128 v140, v[68:71]
  ds_write_b128 v140, v[76:79] offset:640
  v_cvt_pk_bf16_f32 v84, v84, v85
  v_cvt_pk_bf16_f32 v85, v86, v87
  v_cvt_pk_bf16_f32 v86, v88, v89
  v_cvt_pk_bf16_f32 v87, v90, v91
  v_cvt_pk_bf16_f32 v92, v92, v93
  v_cvt_pk_bf16_f32 v93, v94, v95
  v_cvt_pk_bf16_f32 v94, v96, v97
  v_cvt_pk_bf16_f32 v95, v98, v99
  ds_write_b128 v141, v[84:87]
  ds_write_b128 v141, v[92:95] offset:640
  v_cvt_pk_bf16_f32 v100, v100, v101
  v_cvt_pk_bf16_f32 v101, v102, v103
  v_cvt_pk_bf16_f32 v102, v104, v105
  v_cvt_pk_bf16_f32 v103, v106, v107
  v_cvt_pk_bf16_f32 v108, v108, v109
  v_cvt_pk_bf16_f32 v109, v110, v111
  v_cvt_pk_bf16_f32 v110, v112, v113
  v_cvt_pk_bf16_f32 v111, v114, v115
  ds_write_b128 v142, v[100:103]
  ds_write_b128 v142, v[108:111] offset:640
  v_mov_b32 v132, 0x3f803f80
  v_mov_b32 v133, 0x3f803f80
  v_mov_b32 v134, 0x3f803f80
  v_mov_b32 v135, 0x3f803f80
  ds_write_b128 v144, v[132:135]
  ds_write_b128 v144, v[132:135] offset:640
  s_branch gated_mix__linear_attn_block__mha_block__prompt_kernel_e11_cd
gated_mix__linear_attn_block__mha_block__prompt_kernel_e11_c5:
  v_pk_mul_f32 v[132:133], v[68:69], s[78:79]
  v_pk_mul_f32 v[134:135], v[70:71], s[78:79]
  v_pk_mul_f32 v[136:137], v[72:73], s[78:79]
  v_pk_mul_f32 v[138:139], v[74:75], s[78:79]
  v_exp_f32_e64 v132, v132 clamp
  v_exp_f32_e64 v133, v133 clamp
  v_exp_f32_e64 v134, v134 clamp
  v_exp_f32_e64 v135, v135 clamp
  v_exp_f32_e64 v136, v136 clamp
  v_exp_f32_e64 v137, v137 clamp
  v_exp_f32_e64 v138, v138 clamp
  v_exp_f32_e64 v139, v139 clamp
  v_max_f32 v68, 0, v68
  v_max_f32 v69, 0, v69
  v_max_f32 v70, 0, v70
  v_max_f32 v71, 0, v71
  v_max_f32 v72, 0, v72
  v_max_f32 v73, 0, v73
  v_max_f32 v74, 0, v74
  v_max_f32 v75, 0, v75
  v_pk_add_f32 v[132:133], v[132:133], s[76:77]
  v_pk_add_f32 v[134:135], v[134:135], s[76:77]
  v_pk_add_f32 v[136:137], v[136:137], s[76:77]
  v_pk_add_f32 v[138:139], v[138:139], s[76:77]
  v_pk_add_f32 v[68:69], v[68:69], v[132:133]
  v_pk_add_f32 v[70:71], v[70:71], v[134:135]
  v_pk_add_f32 v[72:73], v[72:73], v[136:137]
  v_pk_add_f32 v[74:75], v[74:75], v[138:139]
  v_pk_mul_f32 v[132:133], v[76:77], s[78:79]
  v_pk_mul_f32 v[134:135], v[78:79], s[78:79]
  v_pk_mul_f32 v[136:137], v[80:81], s[78:79]
  v_pk_mul_f32 v[138:139], v[82:83], s[78:79]
  v_exp_f32_e64 v132, v132 clamp
  v_exp_f32_e64 v133, v133 clamp
  v_exp_f32_e64 v134, v134 clamp
  v_exp_f32_e64 v135, v135 clamp
  v_exp_f32_e64 v136, v136 clamp
  v_exp_f32_e64 v137, v137 clamp
  v_exp_f32_e64 v138, v138 clamp
  v_exp_f32_e64 v139, v139 clamp
  v_max_f32 v76, 0, v76
  v_max_f32 v77, 0, v77
  v_max_f32 v78, 0, v78
  v_max_f32 v79, 0, v79
  v_max_f32 v80, 0, v80
  v_max_f32 v81, 0, v81
  v_max_f32 v82, 0, v82
  v_max_f32 v83, 0, v83
  v_pk_add_f32 v[132:133], v[132:133], s[76:77]
  v_pk_add_f32 v[134:135], v[134:135], s[76:77]
  v_pk_add_f32 v[136:137], v[136:137], s[76:77]
  v_pk_add_f32 v[138:139], v[138:139], s[76:77]
  v_pk_add_f32 v[76:77], v[76:77], v[132:133]
  v_pk_add_f32 v[78:79], v[78:79], v[134:135]
  v_pk_add_f32 v[80:81], v[80:81], v[136:137]
  v_pk_add_f32 v[82:83], v[82:83], v[138:139]
  v_cvt_pk_bf16_f32 v68, v68, v69
  v_cvt_pk_bf16_f32 v69, v70, v71
  v_cvt_pk_bf16_f32 v70, v72, v73
  v_cvt_pk_bf16_f32 v71, v74, v75
  v_cvt_pk_bf16_f32 v76, v76, v77
  v_cvt_pk_bf16_f32 v77, v78, v79
  v_cvt_pk_bf16_f32 v78, v80, v81
  v_cvt_pk_bf16_f32 v79, v82, v83
  ds_write_b128 v140, v[68:71]
  ds_write_b128 v140, v[76:79] offset:640
  v_pk_mul_f32 v[132:133], v[84:85], s[78:79]
  v_pk_mul_f32 v[134:135], v[86:87], s[78:79]
  v_pk_mul_f32 v[136:137], v[88:89], s[78:79]
  v_pk_mul_f32 v[138:139], v[90:91], s[78:79]
  v_exp_f32_e64 v132, v132 clamp
  v_exp_f32_e64 v133, v133 clamp
  v_exp_f32_e64 v134, v134 clamp
  v_exp_f32_e64 v135, v135 clamp
  v_exp_f32_e64 v136, v136 clamp
  v_exp_f32_e64 v137, v137 clamp
  v_exp_f32_e64 v138, v138 clamp
  v_exp_f32_e64 v139, v139 clamp
  v_max_f32 v84, 0, v84
  v_max_f32 v85, 0, v85
  v_max_f32 v86, 0, v86
  v_max_f32 v87, 0, v87
  v_max_f32 v88, 0, v88
  v_max_f32 v89, 0, v89
  v_max_f32 v90, 0, v90
  v_max_f32 v91, 0, v91
  v_pk_add_f32 v[132:133], v[132:133], s[76:77]
  v_pk_add_f32 v[134:135], v[134:135], s[76:77]
  v_pk_add_f32 v[136:137], v[136:137], s[76:77]
  v_pk_add_f32 v[138:139], v[138:139], s[76:77]
  v_pk_add_f32 v[84:85], v[84:85], v[132:133]
  v_pk_add_f32 v[86:87], v[86:87], v[134:135]
  v_pk_add_f32 v[88:89], v[88:89], v[136:137]
  v_pk_add_f32 v[90:91], v[90:91], v[138:139]
  v_pk_mul_f32 v[132:133], v[92:93], s[78:79]
  v_pk_mul_f32 v[134:135], v[94:95], s[78:79]
  v_pk_mul_f32 v[136:137], v[96:97], s[78:79]
  v_pk_mul_f32 v[138:139], v[98:99], s[78:79]
  v_exp_f32_e64 v132, v132 clamp
  v_exp_f32_e64 v133, v133 clamp
  v_exp_f32_e64 v134, v134 clamp
  v_exp_f32_e64 v135, v135 clamp
  v_exp_f32_e64 v136, v136 clamp
  v_exp_f32_e64 v137, v137 clamp
  v_exp_f32_e64 v138, v138 clamp
  v_exp_f32_e64 v139, v139 clamp
  v_max_f32 v92, 0, v92
  v_max_f32 v93, 0, v93
  v_max_f32 v94, 0, v94
  v_max_f32 v95, 0, v95
  v_max_f32 v96, 0, v96
  v_max_f32 v97, 0, v97
  v_max_f32 v98, 0, v98
  v_max_f32 v99, 0, v99
  v_pk_add_f32 v[132:133], v[132:133], s[76:77]
  v_pk_add_f32 v[134:135], v[134:135], s[76:77]
  v_pk_add_f32 v[136:137], v[136:137], s[76:77]
  v_pk_add_f32 v[138:139], v[138:139], s[76:77]
  v_pk_add_f32 v[92:93], v[92:93], v[132:133]
  v_pk_add_f32 v[94:95], v[94:95], v[134:135]
  v_pk_add_f32 v[96:97], v[96:97], v[136:137]
  v_pk_add_f32 v[98:99], v[98:99], v[138:139]
  v_cvt_pk_bf16_f32 v84, v84, v85
  v_cvt_pk_bf16_f32 v85, v86, v87
  v_cvt_pk_bf16_f32 v86, v88, v89
  v_cvt_pk_bf16_f32 v87, v90, v91
  v_cvt_pk_bf16_f32 v92, v92, v93
  v_cvt_pk_bf16_f32 v93, v94, v95
  v_cvt_pk_bf16_f32 v94, v96, v97
  v_cvt_pk_bf16_f32 v95, v98, v99
  ds_write_b128 v141, v[84:87]
  ds_write_b128 v141, v[92:95] offset:640
  v_cmp_le_u32 vcc, 8, v21
  s_nop 1
  v_mov_b32 v136, v100
  v_mov_b32 v137, v101
  v_mov_b32 v138, v102
  v_mov_b32 v139, v103
  v_pk_mul_f32 v[132:133], v[136:137], s[78:79]
  v_pk_mul_f32 v[134:135], v[138:139], s[78:79]
  v_exp_f32_e64 v132, v132 clamp
  v_exp_f32_e64 v133, v133 clamp
  v_exp_f32_e64 v134, v134 clamp
  v_exp_f32_e64 v135, v135 clamp
  v_max_f32 v136, 0, v136
  v_max_f32 v137, 0, v137
  v_max_f32 v138, 0, v138
  v_max_f32 v139, 0, v139
  v_pk_add_f32 v[132:133], v[132:133], s[76:77]
  v_pk_add_f32 v[134:135], v[134:135], s[76:77]
  v_pk_add_f32 v[136:137], v[136:137], v[132:133]
  v_pk_add_f32 v[138:139], v[138:139], v[134:135]
  v_cndmask_b32 v100, v100, v136, vcc
  v_cndmask_b32 v101, v101, v137, vcc
  v_cndmask_b32 v102, v102, v138, vcc
  v_cndmask_b32 v103, v103, v139, vcc
  v_mov_b32 v136, v104
  v_mov_b32 v137, v105
  v_mov_b32 v138, v106
  v_mov_b32 v139, v107
  v_pk_mul_f32 v[132:133], v[136:137], s[78:79]
  v_pk_mul_f32 v[134:135], v[138:139], s[78:79]
  v_exp_f32_e64 v132, v132 clamp
  v_exp_f32_e64 v133, v133 clamp
  v_exp_f32_e64 v134, v134 clamp
  v_exp_f32_e64 v135, v135 clamp
  v_max_f32 v136, 0, v136
  v_max_f32 v137, 0, v137
  v_max_f32 v138, 0, v138
  v_max_f32 v139, 0, v139
  v_pk_add_f32 v[132:133], v[132:133], s[76:77]
  v_pk_add_f32 v[134:135], v[134:135], s[76:77]
  v_pk_add_f32 v[136:137], v[136:137], v[132:133]
  v_pk_add_f32 v[138:139], v[138:139], v[134:135]
  v_cndmask_b32 v104, v104, v136, vcc
  v_cndmask_b32 v105, v105, v137, vcc
  v_cndmask_b32 v106, v106, v138, vcc
  v_cndmask_b32 v107, v107, v139, vcc
  v_mov_b32 v136, v108
  v_mov_b32 v137, v109
  v_mov_b32 v138, v110
  v_mov_b32 v139, v111
  v_pk_mul_f32 v[132:133], v[136:137], s[78:79]
  v_pk_mul_f32 v[134:135], v[138:139], s[78:79]
  v_exp_f32_e64 v132, v132 clamp
  v_exp_f32_e64 v133, v133 clamp
  v_exp_f32_e64 v134, v134 clamp
  v_exp_f32_e64 v135, v135 clamp
  v_max_f32 v136, 0, v136
  v_max_f32 v137, 0, v137
  v_max_f32 v138, 0, v138
  v_max_f32 v139, 0, v139
  v_pk_add_f32 v[132:133], v[132:133], s[76:77]
  v_pk_add_f32 v[134:135], v[134:135], s[76:77]
  v_pk_add_f32 v[136:137], v[136:137], v[132:133]
  v_pk_add_f32 v[138:139], v[138:139], v[134:135]
  v_cndmask_b32 v108, v108, v136, vcc
  v_cndmask_b32 v109, v109, v137, vcc
  v_cndmask_b32 v110, v110, v138, vcc
  v_cndmask_b32 v111, v111, v139, vcc
  v_mov_b32 v136, v112
  v_mov_b32 v137, v113
  v_mov_b32 v138, v114
  v_mov_b32 v139, v115
  v_pk_mul_f32 v[132:133], v[136:137], s[78:79]
  v_pk_mul_f32 v[134:135], v[138:139], s[78:79]
  v_exp_f32_e64 v132, v132 clamp
  v_exp_f32_e64 v133, v133 clamp
  v_exp_f32_e64 v134, v134 clamp
  v_exp_f32_e64 v135, v135 clamp
  v_max_f32 v136, 0, v136
  v_max_f32 v137, 0, v137
  v_max_f32 v138, 0, v138
  v_max_f32 v139, 0, v139
  v_pk_add_f32 v[132:133], v[132:133], s[76:77]
  v_pk_add_f32 v[134:135], v[134:135], s[76:77]
  v_pk_add_f32 v[136:137], v[136:137], v[132:133]
  v_pk_add_f32 v[138:139], v[138:139], v[134:135]
  v_cndmask_b32 v112, v112, v136, vcc
  v_cndmask_b32 v113, v113, v137, vcc
  v_cndmask_b32 v114, v114, v138, vcc
  v_cndmask_b32 v115, v115, v139, vcc
  v_cvt_pk_bf16_f32 v100, v100, v101
  v_cvt_pk_bf16_f32 v101, v102, v103
  v_cvt_pk_bf16_f32 v102, v104, v105
  v_cvt_pk_bf16_f32 v103, v106, v107
  v_cvt_pk_bf16_f32 v108, v108, v109
  v_cvt_pk_bf16_f32 v109, v110, v111
  v_cvt_pk_bf16_f32 v110, v112, v113
  v_cvt_pk_bf16_f32 v111, v114, v115
  ds_write_b128 v142, v[100:103]
  ds_write_b128 v142, v[108:111] offset:640
  v_mov_b32 v132, 0x3f803f80
  v_mov_b32 v133, 0x3f803f80
  v_mov_b32 v134, 0x3f803f80
  v_mov_b32 v135, 0x3f803f80
  ds_write_b128 v144, v[132:135]
  ds_write_b128 v144, v[132:135] offset:640
  s_branch gated_mix__linear_attn_block__mha_block__prompt_kernel_e11_cd
gated_mix__linear_attn_block__mha_block__prompt_kernel_e11_c6:
  v_pk_mul_f32 v[132:133], v[68:69], s[78:79]
  v_pk_mul_f32 v[134:135], v[70:71], s[78:79]
  v_pk_mul_f32 v[136:137], v[72:73], s[78:79]
  v_pk_mul_f32 v[138:139], v[74:75], s[78:79]
  v_exp_f32_e64 v132, v132 clamp
  v_exp_f32_e64 v133, v133 clamp
  v_exp_f32_e64 v134, v134 clamp
  v_exp_f32_e64 v135, v135 clamp
  v_exp_f32_e64 v136, v136 clamp
  v_exp_f32_e64 v137, v137 clamp
  v_exp_f32_e64 v138, v138 clamp
  v_exp_f32_e64 v139, v139 clamp
  v_max_f32 v68, 0, v68
  v_max_f32 v69, 0, v69
  v_max_f32 v70, 0, v70
  v_max_f32 v71, 0, v71
  v_max_f32 v72, 0, v72
  v_max_f32 v73, 0, v73
  v_max_f32 v74, 0, v74
  v_max_f32 v75, 0, v75
  v_pk_add_f32 v[132:133], v[132:133], s[76:77]
  v_pk_add_f32 v[134:135], v[134:135], s[76:77]
  v_pk_add_f32 v[136:137], v[136:137], s[76:77]
  v_pk_add_f32 v[138:139], v[138:139], s[76:77]
  v_pk_add_f32 v[68:69], v[68:69], v[132:133]
  v_pk_add_f32 v[70:71], v[70:71], v[134:135]
  v_pk_add_f32 v[72:73], v[72:73], v[136:137]
  v_pk_add_f32 v[74:75], v[74:75], v[138:139]
  v_pk_mul_f32 v[132:133], v[76:77], s[78:79]
  v_pk_mul_f32 v[134:135], v[78:79], s[78:79]
  v_pk_mul_f32 v[136:137], v[80:81], s[78:79]
  v_pk_mul_f32 v[138:139], v[82:83], s[78:79]
  v_exp_f32_e64 v132, v132 clamp
  v_exp_f32_e64 v133, v133 clamp
  v_exp_f32_e64 v134, v134 clamp
  v_exp_f32_e64 v135, v135 clamp
  v_exp_f32_e64 v136, v136 clamp
  v_exp_f32_e64 v137, v137 clamp
  v_exp_f32_e64 v138, v138 clamp
  v_exp_f32_e64 v139, v139 clamp
  v_max_f32 v76, 0, v76
  v_max_f32 v77, 0, v77
  v_max_f32 v78, 0, v78
  v_max_f32 v79, 0, v79
  v_max_f32 v80, 0, v80
  v_max_f32 v81, 0, v81
  v_max_f32 v82, 0, v82
  v_max_f32 v83, 0, v83
  v_pk_add_f32 v[132:133], v[132:133], s[76:77]
  v_pk_add_f32 v[134:135], v[134:135], s[76:77]
  v_pk_add_f32 v[136:137], v[136:137], s[76:77]
  v_pk_add_f32 v[138:139], v[138:139], s[76:77]
  v_pk_add_f32 v[76:77], v[76:77], v[132:133]
  v_pk_add_f32 v[78:79], v[78:79], v[134:135]
  v_pk_add_f32 v[80:81], v[80:81], v[136:137]
  v_pk_add_f32 v[82:83], v[82:83], v[138:139]
  v_cvt_pk_bf16_f32 v68, v68, v69
  v_cvt_pk_bf16_f32 v69, v70, v71
  v_cvt_pk_bf16_f32 v70, v72, v73
  v_cvt_pk_bf16_f32 v71, v74, v75
  v_cvt_pk_bf16_f32 v76, v76, v77
  v_cvt_pk_bf16_f32 v77, v78, v79
  v_cvt_pk_bf16_f32 v78, v80, v81
  v_cvt_pk_bf16_f32 v79, v82, v83
  ds_write_b128 v140, v[68:71]
  ds_write_b128 v140, v[76:79] offset:640
  v_pk_mul_f32 v[132:133], v[84:85], s[78:79]
  v_pk_mul_f32 v[134:135], v[86:87], s[78:79]
  v_pk_mul_f32 v[136:137], v[88:89], s[78:79]
  v_pk_mul_f32 v[138:139], v[90:91], s[78:79]
  v_exp_f32_e64 v132, v132 clamp
  v_exp_f32_e64 v133, v133 clamp
  v_exp_f32_e64 v134, v134 clamp
  v_exp_f32_e64 v135, v135 clamp
  v_exp_f32_e64 v136, v136 clamp
  v_exp_f32_e64 v137, v137 clamp
  v_exp_f32_e64 v138, v138 clamp
  v_exp_f32_e64 v139, v139 clamp
  v_max_f32 v84, 0, v84
  v_max_f32 v85, 0, v85
  v_max_f32 v86, 0, v86
  v_max_f32 v87, 0, v87
  v_max_f32 v88, 0, v88
  v_max_f32 v89, 0, v89
  v_max_f32 v90, 0, v90
  v_max_f32 v91, 0, v91
  v_pk_add_f32 v[132:133], v[132:133], s[76:77]
  v_pk_add_f32 v[134:135], v[134:135], s[76:77]
  v_pk_add_f32 v[136:137], v[136:137], s[76:77]
  v_pk_add_f32 v[138:139], v[138:139], s[76:77]
  v_pk_add_f32 v[84:85], v[84:85], v[132:133]
  v_pk_add_f32 v[86:87], v[86:87], v[134:135]
  v_pk_add_f32 v[88:89], v[88:89], v[136:137]
  v_pk_add_f32 v[90:91], v[90:91], v[138:139]
  v_pk_mul_f32 v[132:133], v[92:93], s[78:79]
  v_pk_mul_f32 v[134:135], v[94:95], s[78:79]
  v_pk_mul_f32 v[136:137], v[96:97], s[78:79]
  v_pk_mul_f32 v[138:139], v[98:99], s[78:79]
  v_exp_f32_e64 v132, v132 clamp
  v_exp_f32_e64 v133, v133 clamp
  v_exp_f32_e64 v134, v134 clamp
  v_exp_f32_e64 v135, v135 clamp
  v_exp_f32_e64 v136, v136 clamp
  v_exp_f32_e64 v137, v137 clamp
  v_exp_f32_e64 v138, v138 clamp
  v_exp_f32_e64 v139, v139 clamp
  v_max_f32 v92, 0, v92
  v_max_f32 v93, 0, v93
  v_max_f32 v94, 0, v94
  v_max_f32 v95, 0, v95
  v_max_f32 v96, 0, v96
  v_max_f32 v97, 0, v97
  v_max_f32 v98, 0, v98
  v_max_f32 v99, 0, v99
  v_pk_add_f32 v[132:133], v[132:133], s[76:77]
  v_pk_add_f32 v[134:135], v[134:135], s[76:77]
  v_pk_add_f32 v[136:137], v[136:137], s[76:77]
  v_pk_add_f32 v[138:139], v[138:139], s[76:77]
  v_pk_add_f32 v[92:93], v[92:93], v[132:133]
  v_pk_add_f32 v[94:95], v[94:95], v[134:135]
  v_pk_add_f32 v[96:97], v[96:97], v[136:137]
  v_pk_add_f32 v[98:99], v[98:99], v[138:139]
  v_cvt_pk_bf16_f32 v84, v84, v85
  v_cvt_pk_bf16_f32 v85, v86, v87
  v_cvt_pk_bf16_f32 v86, v88, v89
  v_cvt_pk_bf16_f32 v87, v90, v91
  v_cvt_pk_bf16_f32 v92, v92, v93
  v_cvt_pk_bf16_f32 v93, v94, v95
  v_cvt_pk_bf16_f32 v94, v96, v97
  v_cvt_pk_bf16_f32 v95, v98, v99
  ds_write_b128 v141, v[84:87]
  ds_write_b128 v141, v[92:95] offset:640
  v_pk_mul_f32 v[132:133], v[100:101], s[78:79]
  v_pk_mul_f32 v[134:135], v[102:103], s[78:79]
  v_pk_mul_f32 v[136:137], v[104:105], s[78:79]
  v_pk_mul_f32 v[138:139], v[106:107], s[78:79]
  v_exp_f32_e64 v132, v132 clamp
  v_exp_f32_e64 v133, v133 clamp
  v_exp_f32_e64 v134, v134 clamp
  v_exp_f32_e64 v135, v135 clamp
  v_exp_f32_e64 v136, v136 clamp
  v_exp_f32_e64 v137, v137 clamp
  v_exp_f32_e64 v138, v138 clamp
  v_exp_f32_e64 v139, v139 clamp
  v_max_f32 v100, 0, v100
  v_max_f32 v101, 0, v101
  v_max_f32 v102, 0, v102
  v_max_f32 v103, 0, v103
  v_max_f32 v104, 0, v104
  v_max_f32 v105, 0, v105
  v_max_f32 v106, 0, v106
  v_max_f32 v107, 0, v107
  v_pk_add_f32 v[132:133], v[132:133], s[76:77]
  v_pk_add_f32 v[134:135], v[134:135], s[76:77]
  v_pk_add_f32 v[136:137], v[136:137], s[76:77]
  v_pk_add_f32 v[138:139], v[138:139], s[76:77]
  v_pk_add_f32 v[100:101], v[100:101], v[132:133]
  v_pk_add_f32 v[102:103], v[102:103], v[134:135]
  v_pk_add_f32 v[104:105], v[104:105], v[136:137]
  v_pk_add_f32 v[106:107], v[106:107], v[138:139]
  v_pk_mul_f32 v[132:133], v[108:109], s[78:79]
  v_pk_mul_f32 v[134:135], v[110:111], s[78:79]
  v_pk_mul_f32 v[136:137], v[112:113], s[78:79]
  v_pk_mul_f32 v[138:139], v[114:115], s[78:79]
  v_exp_f32_e64 v132, v132 clamp
  v_exp_f32_e64 v133, v133 clamp
  v_exp_f32_e64 v134, v134 clamp
  v_exp_f32_e64 v135, v135 clamp
  v_exp_f32_e64 v136, v136 clamp
  v_exp_f32_e64 v137, v137 clamp
  v_exp_f32_e64 v138, v138 clamp
  v_exp_f32_e64 v139, v139 clamp
  v_max_f32 v108, 0, v108
  v_max_f32 v109, 0, v109
  v_max_f32 v110, 0, v110
  v_max_f32 v111, 0, v111
  v_max_f32 v112, 0, v112
  v_max_f32 v113, 0, v113
  v_max_f32 v114, 0, v114
  v_max_f32 v115, 0, v115
  v_pk_add_f32 v[132:133], v[132:133], s[76:77]
  v_pk_add_f32 v[134:135], v[134:135], s[76:77]
  v_pk_add_f32 v[136:137], v[136:137], s[76:77]
  v_pk_add_f32 v[138:139], v[138:139], s[76:77]
  v_pk_add_f32 v[108:109], v[108:109], v[132:133]
  v_pk_add_f32 v[110:111], v[110:111], v[134:135]
  v_pk_add_f32 v[112:113], v[112:113], v[136:137]
  v_pk_add_f32 v[114:115], v[114:115], v[138:139]
  v_cvt_pk_bf16_f32 v100, v100, v101
  v_cvt_pk_bf16_f32 v101, v102, v103
  v_cvt_pk_bf16_f32 v102, v104, v105
  v_cvt_pk_bf16_f32 v103, v106, v107
  v_cvt_pk_bf16_f32 v108, v108, v109
  v_cvt_pk_bf16_f32 v109, v110, v111
  v_cvt_pk_bf16_f32 v110, v112, v113
  v_cvt_pk_bf16_f32 v111, v114, v115
  ds_write_b128 v142, v[100:103]
  ds_write_b128 v142, v[108:111] offset:640
  v_mov_b32 v132, 0x3f803f80
  v_mov_b32 v133, 0x3f803f80
  v_mov_b32 v134, 0x3f803f80
  v_mov_b32 v135, 0x3f803f80
  ds_write_b128 v144, v[132:135]
  ds_write_b128 v144, v[132:135] offset:640
gated_mix__linear_attn_block__mha_block__prompt_kernel_e11_cd:
  s_waitcnt lgkmcnt(0)
  s_barrier
  s_add_u32 s28, s24, 0
  s_lshl_b32 s29, s28, 10
  v_add_u32 v2, s29, v20
  ds_read_b128 v[68:71], v2
  s_add_u32 s28, s24, 8
  s_lshl_b32 s29, s28, 10
  v_add_u32 v2, s29, v20
  ds_read_b128 v[72:75], v2
  s_add_u32 s28, s24, 16
  s_lshl_b32 s29, s28, 10
  v_add_u32 v2, s29, v20
  ds_read_b128 v[76:79], v2
  s_add_u32 s28, s24, 24
  s_lshl_b32 s29, s28, 10
  v_add_u32 v2, s29, v20
  ds_read_b128 v[80:83], v2
  s_add_u32 s28, s24, 32
  s_lshl_b32 s29, s28, 10
  v_add_u32 v2, s29, v20
  ds_read_b128 v[84:87], v2
  s_add_u32 s28, s24, 40
  s_lshl_b32 s29, s28, 10
  v_add_u32 v2, s29, v20
  ds_read_b128 v[88:91], v2
  s_add_u32 s28, s24, 48
  s_lshl_b32 s29, s28, 10
  v_add_u32 v2, s29, v20
  ds_read_b128 v[92:95], v2
  s_cmp_ge_u32 s24, 4
  s_cbranch_scc1 gated_mix__linear_attn_block__mha_block__prompt_kernel_e11_c_57
  s_add_u32 s28, s24, 56
  s_lshl_b32 s29, s28, 10
  v_add_u32 v2, s29, v20
  ds_read_b128 v[96:99], v2
gated_mix__linear_attn_block__mha_block__prompt_kernel_e11_c_57:
  s_add_u32 s28, s24, 0
  s_mul_i32 s29, s28, 13108
  s_lshr_b32 s29, s29, 16
  s_mul_i32 s30, s29, 5
  s_sub_u32 s30, s28, s30
  s_add_u32 s29, s29, s32
  s_lshr_b32 s49, s29, 5
  s_and_b32 s64, s29, 31
  s_mul_i32 s65, s64, 81920
  s_add_u32 s65, s65, s83
  s_cmp_eq_u32 s49, 2
  s_cselect_b32 s31, 4292344832, 0
  s_add_u32 s65, s65, s31
  s_mul_i32 s31, s64, 155648
  s_add_u32 s31, s31, s82
  s_cmp_eq_u32 s49, 0
  s_cselect_b32 s65, s31, s65
  s_lshl_b32 s30, s30, 10
  s_add_u32 s65, s65, s30
  s_waitcnt lgkmcnt(6)
  buffer_store_dwordx4 v[68:71], v20, s[12:15], s65 offen sc1
  s_add_u32 s28, s24, 8
  s_mul_i32 s29, s28, 13108
  s_lshr_b32 s29, s29, 16
  s_mul_i32 s30, s29, 5
  s_sub_u32 s30, s28, s30
  s_add_u32 s29, s29, s32
  s_lshr_b32 s49, s29, 5
  s_and_b32 s64, s29, 31
  s_mul_i32 s65, s64, 81920
  s_add_u32 s65, s65, s83
  s_cmp_eq_u32 s49, 2
  s_cselect_b32 s31, 4292344832, 0
  s_add_u32 s65, s65, s31
  s_mul_i32 s31, s64, 155648
  s_add_u32 s31, s31, s82
  s_cmp_eq_u32 s49, 0
  s_cselect_b32 s65, s31, s65
  s_lshl_b32 s30, s30, 10
  s_add_u32 s65, s65, s30
  s_waitcnt lgkmcnt(5)
  buffer_store_dwordx4 v[72:75], v20, s[12:15], s65 offen sc1
  s_add_u32 s28, s24, 16
  s_mul_i32 s29, s28, 13108
  s_lshr_b32 s29, s29, 16
  s_mul_i32 s30, s29, 5
  s_sub_u32 s30, s28, s30
  s_add_u32 s29, s29, s32
  s_lshr_b32 s49, s29, 5
  s_and_b32 s64, s29, 31
  s_mul_i32 s65, s64, 81920
  s_add_u32 s65, s65, s83
  s_cmp_eq_u32 s49, 2
  s_cselect_b32 s31, 4292344832, 0
  s_add_u32 s65, s65, s31
  s_mul_i32 s31, s64, 155648
  s_add_u32 s31, s31, s82
  s_cmp_eq_u32 s49, 0
  s_cselect_b32 s65, s31, s65
  s_lshl_b32 s30, s30, 10
  s_add_u32 s65, s65, s30
  s_waitcnt lgkmcnt(4)
  buffer_store_dwordx4 v[76:79], v20, s[12:15], s65 offen sc1
  s_add_u32 s28, s24, 24
  s_mul_i32 s29, s28, 13108
  s_lshr_b32 s29, s29, 16
  s_mul_i32 s30, s29, 5
  s_sub_u32 s30, s28, s30
  s_add_u32 s29, s29, s32
  s_lshr_b32 s49, s29, 5
  s_and_b32 s64, s29, 31
  s_mul_i32 s65, s64, 81920
  s_add_u32 s65, s65, s83
  s_cmp_eq_u32 s49, 2
  s_cselect_b32 s31, 4292344832, 0
  s_add_u32 s65, s65, s31
  s_mul_i32 s31, s64, 155648
  s_add_u32 s31, s31, s82
  s_cmp_eq_u32 s49, 0
  s_cselect_b32 s65, s31, s65
  s_lshl_b32 s30, s30, 10
  s_add_u32 s65, s65, s30
  s_waitcnt lgkmcnt(3)
  buffer_store_dwordx4 v[80:83], v20, s[12:15], s65 offen sc1
  s_add_u32 s28, s24, 32
  s_mul_i32 s29, s28, 13108
  s_lshr_b32 s29, s29, 16
  s_mul_i32 s30, s29, 5
  s_sub_u32 s30, s28, s30
  s_add_u32 s29, s29, s32
  s_lshr_b32 s49, s29, 5
  s_and_b32 s64, s29, 31
  s_mul_i32 s65, s64, 81920
  s_add_u32 s65, s65, s83
  s_cmp_eq_u32 s49, 2
  s_cselect_b32 s31, 4292344832, 0
  s_add_u32 s65, s65, s31
  s_mul_i32 s31, s64, 155648
  s_add_u32 s31, s31, s82
  s_cmp_eq_u32 s49, 0
  s_cselect_b32 s65, s31, s65
  s_lshl_b32 s30, s30, 10
  s_add_u32 s65, s65, s30
  s_waitcnt lgkmcnt(2)
  buffer_store_dwordx4 v[84:87], v20, s[12:15], s65 offen sc1
  s_add_u32 s28, s24, 40
  s_mul_i32 s29, s28, 13108
  s_lshr_b32 s29, s29, 16
  s_mul_i32 s30, s29, 5
  s_sub_u32 s30, s28, s30
  s_add_u32 s29, s29, s32
  s_lshr_b32 s49, s29, 5
  s_and_b32 s64, s29, 31
  s_mul_i32 s65, s64, 81920
  s_add_u32 s65, s65, s83
  s_cmp_eq_u32 s49, 2
  s_cselect_b32 s31, 4292344832, 0
  s_add_u32 s65, s65, s31
  s_mul_i32 s31, s64, 155648
  s_add_u32 s31, s31, s82
  s_cmp_eq_u32 s49, 0
  s_cselect_b32 s65, s31, s65
  s_lshl_b32 s30, s30, 10
  s_add_u32 s65, s65, s30
  s_waitcnt lgkmcnt(1)
  buffer_store_dwordx4 v[88:91], v20, s[12:15], s65 offen sc1
  s_add_u32 s28, s24, 48
  s_mul_i32 s29, s28, 13108
  s_lshr_b32 s29, s29, 16
  s_mul_i32 s30, s29, 5
  s_sub_u32 s30, s28, s30
  s_add_u32 s29, s29, s32
  s_lshr_b32 s49, s29, 5
  s_and_b32 s64, s29, 31
  s_mul_i32 s65, s64, 81920
  s_add_u32 s65, s65, s83
  s_cmp_eq_u32 s49, 2
  s_cselect_b32 s31, 4292344832, 0
  s_add_u32 s65, s65, s31
  s_mul_i32 s31, s64, 155648
  s_add_u32 s31, s31, s82
  s_cmp_eq_u32 s49, 0
  s_cselect_b32 s65, s31, s65
  s_lshl_b32 s30, s30, 10
  s_add_u32 s65, s65, s30
  s_waitcnt lgkmcnt(0)
  buffer_store_dwordx4 v[92:95], v20, s[12:15], s65 offen sc1
  s_cmp_ge_u32 s24, 4
  s_cbranch_scc1 gated_mix__linear_attn_block__mha_block__prompt_kernel_e11_d_65
  s_add_u32 s28, s24, 56
  s_mul_i32 s29, s28, 13108
  s_lshr_b32 s29, s29, 16
  s_mul_i32 s30, s29, 5
  s_sub_u32 s30, s28, s30
  s_add_u32 s29, s29, s32
  s_lshr_b32 s49, s29, 5
  s_and_b32 s64, s29, 31
  s_mul_i32 s65, s64, 81920
  s_add_u32 s65, s65, s83
  s_cmp_eq_u32 s49, 2
  s_cselect_b32 s31, 4292344832, 0
  s_add_u32 s65, s65, s31
  s_mul_i32 s31, s64, 155648
  s_add_u32 s31, s31, s82
  s_cmp_eq_u32 s49, 0
  s_cselect_b32 s65, s31, s65
  s_lshl_b32 s30, s30, 10
  s_add_u32 s65, s65, s30
  s_waitcnt lgkmcnt(0)
  buffer_store_dwordx4 v[96:99], v20, s[12:15], s65 offen sc1
gated_mix__linear_attn_block__mha_block__prompt_kernel_e11_d_65:
gated_mix__linear_attn_block__mha_block__prompt_kernel_c2:
  s_and_b32 s26, s2, 7
  s_lshl_b32 s26, s26, 2
  s_lshr_b32 s29, s2, 3
  s_and_b32 s30, s29, 3
  s_add_u32 s26, s26, s30
  s_lshr_b32 s27, s2, 5
  v_and_b32 v1, 63, v0
  v_lshlrev_b32 v9, 4, v1
  v_and_b32 v3, 31, v1
  v_lshrrev_b32 v4, 5, v1
  v_lshlrev_b32 v11, 2, v3
  s_mul_i32 s33, s26, 155648
  s_add_u32 s33, s33, 2359296
  s_and_b32 s38, s24, 3
  s_lshr_b32 s37, s24, 2
  s_lshl_b32 s28, s27, 3
  s_lshl_b32 s29, s38, 1
  s_add_u32 s28, s28, s29
  s_lshl_b32 s29, s26, 6
  s_add_u32 s29, s29, s28
  s_lshl_b32 s35, s29, 10
  s_lshl_b32 s36, s29, 7
  s_lshl_b32 s30, s37, 10
  s_add_u32 s39, s35, s30
  s_lshl_b32 s30, s37, 7
  s_add_u32 s40, s36, s30
  s_mul_i32 s29, s37, 77824
  v_add_u32 v6, s29, v9
  v_lshlrev_b32 v2, 4, v3
  v_mul_u32_u24 v8, 320, v4
  v_add_u32 v8, v8, v2
  v_add_u32 v7, 8192, v11
  v_add_u32 v7, s29, v7
  v_add_u32 v8, 9216, v8
  v_add_u32 v8, s29, v8
  v_mov_b32 v2, 0x10000000
  v_cmp_gt_u32 vcc, 19, v3
  s_nop 1
  v_cndmask_b32 v8, v2, v8, vcc
  v_cmp_gt_u32 vcc, 32, v1
  s_nop 1
  v_cndmask_b32 v7, v2, v7, vcc
  v_mov_b32 v2, 2130706432
  v_cndmask_b32 v10, v2, v11, vcc
  v_mov_b32 v100, 0
  v_mov_b32 v116, 0
  v_mov_b32 v101, 0
  v_mov_b32 v117, 0
  v_mov_b32 v102, 0
  v_mov_b32 v118, 0
  v_mov_b32 v103, 0
  v_mov_b32 v119, 0
  v_mov_b32 v104, 0
  v_mov_b32 v120, 0
  v_mov_b32 v105, 0
  v_mov_b32 v121, 0
  v_mov_b32 v106, 0
  v_mov_b32 v122, 0
  v_mov_b32 v107, 0
  v_mov_b32 v123, 0
  v_mov_b32 v108, 0
  v_mov_b32 v124, 0
  v_mov_b32 v109, 0
  v_mov_b32 v125, 0
  v_mov_b32 v110, 0
  v_mov_b32 v126, 0
  v_mov_b32 v111, 0
  v_mov_b32 v127, 0
  v_mov_b32 v112, 0
  v_mov_b32 v128, 0
  v_mov_b32 v113, 0
  v_mov_b32 v129, 0
  v_mov_b32 v114, 0
  v_mov_b32 v130, 0
  v_mov_b32 v115, 0
  v_mov_b32 v131, 0
  v_mov_b32 v56, 0
  v_mov_b32 v57, 0
  v_mov_b32 v58, 0
  v_mov_b32 v59, 0
  v_mov_b32 v60, 0
  v_mov_b32 v61, 0
  v_mov_b32 v62, 0
  v_mov_b32 v63, 0
  v_mov_b32 v40, 0
  v_mov_b32 v41, 0
  v_mov_b32 v42, 0
  v_mov_b32 v43, 0
  v_mov_b32 v44, 0
  v_mov_b32 v45, 0
  v_mov_b32 v46, 0
  v_mov_b32 v47, 0
  v_mov_b32 v48, 0
  v_mov_b32 v49, 0
  v_mov_b32 v50, 0
  v_mov_b32 v51, 0
  v_mov_b32 v52, 0
  v_mov_b32 v53, 0
  v_mov_b32 v54, 0
  v_mov_b32 v55, 0
  s_waitcnt vmcnt(0)
  s_barrier
  s_barrier
  s_add_u32 s29, s35, 0
  s_add_u32 s30, s36, 2097152
  buffer_load_dwordx4 v[12:15], v9, s[12:15], s29 offen sc1
  buffer_load_dwordx4 v[16:19], v9, s[12:15], s29 offen offset:1024 sc1
  buffer_load_dword v20, v11, s[12:15], s30 offen sc1
  buffer_load_dword v24, v11, s[12:15], s30 offen offset:128 sc1
  v_cmp_gt_u32 vcc, 32, v1
  s_nop 0
  s_waitcnt vmcnt(0)
  v_cndmask_b32 v20, 0, v20, vcc
  v_cndmask_b32 v24, 0, v24, vcc
  v_dot2_f32_bf16 v2, v12, v12, 0
  v_dot2_f32_bf16 v3, v16, v16, 0
  v_dot2_f32_bf16 v2, v13, v13, v2
  v_dot2_f32_bf16 v3, v17, v17, v3
  v_dot2_f32_bf16 v2, v14, v14, v2
  v_dot2_f32_bf16 v3, v18, v18, v3
  v_dot2_f32_bf16 v2, v15, v15, v2
  v_dot2_f32_bf16 v3, v19, v19, v3
  v_dot2_f32_bf16 v2, v20, v20, v2
  v_dot2_f32_bf16 v3, v24, v24, v3
  v_mov_b32 v21, 0
  v_mov_b32 v22, 0
  v_mov_b32 v23, v20
  v_mov_b32 v25, 0
  v_mov_b32 v26, 0
  v_mov_b32 v27, v24
  v_mov_b32 v4, v2
  v_mov_b32 v5, v3
  s_nop 1
  v_permlane32_swap_b32 v2, v4
  v_permlane32_swap_b32 v3, v5
  s_nop 1
  v_add_f32 v84, v2, v4
  v_add_f32 v85, v3, v5
  v_and_b32 v4, 15, v1
  v_lshlrev_b32 v4, 3, v4
  v_add_u32 v4, 155712, v4
  s_barrier
  ds_read_b64 v[64:65], v4
  ds_read_b128 v[28:31], v6
  ds_read2_b32 v[36:37], v7 offset0:0 offset1:32
  ds_read_b128 v[40:43], v8
  ds_read_b128 v[44:47], v8 offset:640
  ds_read_b128 v[32:35], v6 offset:1024
  s_waitcnt lgkmcnt(5)
  v_max_u32_dpp v64, v64, v64 row_ror:1 row_mask:0xf bank_mask:0xf
  v_max_u32_dpp v65, v65, v65 row_ror:1 row_mask:0xf bank_mask:0xf
  s_nop 0
  v_max_u32_dpp v64, v64, v64 row_ror:2 row_mask:0xf bank_mask:0xf
  v_max_u32_dpp v65, v65, v65 row_ror:2 row_mask:0xf bank_mask:0xf
  s_nop 0
  v_max_u32_dpp v64, v64, v64 row_ror:4 row_mask:0xf bank_mask:0xf
  v_max_u32_dpp v65, v65, v65 row_ror:4 row_mask:0xf bank_mask:0xf
  s_nop 0
  v_max_u32_dpp v64, v64, v64 row_ror:8 row_mask:0xf bank_mask:0xf
  v_max_u32_dpp v65, v65, v65 row_ror:8 row_mask:0xf bank_mask:0xf
  s_nop 0
  s_nop 0
  v_add_f32 v65, v64, v65
  v_mul_f32 v2, v84, v65
  v_mul_f32 v3, v85, v65
  v_sqrt_f32 v2, v2
  v_sqrt_f32 v3, v3
  v_mov_b32 v4, 0x3a83126f
  v_mov_b32 v5, 0x42400000
  v_fmac_f32 v4, 0x3f828f5c, v2
  v_mov_b32 v65, 0x3a83126f
  v_fmac_f32 v65, 0x3f828f5c, v3
  v_mov_b32 v64, v4
  v_cmp_nle_f32 vcc, v4, v5
  v_cmp_nle_f32 s[42:43], v65, v5
  s_nop 1
  s_or_b64 vcc, vcc, s[42:43]
  s_cmp_eq_u64 vcc, 0
  s_cbranch_scc0 gated_mix__linear_attn_block__mha_block__prompt_kernel_fb
  v_sub_f32 v132, 0, v64
  v_sub_f32 v148, 0, v65
  v_mov_b32 v133, v132
  v_mov_b32 v149, v148
  v_mov_b32 v134, v132
  v_mov_b32 v150, v148
  v_mov_b32 v135, v132
  v_mov_b32 v151, v148
  v_mov_b32 v136, v132
  v_mov_b32 v152, v148
  v_mov_b32 v137, v132
  v_mov_b32 v153, v148
  v_mov_b32 v138, v132
  v_mov_b32 v154, v148
  v_mov_b32 v139, v132
  v_mov_b32 v155, v148
  v_mov_b32 v140, v132
  v_mov_b32 v156, v148
  v_mov_b32 v141, v132
  v_mov_b32 v157, v148
  v_mov_b32 v142, v132
  v_mov_b32 v158, v148
  v_mov_b32 v143, v132
  v_mov_b32 v159, v148
  v_mov_b32 v144, v132
  v_mov_b32 v160, v148
  v_mov_b32 v145, v132
  v_mov_b32 v161, v148
  v_mov_b32 v146, v132
  v_mov_b32 v162, v148
  v_mov_b32 v147, v132
  v_mov_b32 v163, v148
gated_mix__linear_attn_block__mha_block__prompt_kernel_fast:
  s_waitcnt lgkmcnt(3)
  v_mfma_f32_32x32x16_bf16 v[68:83], v[28:31], v[12:15], v[132:147]
  v_mfma_f32_32x32x8_bf16 v[68:83], v[36:37], v[20:21], v[68:83]
  s_mov_b32 s44, 0
  s_nop 7
  s_nop 3
gated_mix__linear_attn_block__mha_block__prompt_kernel_loop:
  v_mfma_f32_32x32x16_bf16 v[84:99], v[28:31], v[16:19], v[148:163]
  v_exp_f32 v68, v68
  v_exp_f32 v69, v69
  v_exp_f32 v70, v70
  v_exp_f32 v71, v71
  v_cvt_pk_bf16_f32 v56, v68, v69
  v_cvt_pk_bf16_f32 v57, v70, v71
  v_mfma_f32_32x32x16_bf16 v[116:131], v[52:55], v[60:63], v[116:131]
  ds_read_b128 v[48:51], v8 offset:1280
  ds_read_b128 v[52:55], v8 offset:1920
  v_exp_f32 v72, v72
  v_exp_f32 v73, v73
  v_exp_f32 v74, v74
  v_exp_f32 v75, v75
  v_cvt_pk_bf16_f32 v58, v72, v73
  v_cvt_pk_bf16_f32 v59, v74, v75
  v_mfma_f32_32x32x8_bf16 v[84:99], v[36:37], v[24:25], v[84:99]
  v_exp_f32 v76, v76
  v_exp_f32 v77, v77
  v_exp_f32 v78, v78
  v_exp_f32 v79, v79
  v_cvt_pk_bf16_f32 v60, v76, v77
  v_cvt_pk_bf16_f32 v61, v78, v79
  s_waitcnt lgkmcnt(3)
  v_mfma_f32_32x32x16_bf16 v[100:115], v[40:43], v[56:59], v[100:115]
  v_exp_f32 v80, v80
  v_exp_f32 v81, v81
  v_exp_f32 v82, v82
  v_exp_f32 v83, v83
  v_cvt_pk_bf16_f32 v62, v80, v81
  v_cvt_pk_bf16_f32 v63, v82, v83
  s_waitcnt lgkmcnt(2)
  v_mfma_f32_32x32x16_bf16 v[68:83], v[32:35], v[12:15], v[132:147]
  v_exp_f32 v84, v84
  v_exp_f32 v85, v85
  v_exp_f32 v86, v86
  v_exp_f32 v87, v87
  v_cvt_pk_bf16_f32 v56, v84, v85
  v_cvt_pk_bf16_f32 v57, v86, v87
  v_mfma_f32_32x32x16_bf16 v[100:115], v[44:47], v[60:63], v[100:115]
  ds_read_b128 v[28:31], v6 offset:2048
  ds_read2_b32 v[38:39], v7 offset0:64 offset1:96
  v_exp_f32 v88, v88
  v_exp_f32 v89, v89
  v_exp_f32 v90, v90
  v_exp_f32 v91, v91
  v_cvt_pk_bf16_f32 v58, v88, v89
  v_cvt_pk_bf16_f32 v59, v90, v91
  v_mfma_f32_32x32x8_bf16 v[68:83], v[36:37], v[22:23], v[68:83]
  v_exp_f32 v92, v92
  v_exp_f32 v93, v93
  v_exp_f32 v94, v94
  v_exp_f32 v95, v95
  v_cvt_pk_bf16_f32 v60, v92, v93
  v_cvt_pk_bf16_f32 v61, v94, v95
  v_mfma_f32_32x32x16_bf16 v[116:131], v[40:43], v[56:59], v[116:131]
  v_exp_f32 v96, v96
  v_exp_f32 v97, v97
  v_exp_f32 v98, v98
  v_exp_f32 v99, v99
  v_cvt_pk_bf16_f32 v62, v96, v97
  v_cvt_pk_bf16_f32 v63, v98, v99
  v_mfma_f32_32x32x16_bf16 v[84:99], v[32:35], v[16:19], v[148:163]
  v_exp_f32 v68, v68
  v_exp_f32 v69, v69
  v_exp_f32 v70, v70
  v_exp_f32 v71, v71
  v_cvt_pk_bf16_f32 v56, v68, v69
  v_cvt_pk_bf16_f32 v57, v70, v71
  v_mfma_f32_32x32x16_bf16 v[116:131], v[44:47], v[60:63], v[116:131]
  ds_read_b128 v[40:43], v8 offset:2560
  ds_read_b128 v[44:47], v8 offset:3200
  v_exp_f32 v72, v72
  v_exp_f32 v73, v73
  v_exp_f32 v74, v74
  v_exp_f32 v75, v75
  v_cvt_pk_bf16_f32 v58, v72, v73
  v_cvt_pk_bf16_f32 v59, v74, v75
  v_mfma_f32_32x32x8_bf16 v[84:99], v[36:37], v[26:27], v[84:99]
  v_exp_f32 v76, v76
  v_exp_f32 v77, v77
  v_exp_f32 v78, v78
  v_exp_f32 v79, v79
  v_cvt_pk_bf16_f32 v60, v76, v77
  v_cvt_pk_bf16_f32 v61, v78, v79
  s_waitcnt lgkmcnt(4)
  v_mfma_f32_32x32x16_bf16 v[100:115], v[48:51], v[56:59], v[100:115]
  v_exp_f32 v80, v80
  v_exp_f32 v81, v81
  v_exp_f32 v82, v82
  v_exp_f32 v83, v83
  v_cvt_pk_bf16_f32 v62, v80, v81
  v_cvt_pk_bf16_f32 v63, v82, v83
  s_waitcnt lgkmcnt(2)
  v_mfma_f32_32x32x16_bf16 v[68:83], v[28:31], v[12:15], v[132:147]
  v_exp_f32 v84, v84
  v_exp_f32 v85, v85
  v_exp_f32 v86, v86
  v_exp_f32 v87, v87
  v_cvt_pk_bf16_f32 v56, v84, v85
  v_cvt_pk_bf16_f32 v57, v86, v87
  v_mfma_f32_32x32x16_bf16 v[100:115], v[52:55], v[60:63], v[100:115]
  ds_read_b128 v[32:35], v6 offset:3072
  v_exp_f32 v88, v88
  v_exp_f32 v89, v89
  v_exp_f32 v90, v90
  v_exp_f32 v91, v91
  v_cvt_pk_bf16_f32 v58, v88, v89
  v_cvt_pk_bf16_f32 v59, v90, v91
  v_mfma_f32_32x32x8_bf16 v[68:83], v[38:39], v[20:21], v[68:83]
  v_exp_f32 v92, v92
  v_exp_f32 v93, v93
  v_exp_f32 v94, v94
  v_exp_f32 v95, v95
  v_cvt_pk_bf16_f32 v60, v92, v93
  v_cvt_pk_bf16_f32 v61, v94, v95
  v_mfma_f32_32x32x16_bf16 v[116:131], v[48:51], v[56:59], v[116:131]
  v_exp_f32 v96, v96
  v_exp_f32 v97, v97
  v_exp_f32 v98, v98
  v_exp_f32 v99, v99
  v_cvt_pk_bf16_f32 v62, v96, v97
  v_cvt_pk_bf16_f32 v63, v98, v99
  v_mfma_f32_32x32x16_bf16 v[84:99], v[28:31], v[16:19], v[148:163]
  v_exp_f32 v68, v68
  v_exp_f32 v69, v69
  v_exp_f32 v70, v70
  v_exp_f32 v71, v71
  v_cvt_pk_bf16_f32 v56, v68, v69
  v_cvt_pk_bf16_f32 v57, v70, v71
  v_mfma_f32_32x32x16_bf16 v[116:131], v[52:55], v[60:63], v[116:131]
  ds_read_b128 v[48:51], v8 offset:3840
  ds_read_b128 v[52:55], v8 offset:4480
  v_exp_f32 v72, v72
  v_exp_f32 v73, v73
  v_exp_f32 v74, v74
  v_exp_f32 v75, v75
  v_cvt_pk_bf16_f32 v58, v72, v73
  v_cvt_pk_bf16_f32 v59, v74, v75
  v_mfma_f32_32x32x8_bf16 v[84:99], v[38:39], v[24:25], v[84:99]
  v_exp_f32 v76, v76
  v_exp_f32 v77, v77
  v_exp_f32 v78, v78
  v_exp_f32 v79, v79
  v_cvt_pk_bf16_f32 v60, v76, v77
  v_cvt_pk_bf16_f32 v61, v78, v79
  s_waitcnt lgkmcnt(3)
  v_mfma_f32_32x32x16_bf16 v[100:115], v[40:43], v[56:59], v[100:115]
  v_exp_f32 v80, v80
  v_exp_f32 v81, v81
  v_exp_f32 v82, v82
  v_exp_f32 v83, v83
  v_cvt_pk_bf16_f32 v62, v80, v81
  v_cvt_pk_bf16_f32 v63, v82, v83
  s_waitcnt lgkmcnt(2)
  v_mfma_f32_32x32x16_bf16 v[68:83], v[32:35], v[12:15], v[132:147]
  v_exp_f32 v84, v84
  v_exp_f32 v85, v85
  v_exp_f32 v86, v86
  v_exp_f32 v87, v87
  v_cvt_pk_bf16_f32 v56, v84, v85
  v_cvt_pk_bf16_f32 v57, v86, v87
  v_mfma_f32_32x32x16_bf16 v[100:115], v[44:47], v[60:63], v[100:115]
  ds_read_b128 v[28:31], v6 offset:4096
  ds_read2_b32 v[36:37], v7 offset0:128 offset1:160
  v_exp_f32 v88, v88
  v_exp_f32 v89, v89
  v_exp_f32 v90, v90
  v_exp_f32 v91, v91
  v_cvt_pk_bf16_f32 v58, v88, v89
  v_cvt_pk_bf16_f32 v59, v90, v91
  v_mfma_f32_32x32x8_bf16 v[68:83], v[38:39], v[22:23], v[68:83]
  v_exp_f32 v92, v92
  v_exp_f32 v93, v93
  v_exp_f32 v94, v94
  v_exp_f32 v95, v95
  v_cvt_pk_bf16_f32 v60, v92, v93
  v_cvt_pk_bf16_f32 v61, v94, v95
  v_mfma_f32_32x32x16_bf16 v[116:131], v[40:43], v[56:59], v[116:131]
  v_exp_f32 v96, v96
  v_exp_f32 v97, v97
  v_exp_f32 v98, v98
  v_exp_f32 v99, v99
  v_cvt_pk_bf16_f32 v62, v96, v97
  v_cvt_pk_bf16_f32 v63, v98, v99
  v_mfma_f32_32x32x16_bf16 v[84:99], v[32:35], v[16:19], v[148:163]
  v_exp_f32 v68, v68
  v_exp_f32 v69, v69
  v_exp_f32 v70, v70
  v_exp_f32 v71, v71
  v_cvt_pk_bf16_f32 v56, v68, v69
  v_cvt_pk_bf16_f32 v57, v70, v71
  v_mfma_f32_32x32x16_bf16 v[116:131], v[44:47], v[60:63], v[116:131]
  ds_read_b128 v[40:43], v8 offset:5120
  ds_read_b128 v[44:47], v8 offset:5760
  v_exp_f32 v72, v72
  v_exp_f32 v73, v73
  v_exp_f32 v74, v74
  v_exp_f32 v75, v75
  v_cvt_pk_bf16_f32 v58, v72, v73
  v_cvt_pk_bf16_f32 v59, v74, v75
  v_mfma_f32_32x32x8_bf16 v[84:99], v[38:39], v[26:27], v[84:99]
  v_exp_f32 v76, v76
  v_exp_f32 v77, v77
  v_exp_f32 v78, v78
  v_exp_f32 v79, v79
  v_cvt_pk_bf16_f32 v60, v76, v77
  v_cvt_pk_bf16_f32 v61, v78, v79
  s_waitcnt lgkmcnt(4)
  v_mfma_f32_32x32x16_bf16 v[100:115], v[48:51], v[56:59], v[100:115]
  v_exp_f32 v80, v80
  v_exp_f32 v81, v81
  v_exp_f32 v82, v82
  v_exp_f32 v83, v83
  v_cvt_pk_bf16_f32 v62, v80, v81
  v_cvt_pk_bf16_f32 v63, v82, v83
  s_waitcnt lgkmcnt(2)
  v_mfma_f32_32x32x16_bf16 v[68:83], v[28:31], v[12:15], v[132:147]
  v_exp_f32 v84, v84
  v_exp_f32 v85, v85
  v_exp_f32 v86, v86
  v_exp_f32 v87, v87
  v_cvt_pk_bf16_f32 v56, v84, v85
  v_cvt_pk_bf16_f32 v57, v86, v87
  v_mfma_f32_32x32x16_bf16 v[100:115], v[52:55], v[60:63], v[100:115]
  ds_read_b128 v[32:35], v6 offset:5120
  v_exp_f32 v88, v88
  v_exp_f32 v89, v89
  v_exp_f32 v90, v90
  v_exp_f32 v91, v91
  v_cvt_pk_bf16_f32 v58, v88, v89
  v_cvt_pk_bf16_f32 v59, v90, v91
  v_mfma_f32_32x32x8_bf16 v[68:83], v[36:37], v[20:21], v[68:83]
  v_exp_f32 v92, v92
  v_exp_f32 v93, v93
  v_exp_f32 v94, v94
  v_exp_f32 v95, v95
  v_cvt_pk_bf16_f32 v60, v92, v93
  v_cvt_pk_bf16_f32 v61, v94, v95
  v_mfma_f32_32x32x16_bf16 v[116:131], v[48:51], v[56:59], v[116:131]
  v_exp_f32 v96, v96
  v_exp_f32 v97, v97
  v_exp_f32 v98, v98
  v_exp_f32 v99, v99
  v_cvt_pk_bf16_f32 v62, v96, v97
  v_cvt_pk_bf16_f32 v63, v98, v99
  v_mfma_f32_32x32x16_bf16 v[84:99], v[28:31], v[16:19], v[148:163]
  v_exp_f32 v68, v68
  v_exp_f32 v69, v69
  v_exp_f32 v70, v70
  v_exp_f32 v71, v71
  v_cvt_pk_bf16_f32 v56, v68, v69
  v_cvt_pk_bf16_f32 v57, v70, v71
  v_mfma_f32_32x32x16_bf16 v[116:131], v[52:55], v[60:63], v[116:131]
  ds_read_b128 v[48:51], v8 offset:6400
  ds_read_b128 v[52:55], v8 offset:7040
  v_exp_f32 v72, v72
  v_exp_f32 v73, v73
  v_exp_f32 v74, v74
  v_exp_f32 v75, v75
  v_cvt_pk_bf16_f32 v58, v72, v73
  v_cvt_pk_bf16_f32 v59, v74, v75
  v_mfma_f32_32x32x8_bf16 v[84:99], v[36:37], v[24:25], v[84:99]
  v_exp_f32 v76, v76
  v_exp_f32 v77, v77
  v_exp_f32 v78, v78
  v_exp_f32 v79, v79
  v_cvt_pk_bf16_f32 v60, v76, v77
  v_cvt_pk_bf16_f32 v61, v78, v79
  s_waitcnt lgkmcnt(3)
  v_mfma_f32_32x32x16_bf16 v[100:115], v[40:43], v[56:59], v[100:115]
  v_exp_f32 v80, v80
  v_exp_f32 v81, v81
  v_exp_f32 v82, v82
  v_exp_f32 v83, v83
  v_cvt_pk_bf16_f32 v62, v80, v81
  v_cvt_pk_bf16_f32 v63, v82, v83
  s_waitcnt lgkmcnt(2)
  v_mfma_f32_32x32x16_bf16 v[68:83], v[32:35], v[12:15], v[132:147]
  v_exp_f32 v84, v84
  v_exp_f32 v85, v85
  v_exp_f32 v86, v86
  v_exp_f32 v87, v87
  v_cvt_pk_bf16_f32 v56, v84, v85
  v_cvt_pk_bf16_f32 v57, v86, v87
  v_mfma_f32_32x32x16_bf16 v[100:115], v[44:47], v[60:63], v[100:115]
  ds_read_b128 v[28:31], v6 offset:6144
  ds_read2_b32 v[38:39], v7 offset0:192 offset1:224
  v_exp_f32 v88, v88
  v_exp_f32 v89, v89
  v_exp_f32 v90, v90
  v_exp_f32 v91, v91
  v_cvt_pk_bf16_f32 v58, v88, v89
  v_cvt_pk_bf16_f32 v59, v90, v91
  v_mfma_f32_32x32x8_bf16 v[68:83], v[36:37], v[22:23], v[68:83]
  v_exp_f32 v92, v92
  v_exp_f32 v93, v93
  v_exp_f32 v94, v94
  v_exp_f32 v95, v95
  v_cvt_pk_bf16_f32 v60, v92, v93
  v_cvt_pk_bf16_f32 v61, v94, v95
  v_mfma_f32_32x32x16_bf16 v[116:131], v[40:43], v[56:59], v[116:131]
  v_exp_f32 v96, v96
  v_exp_f32 v97, v97
  v_exp_f32 v98, v98
  v_exp_f32 v99, v99
  v_cvt_pk_bf16_f32 v62, v96, v97
  v_cvt_pk_bf16_f32 v63, v98, v99
  v_mfma_f32_32x32x16_bf16 v[84:99], v[32:35], v[16:19], v[148:163]
  v_exp_f32 v68, v68
  v_exp_f32 v69, v69
  v_exp_f32 v70, v70
  v_exp_f32 v71, v71
  v_cvt_pk_bf16_f32 v56, v68, v69
  v_cvt_pk_bf16_f32 v57, v70, v71
  v_mfma_f32_32x32x16_bf16 v[116:131], v[44:47], v[60:63], v[116:131]
  ds_read_b128 v[40:43], v8 offset:7680
  ds_read_b128 v[44:47], v8 offset:8320
  v_exp_f32 v72, v72
  v_exp_f32 v73, v73
  v_exp_f32 v74, v74
  v_exp_f32 v75, v75
  v_cvt_pk_bf16_f32 v58, v72, v73
  v_cvt_pk_bf16_f32 v59, v74, v75
  v_mfma_f32_32x32x8_bf16 v[84:99], v[36:37], v[26:27], v[84:99]
  v_exp_f32 v76, v76
  v_exp_f32 v77, v77
  v_exp_f32 v78, v78
  v_exp_f32 v79, v79
  v_cvt_pk_bf16_f32 v60, v76, v77
  v_cvt_pk_bf16_f32 v61, v78, v79
  s_waitcnt lgkmcnt(4)
  v_mfma_f32_32x32x16_bf16 v[100:115], v[48:51], v[56:59], v[100:115]
  v_exp_f32 v80, v80
  v_exp_f32 v81, v81
  v_exp_f32 v82, v82
  v_exp_f32 v83, v83
  v_cvt_pk_bf16_f32 v62, v80, v81
  v_cvt_pk_bf16_f32 v63, v82, v83
  s_waitcnt lgkmcnt(2)
  v_mfma_f32_32x32x16_bf16 v[68:83], v[28:31], v[12:15], v[132:147]
  v_exp_f32 v84, v84
  v_exp_f32 v85, v85
  v_exp_f32 v86, v86
  v_exp_f32 v87, v87
  v_cvt_pk_bf16_f32 v56, v84, v85
  v_cvt_pk_bf16_f32 v57, v86, v87
  v_mfma_f32_32x32x16_bf16 v[100:115], v[52:55], v[60:63], v[100:115]
  ds_read_b128 v[32:35], v6 offset:7168
  v_exp_f32 v88, v88
  v_exp_f32 v89, v89
  v_exp_f32 v90, v90
  v_exp_f32 v91, v91
  v_cvt_pk_bf16_f32 v58, v88, v89
  v_cvt_pk_bf16_f32 v59, v90, v91
  v_mfma_f32_32x32x8_bf16 v[68:83], v[38:39], v[20:21], v[68:83]
  v_exp_f32 v92, v92
  v_exp_f32 v93, v93
  v_exp_f32 v94, v94
  v_exp_f32 v95, v95
  v_cvt_pk_bf16_f32 v60, v92, v93
  v_cvt_pk_bf16_f32 v61, v94, v95
  v_mfma_f32_32x32x16_bf16 v[116:131], v[48:51], v[56:59], v[116:131]
  v_exp_f32 v96, v96
  v_exp_f32 v97, v97
  v_exp_f32 v98, v98
  v_exp_f32 v99, v99
  v_cvt_pk_bf16_f32 v62, v96, v97
  v_cvt_pk_bf16_f32 v63, v98, v99
  s_barrier
  v_mfma_f32_32x32x16_bf16 v[84:99], v[28:31], v[16:19], v[148:163]
  v_exp_f32 v68, v68
  v_exp_f32 v69, v69
  v_exp_f32 v70, v70
  v_exp_f32 v71, v71
  v_cvt_pk_bf16_f32 v56, v68, v69
  v_cvt_pk_bf16_f32 v57, v70, v71
  v_mfma_f32_32x32x16_bf16 v[116:131], v[52:55], v[60:63], v[116:131]
  ds_read_b128 v[48:51], v8 offset:8960
  ds_read_b128 v[52:55], v8 offset:9600
  v_exp_f32 v72, v72
  v_exp_f32 v73, v73
  v_exp_f32 v74, v74
  v_exp_f32 v75, v75
  v_cvt_pk_bf16_f32 v58, v72, v73
  v_cvt_pk_bf16_f32 v59, v74, v75
  v_mfma_f32_32x32x8_bf16 v[84:99], v[38:39], v[24:25], v[84:99]
  v_exp_f32 v76, v76
  v_exp_f32 v77, v77
  v_exp_f32 v78, v78
  v_exp_f32 v79, v79
  v_cvt_pk_bf16_f32 v60, v76, v77
  v_cvt_pk_bf16_f32 v61, v78, v79
  s_waitcnt lgkmcnt(3)
  v_mfma_f32_32x32x16_bf16 v[100:115], v[40:43], v[56:59], v[100:115]
  v_exp_f32 v80, v80
  v_exp_f32 v81, v81
  v_exp_f32 v82, v82
  v_exp_f32 v83, v83
  v_cvt_pk_bf16_f32 v62, v80, v81
  v_cvt_pk_bf16_f32 v63, v82, v83
  s_waitcnt lgkmcnt(2)
  v_mfma_f32_32x32x16_bf16 v[68:83], v[32:35], v[12:15], v[132:147]
  v_exp_f32 v84, v84
  v_exp_f32 v85, v85
  v_exp_f32 v86, v86
  v_exp_f32 v87, v87
  v_cvt_pk_bf16_f32 v56, v84, v85
  v_cvt_pk_bf16_f32 v57, v86, v87
  v_mfma_f32_32x32x16_bf16 v[100:115], v[44:47], v[60:63], v[100:115]
  ds_read_b128 v[28:31], v6 offset:19456
  v_add_u32 v2, 19456, v7
  ds_read2_b32 v[36:37], v2 offset0:0 offset1:32
  v_exp_f32 v88, v88
  v_exp_f32 v89, v89
  v_exp_f32 v90, v90
  v_exp_f32 v91, v91
  v_cvt_pk_bf16_f32 v58, v88, v89
  v_cvt_pk_bf16_f32 v59, v90, v91
  v_mfma_f32_32x32x8_bf16 v[68:83], v[38:39], v[22:23], v[68:83]
  v_exp_f32 v92, v92
  v_exp_f32 v93, v93
  v_exp_f32 v94, v94
  v_exp_f32 v95, v95
  v_cvt_pk_bf16_f32 v60, v92, v93
  v_cvt_pk_bf16_f32 v61, v94, v95
  v_mfma_f32_32x32x16_bf16 v[116:131], v[40:43], v[56:59], v[116:131]
  v_exp_f32 v96, v96
  v_exp_f32 v97, v97
  v_exp_f32 v98, v98
  v_exp_f32 v99, v99
  v_cvt_pk_bf16_f32 v62, v96, v97
  v_cvt_pk_bf16_f32 v63, v98, v99
  v_mfma_f32_32x32x16_bf16 v[84:99], v[32:35], v[16:19], v[148:163]
  v_exp_f32 v68, v68
  v_exp_f32 v69, v69
  v_exp_f32 v70, v70
  v_exp_f32 v71, v71
  v_cvt_pk_bf16_f32 v56, v68, v69
  v_cvt_pk_bf16_f32 v57, v70, v71
  v_mfma_f32_32x32x16_bf16 v[116:131], v[44:47], v[60:63], v[116:131]
  ds_read_b128 v[40:43], v8 offset:19456
  ds_read_b128 v[44:47], v8 offset:20096
  v_exp_f32 v72, v72
  v_exp_f32 v73, v73
  v_exp_f32 v74, v74
  v_exp_f32 v75, v75
  v_cvt_pk_bf16_f32 v58, v72, v73
  v_cvt_pk_bf16_f32 v59, v74, v75
  v_mfma_f32_32x32x8_bf16 v[84:99], v[38:39], v[26:27], v[84:99]
  v_exp_f32 v76, v76
  v_exp_f32 v77, v77
  v_exp_f32 v78, v78
  v_exp_f32 v79, v79
  v_cvt_pk_bf16_f32 v60, v76, v77
  v_cvt_pk_bf16_f32 v61, v78, v79
  s_waitcnt lgkmcnt(4)
  v_mfma_f32_32x32x16_bf16 v[100:115], v[48:51], v[56:59], v[100:115]
  v_exp_f32 v80, v80
  v_exp_f32 v81, v81
  v_exp_f32 v82, v82
  v_exp_f32 v83, v83
  v_cvt_pk_bf16_f32 v62, v80, v81
  v_cvt_pk_bf16_f32 v63, v82, v83
  s_waitcnt lgkmcnt(2)
  v_mfma_f32_32x32x16_bf16 v[68:83], v[28:31], v[12:15], v[132:147]
  v_exp_f32 v84, v84
  v_exp_f32 v85, v85
  v_exp_f32 v86, v86
  v_exp_f32 v87, v87
  v_cvt_pk_bf16_f32 v56, v84, v85
  v_cvt_pk_bf16_f32 v57, v86, v87
  v_mfma_f32_32x32x16_bf16 v[100:115], v[52:55], v[60:63], v[100:115]
  ds_read_b128 v[32:35], v6 offset:20480
  v_exp_f32 v88, v88
  v_exp_f32 v89, v89
  v_exp_f32 v90, v90
  v_exp_f32 v91, v91
  v_cvt_pk_bf16_f32 v58, v88, v89
  v_cvt_pk_bf16_f32 v59, v90, v91
  v_mfma_f32_32x32x8_bf16 v[68:83], v[36:37], v[20:21], v[68:83]
  v_exp_f32 v92, v92
  v_exp_f32 v93, v93
  v_exp_f32 v94, v94
  v_exp_f32 v95, v95
  v_cvt_pk_bf16_f32 v60, v92, v93
  v_cvt_pk_bf16_f32 v61, v94, v95
  v_mfma_f32_32x32x16_bf16 v[116:131], v[48:51], v[56:59], v[116:131]
  v_exp_f32 v96, v96
  v_exp_f32 v97, v97
  v_exp_f32 v98, v98
  v_exp_f32 v99, v99
  v_cvt_pk_bf16_f32 v62, v96, v97
  v_cvt_pk_bf16_f32 v63, v98, v99
  v_add_u32 v6, 19456, v6
  v_add_u32 v7, 19456, v7
  v_add_u32 v8, 19456, v8
  s_add_u32 s44, s44, 1
  s_cmp_lt_u32 s44, 4
  s_cbranch_scc1 gated_mix__linear_attn_block__mha_block__prompt_kernel_loop
  v_mfma_f32_32x32x16_bf16 v[116:131], v[52:55], v[60:63], v[116:131]
  s_waitcnt lgkmcnt(0)
  s_nop 7
  s_nop 1
  s_and_b32 s29, s24, 3
  s_mul_i32 s29, s29, 3072
  s_add_u32 s30, s29, 41472
  s_add_u32 s31, s29, 120320
  s_cmp_eq_u32 s37, 0
  s_cselect_b32 s32, s30, s31
  s_cselect_b32 s30, s31, s30
  v_add_u32 v2, s32, v9
  v_add_u32 v3, s30, v9
  s_cbranch_scc1 gated_mix__linear_attn_block__mha_block__prompt_kernel_h0
  ds_write_b128 v2, v[100:103] offset:0
  ds_write_b128 v2, v[104:107] offset:1024
  ds_write_b128 v2, v[108:111] offset:2048
  s_waitcnt lgkmcnt(0)
  v_mov_b32 v100, v116
  v_mov_b32 v101, v117
  v_mov_b32 v102, v118
  v_mov_b32 v103, v119
  v_mov_b32 v104, v120
  v_mov_b32 v105, v121
  v_mov_b32 v106, v122
  v_mov_b32 v107, v123
  v_mov_b32 v108, v124
  v_mov_b32 v109, v125
  v_mov_b32 v110, v126
  v_mov_b32 v111, v127
  s_branch gated_mix__linear_attn_block__mha_block__prompt_kernel_h1
gated_mix__linear_attn_block__mha_block__prompt_kernel_h0:
  ds_write_b128 v2, v[116:119] offset:0
  ds_write_b128 v2, v[120:123] offset:1024
  ds_write_b128 v2, v[124:127] offset:2048
gated_mix__linear_attn_block__mha_block__prompt_kernel_h1:
  s_waitcnt lgkmcnt(0)
  s_barrier
  ds_read_b128 v[68:71], v3 offset:0
  ds_read_b128 v[72:75], v3 offset:1024
  ds_read_b128 v[76:79], v3 offset:2048
  s_lshl_b32 s29, s38, 1
  s_add_u32 s29, s29, s37
  s_lshl_b32 s29, s29, 7
  s_add_u32 s29, s29, 119296
  v_add_u32 v4, s29, v11
  ds_read_b32 v64, v4
  s_waitcnt lgkmcnt(0)
  v_add_f32 v100, v100, v68
  v_add_f32 v101, v101, v69
  v_add_f32 v102, v102, v70
  v_add_f32 v103, v103, v71
  v_add_f32 v104, v104, v72
  v_add_f32 v105, v105, v73
  v_add_f32 v106, v106, v74
  v_add_f32 v107, v107, v75
  v_add_f32 v108, v108, v76
  v_add_f32 v109, v109, v77
  v_add_f32 v110, v110, v78
  v_add_f32 v111, v111, v79
  v_mov_b32 v2, v110
  v_mov_b32 v3, v110
  s_nop 1
  v_permlane32_swap_b32 v2, v3
  s_nop 1
  v_rcp_f32 v2, v2
  s_nop 0
  v_mul_f32 v2, v2, v64
  v_mul_f32 v100, v100, v2
  v_mul_f32 v101, v101, v2
  v_mul_f32 v102, v102, v2
  v_mul_f32 v103, v103, v2
  v_mul_f32 v104, v104, v2
  v_mul_f32 v105, v105, v2
  v_mul_f32 v106, v106, v2
  v_mul_f32 v107, v107, v2
  v_mul_f32 v108, v108, v2
  v_mul_f32 v109, v109, v2
  v_cvt_pk_bf16_f32 v100, v100, v101
  v_cvt_pk_bf16_f32 v101, v102, v103
  v_cvt_pk_bf16_f32 v102, v104, v105
  v_cvt_pk_bf16_f32 v103, v106, v107
  v_cvt_pk_bf16_f32 v104, v108, v109
  s_add_u32 s29, s39, 17328128
  s_add_u32 s30, s40, 19425280
  buffer_store_dwordx4 v[100:103], v9, s[12:15], s29 offen sc1
  buffer_store_dword v104, v10, s[12:15], s30 offen sc1
  s_waitcnt vmcnt(0)
  s_barrier
  s_and_b32 s71, s2, 7
  s_lshl_b32 s71, s71, 2
  s_lshr_b32 s31, s2, 3
  s_and_b32 s32, s31, 3
  s_add_u32 s71, s71, s32
  s_lshr_b32 s70, s31, 2
  s_lshr_b32 s72, s24, 1
  s_and_b32 s32, s24, 1
  s_lshl_b32 s73, s71, 1
  s_add_u32 s73, s73, s32
  s_lshl_b32 s31, s72, 9
  s_add_u32 s31, s31, s73
  s_lshl_b32 s31, s31, 10
  s_add_u32 s31, s31, 14968832
  buffer_load_dwordx4 v[28:31], v9, s[12:15], s31 offen sc1
  s_add_u32 s31, s31, 65536
  buffer_load_dwordx4 v[32:35], v9, s[12:15], s31 offen sc1
  s_add_u32 s31, s31, 65536
  buffer_load_dwordx4 v[36:39], v9, s[12:15], s31 offen sc1
  s_add_u32 s31, s31, 65536
  buffer_load_dwordx4 v[40:43], v9, s[12:15], s31 offen sc1
  s_add_u32 s31, s31, 65536
  buffer_load_dwordx4 v[44:47], v9, s[12:15], s31 offen sc1
  s_add_u32 s31, s31, 65536
  buffer_load_dwordx4 v[48:51], v9, s[12:15], s31 offen sc1
  s_add_u32 s31, s31, 65536
  buffer_load_dwordx4 v[52:55], v9, s[12:15], s31 offen sc1
  s_add_u32 s31, s31, 65536
  buffer_load_dwordx4 v[56:59], v9, s[12:15], s31 offen sc1
  s_lshl_b32 s31, s72, 16
  s_lshl_b32 s32, s73, 7
  s_add_u32 s31, s31, s32
  s_add_u32 s31, s31, 17065984
  v_lshrrev_b32 v65, 5, v1
  v_lshlrev_b32 v65, 15, v65
  v_add_u32 v65, v65, v11
  buffer_load_dword v60, v65, s[12:15], s31 offen sc1
  s_add_u32 s31, s31, 8192
  buffer_load_dword v61, v65, s[12:15], s31 offen sc1
  s_add_u32 s31, s31, 8192
  buffer_load_dword v62, v65, s[12:15], s31 offen sc1
  s_add_u32 s31, s31, 8192
  buffer_load_dword v63, v65, s[12:15], s31 offen sc1
  v_lshrrev_b32 v2, 4, v1
  v_and_b32 v3, 1, v2
  v_lshrrev_b32 v2, 1, v2
  v_and_b32 v4, 15, v1
  v_lshrrev_b32 v5, 2, v4
  v_and_b32 v4, 3, v4
  v_lshlrev_b32 v3, 5, v3
  v_lshlrev_b32 v4, 3, v4
  v_add_u32 v3, v3, v4
  v_mul_u32_u24 v5, 144, v5
  v_add_u32 v3, v3, v5
  s_and_b32 s31, s72, 1
  s_mul_i32 s31, s31, 77824
  s_lshr_b32 s32, s72, 1
  s_mul_i32 s32, s32, 20736
  s_add_u32 s31, s31, s32
  v_add_u32 v3, s31, v3
  v_mul_u32_u24 v4, 576, v2
  v_add_u32 v6, v3, v4
  v_mul_u32_u24 v4, 10368, v2
  v_add_u32 v7, v3, v4
  ds_read_b64_tr_b16 v[68:69], v6 offset:0
  ds_read_b64_tr_b16 v[70:71], v6 offset:1152
  ds_read_b64_tr_b16 v[72:73], v6 offset:64
  ds_read_b64_tr_b16 v[74:75], v6 offset:1216
  ds_read_b64_tr_b16 v[76:77], v6 offset:128
  ds_read_b64_tr_b16 v[78:79], v6 offset:1280
  s_waitcnt vmcnt(11)
  s_waitcnt lgkmcnt(4)
  v_mfma_f32_32x32x16_bf16 v[116:131], v[68:71], v[28:31], 0
  ds_read_b64_tr_b16 v[80:81], v6 offset:2880
  ds_read_b64_tr_b16 v[82:83], v6 offset:4032
  s_waitcnt lgkmcnt(4)
  v_mfma_f32_32x32x16_bf16 v[132:147], v[72:75], v[28:31], 0
  ds_read_b64_tr_b16 v[84:85], v6 offset:2944
  ds_read_b64_tr_b16 v[86:87], v6 offset:4096
  s_waitcnt lgkmcnt(4)
  v_mfma_f32_32x32x16_bf16 v[148:163], v[76:79], v[28:31], 0
  ds_read_b64_tr_b16 v[88:89], v6 offset:3008
  ds_read_b64_tr_b16 v[90:91], v6 offset:4160
  s_waitcnt vmcnt(10)
  s_waitcnt lgkmcnt(4)
  v_mfma_f32_32x32x16_bf16 v[116:131], v[80:83], v[32:35], v[116:131]
  ds_read_b64_tr_b16 v[68:69], v6 offset:5184
  ds_read_b64_tr_b16 v[70:71], v6 offset:6336
  s_waitcnt lgkmcnt(4)
  v_mfma_f32_32x32x16_bf16 v[132:147], v[84:87], v[32:35], v[132:147]
  ds_read_b64_tr_b16 v[72:73], v6 offset:5248
  ds_read_b64_tr_b16 v[74:75], v6 offset:6400
  s_waitcnt lgkmcnt(4)
  v_mfma_f32_32x32x16_bf16 v[148:163], v[88:91], v[32:35], v[148:163]
  ds_read_b64_tr_b16 v[76:77], v6 offset:5312
  ds_read_b64_tr_b16 v[78:79], v6 offset:6464
  s_waitcnt vmcnt(9)
  s_waitcnt lgkmcnt(4)
  v_mfma_f32_32x32x16_bf16 v[116:131], v[68:71], v[36:39], v[116:131]
  ds_read_b64_tr_b16 v[80:81], v6 offset:8064
  ds_read_b64_tr_b16 v[82:83], v6 offset:9216
  s_waitcnt lgkmcnt(4)
  v_mfma_f32_32x32x16_bf16 v[132:147], v[72:75], v[36:39], v[132:147]
  ds_read_b64_tr_b16 v[84:85], v6 offset:8128
  ds_read_b64_tr_b16 v[86:87], v6 offset:9280
  s_waitcnt lgkmcnt(4)
  v_mfma_f32_32x32x16_bf16 v[148:163], v[76:79], v[36:39], v[148:163]
  ds_read_b64_tr_b16 v[88:89], v6 offset:8192
  ds_read_b64_tr_b16 v[90:91], v6 offset:9344
  s_waitcnt vmcnt(8)
  s_waitcnt lgkmcnt(4)
  v_mfma_f32_32x32x16_bf16 v[116:131], v[80:83], v[40:43], v[116:131]
  ds_read_b64_tr_b16 v[68:69], v6 offset:10368
  ds_read_b64_tr_b16 v[70:71], v6 offset:11520
  s_waitcnt lgkmcnt(4)
  v_mfma_f32_32x32x16_bf16 v[132:147], v[84:87], v[40:43], v[132:147]
  ds_read_b64_tr_b16 v[72:73], v6 offset:10432
  ds_read_b64_tr_b16 v[74:75], v6 offset:11584
  s_waitcnt lgkmcnt(4)
  v_mfma_f32_32x32x16_bf16 v[148:163], v[88:91], v[40:43], v[148:163]
  ds_read_b64_tr_b16 v[76:77], v6 offset:10496
  ds_read_b64_tr_b16 v[78:79], v6 offset:11648
  s_waitcnt vmcnt(7)
  s_waitcnt lgkmcnt(4)
  v_mfma_f32_32x32x16_bf16 v[116:131], v[68:71], v[44:47], v[116:131]
  ds_read_b64_tr_b16 v[80:81], v6 offset:13248
  ds_read_b64_tr_b16 v[82:83], v6 offset:14400
  s_waitcnt lgkmcnt(4)
  v_mfma_f32_32x32x16_bf16 v[132:147], v[72:75], v[44:47], v[132:147]
  ds_read_b64_tr_b16 v[84:85], v6 offset:13312
  ds_read_b64_tr_b16 v[86:87], v6 offset:14464
  s_waitcnt lgkmcnt(4)
  v_mfma_f32_32x32x16_bf16 v[148:163], v[76:79], v[44:47], v[148:163]
  ds_read_b64_tr_b16 v[88:89], v6 offset:13376
  ds_read_b64_tr_b16 v[90:91], v6 offset:14528
  s_waitcnt vmcnt(6)
  s_waitcnt lgkmcnt(4)
  v_mfma_f32_32x32x16_bf16 v[116:131], v[80:83], v[48:51], v[116:131]
  ds_read_b64_tr_b16 v[68:69], v6 offset:15552
  ds_read_b64_tr_b16 v[70:71], v6 offset:16704
  s_waitcnt lgkmcnt(4)
  v_mfma_f32_32x32x16_bf16 v[132:147], v[84:87], v[48:51], v[132:147]
  ds_read_b64_tr_b16 v[72:73], v6 offset:15616
  ds_read_b64_tr_b16 v[74:75], v6 offset:16768
  s_waitcnt lgkmcnt(4)
  v_mfma_f32_32x32x16_bf16 v[148:163], v[88:91], v[48:51], v[148:163]
  ds_read_b64_tr_b16 v[76:77], v6 offset:15680
  ds_read_b64_tr_b16 v[78:79], v6 offset:16832
  s_waitcnt vmcnt(5)
  s_waitcnt lgkmcnt(4)
  v_mfma_f32_32x32x16_bf16 v[116:131], v[68:71], v[52:55], v[116:131]
  ds_read_b64_tr_b16 v[80:81], v6 offset:18432
  ds_read_b64_tr_b16 v[82:83], v6 offset:19584
  s_waitcnt lgkmcnt(4)
  v_mfma_f32_32x32x16_bf16 v[132:147], v[72:75], v[52:55], v[132:147]
  ds_read_b64_tr_b16 v[84:85], v6 offset:18496
  ds_read_b64_tr_b16 v[86:87], v6 offset:19648
  s_waitcnt lgkmcnt(4)
  v_mfma_f32_32x32x16_bf16 v[148:163], v[76:79], v[52:55], v[148:163]
  ds_read_b64_tr_b16 v[88:89], v6 offset:18560
  ds_read_b64_tr_b16 v[90:91], v6 offset:19712
  s_waitcnt vmcnt(4)
  s_waitcnt lgkmcnt(4)
  v_mfma_f32_32x32x16_bf16 v[116:131], v[80:83], v[56:59], v[116:131]
  ds_read_b64_tr_b16 v[68:69], v7 offset:2304
  ds_read_b64_tr_b16 v[70:71], v7 offset:7488
  s_waitcnt lgkmcnt(4)
  v_mfma_f32_32x32x16_bf16 v[132:147], v[84:87], v[56:59], v[132:147]
  ds_read_b64_tr_b16 v[72:73], v7 offset:2368
  ds_read_b64_tr_b16 v[74:75], v7 offset:7552
  s_waitcnt lgkmcnt(4)
  v_mfma_f32_32x32x16_bf16 v[148:163], v[88:91], v[56:59], v[148:163]
  ds_read_b64_tr_b16 v[76:77], v7 offset:2432
  ds_read_b64_tr_b16 v[78:79], v7 offset:7616
  s_waitcnt vmcnt(0)
  s_waitcnt lgkmcnt(4)
  v_mfma_f32_32x32x16_bf16 v[116:131], v[68:71], v[60:63], v[116:131]
  s_waitcnt lgkmcnt(2)
  v_mfma_f32_32x32x16_bf16 v[132:147], v[72:75], v[60:63], v[132:147]
  s_waitcnt lgkmcnt(0)
  v_mfma_f32_32x32x16_bf16 v[148:163], v[76:79], v[60:63], v[148:163]
  s_barrier
  s_mov_b32 s31, 120320
  s_cmp_eq_u32 s72, 1
  s_cselect_b32 s31, 63232, s31
  s_cmp_eq_u32 s72, 2
  s_cselect_b32 s31, 20736, s31
  s_cmp_eq_u32 s72, 3
  s_cselect_b32 s31, 4294868736, s31
  v_add_u32 v6, s31, v6
  v_add_u32 v7, s31, v7
  s_barrier
  s_lshl_b32 s31, s72, 9
  s_add_u32 s31, s31, s73
  s_lshl_b32 s31, s31, 10
  s_add_u32 s31, s31, 17328128
  buffer_load_dwordx4 v[28:31], v9, s[12:15], s31 offen sc1
  s_add_u32 s31, s31, 65536
  buffer_load_dwordx4 v[32:35], v9, s[12:15], s31 offen sc1
  s_add_u32 s31, s31, 65536
  buffer_load_dwordx4 v[36:39], v9, s[12:15], s31 offen sc1
  s_add_u32 s31, s31, 65536
  buffer_load_dwordx4 v[40:43], v9, s[12:15], s31 offen sc1
  s_add_u32 s31, s31, 65536
  buffer_load_dwordx4 v[44:47], v9, s[12:15], s31 offen sc1
  s_add_u32 s31, s31, 65536
  buffer_load_dwordx4 v[48:51], v9, s[12:15], s31 offen sc1
  s_add_u32 s31, s31, 65536
  buffer_load_dwordx4 v[52:55], v9, s[12:15], s31 offen sc1
  s_add_u32 s31, s31, 65536
  buffer_load_dwordx4 v[56:59], v9, s[12:15], s31 offen sc1
  s_lshl_b32 s31, s72, 16
  s_lshl_b32 s32, s73, 7
  s_add_u32 s31, s31, s32
  s_add_u32 s31, s31, 19425280
  v_lshrrev_b32 v65, 5, v1
  v_lshlrev_b32 v65, 15, v65
  v_add_u32 v65, v65, v11
  buffer_load_dword v60, v65, s[12:15], s31 offen sc1
  s_add_u32 s31, s31, 8192
  buffer_load_dword v61, v65, s[12:15], s31 offen sc1
  s_add_u32 s31, s31, 8192
  buffer_load_dword v62, v65, s[12:15], s31 offen sc1
  s_add_u32 s31, s31, 8192
  buffer_load_dword v63, v65, s[12:15], s31 offen sc1
  ds_read_b64_tr_b16 v[68:69], v6 offset:0
  ds_read_b64_tr_b16 v[70:71], v6 offset:1152
  ds_read_b64_tr_b16 v[72:73], v6 offset:64
  ds_read_b64_tr_b16 v[74:75], v6 offset:1216
  ds_read_b64_tr_b16 v[76:77], v6 offset:128
  ds_read_b64_tr_b16 v[78:79], v6 offset:1280
  s_waitcnt vmcnt(11)
  s_waitcnt lgkmcnt(4)
  v_mfma_f32_32x32x16_bf16 v[116:131], v[68:71], v[28:31], v[116:131]
  ds_read_b64_tr_b16 v[80:81], v6 offset:2880
  ds_read_b64_tr_b16 v[82:83], v6 offset:4032
  s_waitcnt lgkmcnt(4)
  v_mfma_f32_32x32x16_bf16 v[132:147], v[72:75], v[28:31], v[132:147]
  ds_read_b64_tr_b16 v[84:85], v6 offset:2944
  ds_read_b64_tr_b16 v[86:87], v6 offset:4096
  s_waitcnt lgkmcnt(4)
  v_mfma_f32_32x32x16_bf16 v[148:163], v[76:79], v[28:31], v[148:163]
  ds_read_b64_tr_b16 v[88:89], v6 offset:3008
  ds_read_b64_tr_b16 v[90:91], v6 offset:4160
  s_waitcnt vmcnt(10)
  s_waitcnt lgkmcnt(4)
  v_mfma_f32_32x32x16_bf16 v[116:131], v[80:83], v[32:35], v[116:131]
  ds_read_b64_tr_b16 v[68:69], v6 offset:5184
  ds_read_b64_tr_b16 v[70:71], v6 offset:6336
  s_waitcnt lgkmcnt(4)
  v_mfma_f32_32x32x16_bf16 v[132:147], v[84:87], v[32:35], v[132:147]
  ds_read_b64_tr_b16 v[72:73], v6 offset:5248
  ds_read_b64_tr_b16 v[74:75], v6 offset:6400
  s_waitcnt lgkmcnt(4)
  v_mfma_f32_32x32x16_bf16 v[148:163], v[88:91], v[32:35], v[148:163]
  ds_read_b64_tr_b16 v[76:77], v6 offset:5312
  ds_read_b64_tr_b16 v[78:79], v6 offset:6464
  s_waitcnt vmcnt(9)
  s_waitcnt lgkmcnt(4)
  v_mfma_f32_32x32x16_bf16 v[116:131], v[68:71], v[36:39], v[116:131]
  ds_read_b64_tr_b16 v[80:81], v6 offset:8064
  ds_read_b64_tr_b16 v[82:83], v6 offset:9216
  s_waitcnt lgkmcnt(4)
  v_mfma_f32_32x32x16_bf16 v[132:147], v[72:75], v[36:39], v[132:147]
  ds_read_b64_tr_b16 v[84:85], v6 offset:8128
  ds_read_b64_tr_b16 v[86:87], v6 offset:9280
  s_waitcnt lgkmcnt(4)
  v_mfma_f32_32x32x16_bf16 v[148:163], v[76:79], v[36:39], v[148:163]
  ds_read_b64_tr_b16 v[88:89], v6 offset:8192
  ds_read_b64_tr_b16 v[90:91], v6 offset:9344
  s_waitcnt vmcnt(8)
  s_waitcnt lgkmcnt(4)
  v_mfma_f32_32x32x16_bf16 v[116:131], v[80:83], v[40:43], v[116:131]
  ds_read_b64_tr_b16 v[68:69], v6 offset:10368
  ds_read_b64_tr_b16 v[70:71], v6 offset:11520
  s_waitcnt lgkmcnt(4)
  v_mfma_f32_32x32x16_bf16 v[132:147], v[84:87], v[40:43], v[132:147]
  ds_read_b64_tr_b16 v[72:73], v6 offset:10432
  ds_read_b64_tr_b16 v[74:75], v6 offset:11584
  s_waitcnt lgkmcnt(4)
  v_mfma_f32_32x32x16_bf16 v[148:163], v[88:91], v[40:43], v[148:163]
  ds_read_b64_tr_b16 v[76:77], v6 offset:10496
  ds_read_b64_tr_b16 v[78:79], v6 offset:11648
  s_waitcnt vmcnt(7)
  s_waitcnt lgkmcnt(4)
  v_mfma_f32_32x32x16_bf16 v[116:131], v[68:71], v[44:47], v[116:131]
  ds_read_b64_tr_b16 v[80:81], v6 offset:13248
  ds_read_b64_tr_b16 v[82:83], v6 offset:14400
  s_waitcnt lgkmcnt(4)
  v_mfma_f32_32x32x16_bf16 v[132:147], v[72:75], v[44:47], v[132:147]
  ds_read_b64_tr_b16 v[84:85], v6 offset:13312
  ds_read_b64_tr_b16 v[86:87], v6 offset:14464
  s_waitcnt lgkmcnt(4)
  v_mfma_f32_32x32x16_bf16 v[148:163], v[76:79], v[44:47], v[148:163]
  ds_read_b64_tr_b16 v[88:89], v6 offset:13376
  ds_read_b64_tr_b16 v[90:91], v6 offset:14528
  s_waitcnt vmcnt(6)
  s_waitcnt lgkmcnt(4)
  v_mfma_f32_32x32x16_bf16 v[116:131], v[80:83], v[48:51], v[116:131]
  ds_read_b64_tr_b16 v[68:69], v6 offset:15552
  ds_read_b64_tr_b16 v[70:71], v6 offset:16704
  s_waitcnt lgkmcnt(4)
  v_mfma_f32_32x32x16_bf16 v[132:147], v[84:87], v[48:51], v[132:147]
  ds_read_b64_tr_b16 v[72:73], v6 offset:15616
  ds_read_b64_tr_b16 v[74:75], v6 offset:16768
  s_waitcnt lgkmcnt(4)
  v_mfma_f32_32x32x16_bf16 v[148:163], v[88:91], v[48:51], v[148:163]
  ds_read_b64_tr_b16 v[76:77], v6 offset:15680
  ds_read_b64_tr_b16 v[78:79], v6 offset:16832
  s_waitcnt vmcnt(5)
  s_waitcnt lgkmcnt(4)
  v_mfma_f32_32x32x16_bf16 v[116:131], v[68:71], v[52:55], v[116:131]
  ds_read_b64_tr_b16 v[80:81], v6 offset:18432
  ds_read_b64_tr_b16 v[82:83], v6 offset:19584
  s_waitcnt lgkmcnt(4)
  v_mfma_f32_32x32x16_bf16 v[132:147], v[72:75], v[52:55], v[132:147]
  ds_read_b64_tr_b16 v[84:85], v6 offset:18496
  ds_read_b64_tr_b16 v[86:87], v6 offset:19648
  s_waitcnt lgkmcnt(4)
  v_mfma_f32_32x32x16_bf16 v[148:163], v[76:79], v[52:55], v[148:163]
  ds_read_b64_tr_b16 v[88:89], v6 offset:18560
  ds_read_b64_tr_b16 v[90:91], v6 offset:19712
  s_waitcnt vmcnt(4)
  s_waitcnt lgkmcnt(4)
  v_mfma_f32_32x32x16_bf16 v[116:131], v[80:83], v[56:59], v[116:131]
  ds_read_b64_tr_b16 v[68:69], v7 offset:2304
  ds_read_b64_tr_b16 v[70:71], v7 offset:7488
  s_waitcnt lgkmcnt(4)
  v_mfma_f32_32x32x16_bf16 v[132:147], v[84:87], v[56:59], v[132:147]
  ds_read_b64_tr_b16 v[72:73], v7 offset:2368
  ds_read_b64_tr_b16 v[74:75], v7 offset:7552
  s_waitcnt lgkmcnt(4)
  v_mfma_f32_32x32x16_bf16 v[148:163], v[88:91], v[56:59], v[148:163]
  ds_read_b64_tr_b16 v[76:77], v7 offset:2432
  ds_read_b64_tr_b16 v[78:79], v7 offset:7616
  s_waitcnt vmcnt(0)
  s_waitcnt lgkmcnt(4)
  v_mfma_f32_32x32x16_bf16 v[116:131], v[68:71], v[60:63], v[116:131]
  s_waitcnt lgkmcnt(2)
  v_mfma_f32_32x32x16_bf16 v[132:147], v[72:75], v[60:63], v[132:147]
  s_waitcnt lgkmcnt(0)
  v_mfma_f32_32x32x16_bf16 v[148:163], v[76:79], v[60:63], v[148:163]
  s_nop 15
  s_nop 3
  s_barrier
  s_and_b32 s32, s24, 1
  s_lshl_b32 s31, s32, 5
  v_and_b32 v3, 31, v1
  v_add_u32 v2, s31, v3
  v_mul_u32_u24 v2, 304, v2
  s_mul_i32 s31, s72, 19456
  v_add_u32 v2, s31, v2
  v_lshrrev_b32 v3, 5, v1
  v_lshlrev_b32 v3, 4, v3
  v_add_u32 v2, v2, v3
  ds_write_b128 v2, v[116:119] offset:0
  ds_write_b128 v2, v[120:123] offset:32
  ds_write_b128 v2, v[124:127] offset:64
  ds_write_b128 v2, v[128:131] offset:96
  ds_write_b128 v2, v[132:135] offset:128
  ds_write_b128 v2, v[136:139] offset:160
  ds_write_b128 v2, v[140:143] offset:192
  ds_write_b128 v2, v[144:147] offset:224
  ds_write_b128 v2, v[148:151] offset:256
  s_waitcnt lgkmcnt(0)
  s_barrier
  s_lshl_b32 s31, s24, 6
  v_add_u32 v2, s31, v1
  v_mul_u32_u24 v3, 7282, v2
  v_lshrrev_b32 v3, 16, v3
  v_mul_u32_u24 v4, 9, v3
  v_sub_u32 v4, v2, v4
  v_mul_u32_u24 v5, 304, v3
  v_lshlrev_b32 v66, 5, v4
  v_add_u32 v5, v5, v66
  ds_read_b128 v[28:31], v5 offset:0
  ds_read_b128 v[32:35], v5 offset:16
  ds_read_b128 v[36:39], v5 offset:19456
  ds_read_b128 v[40:43], v5 offset:19472
  ds_read_b128 v[44:47], v5 offset:38912
  ds_read_b128 v[48:51], v5 offset:38928
  ds_read_b128 v[52:55], v5 offset:58368
  ds_read_b128 v[56:59], v5 offset:58384
  s_lshl_b32 s31, s71, 6
  v_add_u32 v3, s31, v3
  v_mul_u32_u24 v3, 1152, v3
  v_lshlrev_b32 v4, 4, v4
  v_add_u32 v3, v3, v4
  s_mul_i32 s31, s70, 144
  s_waitcnt lgkmcnt(0)
  v_add_f32 v28, v28, v36
  v_add_f32 v44, v44, v52
  v_add_f32 v29, v29, v37
  v_add_f32 v45, v45, v53
  v_add_f32 v30, v30, v38
  v_add_f32 v46, v46, v54
  v_add_f32 v31, v31, v39
  v_add_f32 v47, v47, v55
  v_add_f32 v32, v32, v40
  v_add_f32 v48, v48, v56
  v_add_f32 v33, v33, v41
  v_add_f32 v49, v49, v57
  v_add_f32 v34, v34, v42
  v_add_f32 v50, v50, v58
  v_add_f32 v35, v35, v43
  v_add_f32 v51, v51, v59
  v_add_f32 v28, v28, v44
  v_add_f32 v29, v29, v45
  v_add_f32 v30, v30, v46
  v_add_f32 v31, v31, v47
  v_add_f32 v32, v32, v48
  v_add_f32 v33, v33, v49
  v_add_f32 v34, v34, v50
  v_add_f32 v35, v35, v51
  v_cvt_pk_bf16_f32 v60, v28, v29
  v_cvt_pk_bf16_f32 v61, v30, v31
  v_cvt_pk_bf16_f32 v62, v32, v33
  v_cvt_pk_bf16_f32 v63, v34, v35
  buffer_store_dwordx4 v[60:63], v3, s[88:91], s31 offen
  s_endpgm
gated_mix__linear_attn_block__mha_block__prompt_kernel_fb:
  s_waitcnt lgkmcnt(0)
  v_mov_b32 v2, 155904
  s_mov_b32 s29, 0
gated_mix__linear_attn_block__mha_block__prompt_kernel_fb_spin:
  ds_read_b32 v3, v2
  s_waitcnt lgkmcnt(0)
  v_readfirstlane_b32 s30, v3
  s_add_u32 s29, s29, 1
  s_cmp_gt_u32 s29, 0x100000
  s_cbranch_scc1 gated_mix__linear_attn_block__mha_block__prompt_kernel_fb_go
  s_sleep 1
  s_cmp_lg_u32 s30, 4
  s_cbranch_scc1 gated_mix__linear_attn_block__mha_block__prompt_kernel_fb_spin
gated_mix__linear_attn_block__mha_block__prompt_kernel_fb_go:
  v_mov_b32 v64, 0xff7fffff
  v_mov_b32 v65, 0xff7fffff
  v_mov_b32 v2, v9
  v_add_u32 v3, 8192, v11
  s_mov_b32 s29, 0
gated_mix__linear_attn_block__mha_block__prompt_kernel_fb_chunk:
  ds_read_b128 v[28:31], v2 offset:0
  ds_read2_b32 v[36:37], v3 offset0:0 offset1:32
  s_waitcnt lgkmcnt(0)
  v_mfma_f32_32x32x16_bf16 v[68:83], v[28:31], v[12:15], 0
  v_mfma_f32_32x32x8_bf16 v[68:83], v[36:37], v[20:21], v[68:83]
  v_mfma_f32_32x32x16_bf16 v[84:99], v[28:31], v[16:19], 0
  v_mfma_f32_32x32x8_bf16 v[84:99], v[36:37], v[24:25], v[84:99]
  s_nop 15
  s_nop 3
  v_max3_f32 v64, v64, v68, v69
  v_max3_f32 v64, v64, v70, v71
  v_max3_f32 v64, v64, v72, v73
  v_max3_f32 v64, v64, v74, v75
  v_max3_f32 v64, v64, v76, v77
  v_max3_f32 v64, v64, v78, v79
  v_max3_f32 v64, v64, v80, v81
  v_max3_f32 v64, v64, v82, v83
  v_max3_f32 v65, v65, v84, v85
  v_max3_f32 v65, v65, v86, v87
  v_max3_f32 v65, v65, v88, v89
  v_max3_f32 v65, v65, v90, v91
  v_max3_f32 v65, v65, v92, v93
  v_max3_f32 v65, v65, v94, v95
  v_max3_f32 v65, v65, v96, v97
  v_max3_f32 v65, v65, v98, v99
  ds_read_b128 v[28:31], v2 offset:1024
  s_waitcnt lgkmcnt(0)
  v_mfma_f32_32x32x16_bf16 v[68:83], v[28:31], v[12:15], 0
  v_mfma_f32_32x32x8_bf16 v[68:83], v[36:37], v[22:23], v[68:83]
  v_mfma_f32_32x32x16_bf16 v[84:99], v[28:31], v[16:19], 0
  v_mfma_f32_32x32x8_bf16 v[84:99], v[36:37], v[26:27], v[84:99]
  s_nop 15
  s_nop 3
  v_max3_f32 v64, v64, v68, v69
  v_max3_f32 v64, v64, v70, v71
  v_max3_f32 v64, v64, v72, v73
  v_max3_f32 v64, v64, v74, v75
  v_max3_f32 v64, v64, v76, v77
  v_max3_f32 v64, v64, v78, v79
  v_max3_f32 v64, v64, v80, v81
  v_max3_f32 v64, v64, v82, v83
  v_max3_f32 v65, v65, v84, v85
  v_max3_f32 v65, v65, v86, v87
  v_max3_f32 v65, v65, v88, v89
  v_max3_f32 v65, v65, v90, v91
  v_max3_f32 v65, v65, v92, v93
  v_max3_f32 v65, v65, v94, v95
  v_max3_f32 v65, v65, v96, v97
  v_max3_f32 v65, v65, v98, v99
  ds_read_b128 v[28:31], v2 offset:2048
  ds_read2_b32 v[36:37], v3 offset0:64 offset1:96
  s_waitcnt lgkmcnt(0)
  v_mfma_f32_32x32x16_bf16 v[68:83], v[28:31], v[12:15], 0
  v_mfma_f32_32x32x8_bf16 v[68:83], v[36:37], v[20:21], v[68:83]
  v_mfma_f32_32x32x16_bf16 v[84:99], v[28:31], v[16:19], 0
  v_mfma_f32_32x32x8_bf16 v[84:99], v[36:37], v[24:25], v[84:99]
  s_nop 15
  s_nop 3
  v_max3_f32 v64, v64, v68, v69
  v_max3_f32 v64, v64, v70, v71
  v_max3_f32 v64, v64, v72, v73
  v_max3_f32 v64, v64, v74, v75
  v_max3_f32 v64, v64, v76, v77
  v_max3_f32 v64, v64, v78, v79
  v_max3_f32 v64, v64, v80, v81
  v_max3_f32 v64, v64, v82, v83
  v_max3_f32 v65, v65, v84, v85
  v_max3_f32 v65, v65, v86, v87
  v_max3_f32 v65, v65, v88, v89
  v_max3_f32 v65, v65, v90, v91
  v_max3_f32 v65, v65, v92, v93
  v_max3_f32 v65, v65, v94, v95
  v_max3_f32 v65, v65, v96, v97
  v_max3_f32 v65, v65, v98, v99
  ds_read_b128 v[28:31], v2 offset:3072
  s_waitcnt lgkmcnt(0)
  v_mfma_f32_32x32x16_bf16 v[68:83], v[28:31], v[12:15], 0
  v_mfma_f32_32x32x8_bf16 v[68:83], v[36:37], v[22:23], v[68:83]
  v_mfma_f32_32x32x16_bf16 v[84:99], v[28:31], v[16:19], 0
  v_mfma_f32_32x32x8_bf16 v[84:99], v[36:37], v[26:27], v[84:99]
  s_nop 15
  s_nop 3
  v_max3_f32 v64, v64, v68, v69
  v_max3_f32 v64, v64, v70, v71
  v_max3_f32 v64, v64, v72, v73
  v_max3_f32 v64, v64, v74, v75
  v_max3_f32 v64, v64, v76, v77
  v_max3_f32 v64, v64, v78, v79
  v_max3_f32 v64, v64, v80, v81
  v_max3_f32 v64, v64, v82, v83
  v_max3_f32 v65, v65, v84, v85
  v_max3_f32 v65, v65, v86, v87
  v_max3_f32 v65, v65, v88, v89
  v_max3_f32 v65, v65, v90, v91
  v_max3_f32 v65, v65, v92, v93
  v_max3_f32 v65, v65, v94, v95
  v_max3_f32 v65, v65, v96, v97
  v_max3_f32 v65, v65, v98, v99
  ds_read_b128 v[28:31], v2 offset:4096
  ds_read2_b32 v[36:37], v3 offset0:128 offset1:160
  s_waitcnt lgkmcnt(0)
  v_mfma_f32_32x32x16_bf16 v[68:83], v[28:31], v[12:15], 0
  v_mfma_f32_32x32x8_bf16 v[68:83], v[36:37], v[20:21], v[68:83]
  v_mfma_f32_32x32x16_bf16 v[84:99], v[28:31], v[16:19], 0
  v_mfma_f32_32x32x8_bf16 v[84:99], v[36:37], v[24:25], v[84:99]
  s_nop 15
  s_nop 3
  v_max3_f32 v64, v64, v68, v69
  v_max3_f32 v64, v64, v70, v71
  v_max3_f32 v64, v64, v72, v73
  v_max3_f32 v64, v64, v74, v75
  v_max3_f32 v64, v64, v76, v77
  v_max3_f32 v64, v64, v78, v79
  v_max3_f32 v64, v64, v80, v81
  v_max3_f32 v64, v64, v82, v83
  v_max3_f32 v65, v65, v84, v85
  v_max3_f32 v65, v65, v86, v87
  v_max3_f32 v65, v65, v88, v89
  v_max3_f32 v65, v65, v90, v91
  v_max3_f32 v65, v65, v92, v93
  v_max3_f32 v65, v65, v94, v95
  v_max3_f32 v65, v65, v96, v97
  v_max3_f32 v65, v65, v98, v99
  ds_read_b128 v[28:31], v2 offset:5120
  s_waitcnt lgkmcnt(0)
  v_mfma_f32_32x32x16_bf16 v[68:83], v[28:31], v[12:15], 0
  v_mfma_f32_32x32x8_bf16 v[68:83], v[36:37], v[22:23], v[68:83]
  v_mfma_f32_32x32x16_bf16 v[84:99], v[28:31], v[16:19], 0
  v_mfma_f32_32x32x8_bf16 v[84:99], v[36:37], v[26:27], v[84:99]
  s_nop 15
  s_nop 3
  v_max3_f32 v64, v64, v68, v69
  v_max3_f32 v64, v64, v70, v71
  v_max3_f32 v64, v64, v72, v73
  v_max3_f32 v64, v64, v74, v75
  v_max3_f32 v64, v64, v76, v77
  v_max3_f32 v64, v64, v78, v79
  v_max3_f32 v64, v64, v80, v81
  v_max3_f32 v64, v64, v82, v83
  v_max3_f32 v65, v65, v84, v85
  v_max3_f32 v65, v65, v86, v87
  v_max3_f32 v65, v65, v88, v89
  v_max3_f32 v65, v65, v90, v91
  v_max3_f32 v65, v65, v92, v93
  v_max3_f32 v65, v65, v94, v95
  v_max3_f32 v65, v65, v96, v97
  v_max3_f32 v65, v65, v98, v99
  ds_read_b128 v[28:31], v2 offset:6144
  ds_read2_b32 v[36:37], v3 offset0:192 offset1:224
  s_waitcnt lgkmcnt(0)
  v_mfma_f32_32x32x16_bf16 v[68:83], v[28:31], v[12:15], 0
  v_mfma_f32_32x32x8_bf16 v[68:83], v[36:37], v[20:21], v[68:83]
  v_mfma_f32_32x32x16_bf16 v[84:99], v[28:31], v[16:19], 0
  v_mfma_f32_32x32x8_bf16 v[84:99], v[36:37], v[24:25], v[84:99]
  s_nop 15
  s_nop 3
  v_max3_f32 v64, v64, v68, v69
  v_max3_f32 v64, v64, v70, v71
  v_max3_f32 v64, v64, v72, v73
  v_max3_f32 v64, v64, v74, v75
  v_max3_f32 v64, v64, v76, v77
  v_max3_f32 v64, v64, v78, v79
  v_max3_f32 v64, v64, v80, v81
  v_max3_f32 v64, v64, v82, v83
  v_max3_f32 v65, v65, v84, v85
  v_max3_f32 v65, v65, v86, v87
  v_max3_f32 v65, v65, v88, v89
  v_max3_f32 v65, v65, v90, v91
  v_max3_f32 v65, v65, v92, v93
  v_max3_f32 v65, v65, v94, v95
  v_max3_f32 v65, v65, v96, v97
  v_max3_f32 v65, v65, v98, v99
  ds_read_b128 v[28:31], v2 offset:7168
  s_waitcnt lgkmcnt(0)
  v_mfma_f32_32x32x16_bf16 v[68:83], v[28:31], v[12:15], 0
  v_mfma_f32_32x32x8_bf16 v[68:83], v[36:37], v[22:23], v[68:83]
  v_mfma_f32_32x32x16_bf16 v[84:99], v[28:31], v[16:19], 0
  v_mfma_f32_32x32x8_bf16 v[84:99], v[36:37], v[26:27], v[84:99]
  s_nop 15
  s_nop 3
  v_max3_f32 v64, v64, v68, v69
  v_max3_f32 v64, v64, v70, v71
  v_max3_f32 v64, v64, v72, v73
  v_max3_f32 v64, v64, v74, v75
  v_max3_f32 v64, v64, v76, v77
  v_max3_f32 v64, v64, v78, v79
  v_max3_f32 v64, v64, v80, v81
  v_max3_f32 v64, v64, v82, v83
  v_max3_f32 v65, v65, v84, v85
  v_max3_f32 v65, v65, v86, v87
  v_max3_f32 v65, v65, v88, v89
  v_max3_f32 v65, v65, v90, v91
  v_max3_f32 v65, v65, v92, v93
  v_max3_f32 v65, v65, v94, v95
  v_max3_f32 v65, v65, v96, v97
  v_max3_f32 v65, v65, v98, v99
  v_add_u32 v2, 19456, v2
  v_add_u32 v3, 19456, v3
  s_add_u32 s29, s29, 1
  s_cmp_lt_u32 s29, 8
  s_cbranch_scc1 gated_mix__linear_attn_block__mha_block__prompt_kernel_fb_chunk
  v_mov_b32 v2, v64
  v_mov_b32 v3, v65
  s_nop 1
  v_permlane32_swap_b32 v64, v2
  v_permlane32_swap_b32 v65, v3
  s_nop 1
  v_max_f32 v64, v64, v2
  v_max_f32 v65, v65, v3
  v_sub_f32 v132, 0, v64
  v_sub_f32 v148, 0, v65
  v_mov_b32 v133, v132
  v_mov_b32 v149, v148
  v_mov_b32 v134, v132
  v_mov_b32 v150, v148
  v_mov_b32 v135, v132
  v_mov_b32 v151, v148
  v_mov_b32 v136, v132
  v_mov_b32 v152, v148
  v_mov_b32 v137, v132
  v_mov_b32 v153, v148
  v_mov_b32 v138, v132
  v_mov_b32 v154, v148
  v_mov_b32 v139, v132
  v_mov_b32 v155, v148
  v_mov_b32 v140, v132
  v_mov_b32 v156, v148
  v_mov_b32 v141, v132
  v_mov_b32 v157, v148
  v_mov_b32 v142, v132
  v_mov_b32 v158, v148
  v_mov_b32 v143, v132
  v_mov_b32 v159, v148
  v_mov_b32 v144, v132
  v_mov_b32 v160, v148
  v_mov_b32 v145, v132
  v_mov_b32 v161, v148
  v_mov_b32 v146, v132
  v_mov_b32 v162, v148
  v_mov_b32 v147, v132
  v_mov_b32 v163, v148
  ds_read_b128 v[28:31], v6
  ds_read2_b32 v[36:37], v7 offset0:0 offset1:32
  ds_read_b128 v[40:43], v8
  ds_read_b128 v[44:47], v8 offset:640
  ds_read_b128 v[32:35], v6 offset:1024
  s_branch gated_mix__linear_attn_block__mha_block__prompt_kernel_fast
gated_mix__linear_attn_block__mha_block__prompt_kernel_end:
  s_endpgm
.section .rodata,"a"
.p2align 6
.amdhsa_kernel gated_mix__linear_attn_block__mha_block__prompt_kernel
  .amdhsa_next_free_vgpr 168
  .amdhsa_next_free_sgpr 100
  .amdhsa_accum_offset 168
  .amdhsa_group_segment_fixed_size 0
  .amdhsa_kernarg_size 80
  .amdhsa_user_sgpr_count 2
  .amdhsa_user_sgpr_kernarg_segment_ptr 1
  .amdhsa_system_sgpr_workgroup_id_x 1
.end_amdhsa_kernel
.text
```
